```python
import torch

def _softmax(x, axis=-1):
    return torch.softmax(x, dim=axis)
def _gelu(x):
    return torch.nn.functional.gelu(x, approximate="tanh")
def _silu(x):
    return torch.nn.functional.silu(x)
def _sigmoid(x):
    return torch.sigmoid(x)
def _layernorm(x, axis=-1, eps=1e-5):
    m = x.mean(dim=axis, keepdim=True)
    v = x.var(dim=axis, keepdim=True, unbiased=False)
    return (x - m) / torch.sqrt(v + eps)
def _scatter_add(tgt, idx, src, axis=0):
    return tgt.clone().index_add_(axis, idx, src)
def _segment_sum(src, seg, n):
    out = torch.zeros((n,) + src.shape[1:], dtype=src.dtype)
    return out.index_add_(0, seg, src)
def _pad(x, pw):
    flat = tuple(v for pair in reversed(pw) for v in pair)
    return torch.nn.functional.pad(x, flat)

kernel_name = 'standalone__mha_block_cached__near_ridge'

def setup_inputs():

    _w = (lambda a: (lambda t: t.to(torch.bfloat16) if t.is_floating_point() else t)(torch.as_tensor(a)))
    B, Sq, D = 8, 192, 512
    H, Sk, Dh = 32, 2048, 128
    return {
        "x": _w((lambda *s: torch.randn(*s, dtype=torch.bfloat16) * 0.8)(B, Sq, D)),
        "k_cache": _w((lambda *s: torch.randn(*s, dtype=torch.bfloat16) * 0.8)(B, H, Sk, Dh)),
        "v_cache": _w((lambda *s: torch.randn(*s, dtype=torch.bfloat16) * 0.05)(B, H, Sk, Dh)),
        "wq": _w((lambda *s: torch.randn(*s, dtype=torch.bfloat16) * 0.8)(D, H * Dh) * (D ** -0.5)),
        "wo": _w((lambda *s: torch.randn(*s, dtype=torch.bfloat16) * 0.05)(H * Dh, D) * ((H * Dh) ** -0.5)),
    }

def reference(x, k_cache, v_cache, wq, wo):
    B, Sq, D = x.shape
    H, Dh = 32, 128
    q = (lambda x, *d: x.permute(*d))((x @ wq).reshape(B, Sq, H, Dh), 0, 2, 1, 3)
    scores = torch.einsum("bhqd,bhkd->bhqk", q, k_cache) * (Dh ** -0.5)
    p = _softmax(scores, axis=-1)
    o = torch.einsum("bhqk,bhkd->bhqd", p, v_cache)
    return (lambda x, *d: x.permute(*d))(o, 0, 2, 1, 3).reshape(B, Sq, H * Dh) @ wo
```

```asm
; @launch grid=(256,1,1) block=(256,1,1) lds=163840
.amdgcn_target "amdgcn-amd-amdhsa--gfx950"
.text
.globl standalone__mha_block_cached__near_ridge_kernel
.p2align 8
.type standalone__mha_block_cached__near_ridge_kernel,@function
standalone__mha_block_cached__near_ridge_kernel:
s_cmp_ge_u32 s2, 256
s_cbranch_scc1 L_end
v_lshrrev_b32 v6, 6, v0
v_and_b32 v0, 63, v0
v_readfirstlane_b32 s40, v6
s_mov_b32 s3, 0
L_restart:
s_load_dwordx16 s[4:19], s[0:1], 0
s_and_b32 s50, s2, 7
s_lshr_b32 s51, s2, 3
s_and_b32 s52, s50, 1
s_lshl_b32 s52, s52, 2
s_and_b32 s53, s51, 3
s_add_u32 s43, s52, s53
s_lshr_b32 s52, s50, 1
s_lshl_b32 s52, s52, 3
s_lshr_b32 s53, s51, 2
s_add_u32 s44, s52, s53
s_and_b32 s41, s40, 1
s_lshr_b32 s42, s40, 1
v_lshlrev_b32 v1, 4, v0
v_lshrrev_b32 v12, 3, v0
v_lshlrev_b32 v12, 12, v12
v_and_b32 v13, 7, v0
v_lshl_add_u32 v6, v13, 4, v12
v_add_u32 v7, 32768, v6
v_add_u32 v8, 65536, v6
v_add_u32 v9, 98304, v6
v_add_u32 v10, 131072, v6
v_add_u32 v11, 163840, v6
v_lshrrev_b32 v12, 4, v0
v_lshlrev_b32 v12, 15, v12
v_and_b32 v13, 15, v0
v_lshl_add_u32 v12, v13, 4, v12
v_add_u32 v13, 262144, v12
v_add_u32 v14, 131072, v12
v_add_u32 v15, 393216, v12
s_add_u32 s49, s43, s44
s_and_b32 s49, s49, 3
s_lshl_b32 s49, s49, 7
s_lshl_b32 s59, s40, 10
s_lshl_b32 s46, s40, 13
s_add_u32 s58, s49, 0
s_and_b32 s58, s58, 511
s_or_b32 s58, s58, 0
s_or_b32 s54, s58, s59
s_lshl_b32 s55, s58, 12
s_or_b32 s55, s55, s46
s_mul_i32 s56, s40, 1040
s_mul_i32 s57, s40, 1056
s_mul_i32 s52, s43, 196608
s_lshl_b32 s51, s44, 8
s_waitcnt lgkmcnt(0)
s_add_u32 s32, s10, s51
s_addc_u32 s33, s11, 0
s_sub_u32 s34, 4194304, s51
s_mov_b32 s35, 0x20000
s_add_u32 s28, s4, s52
s_addc_u32 s29, s5, 0
s_mov_b32 s30, 196608
s_mov_b32 s31, 0x20000
s_add_u32 m0, s57, 108416
s_nop 0
buffer_load_dwordx4 v12, s[32:35], s55 offen  lds
s_add_u32 m0, s57, 112640
s_nop 0
buffer_load_dwordx4 v13, s[32:35], s55 offen  lds
s_add_u32 m0, s57, 116864
s_nop 0
buffer_load_dwordx4 v14, s[32:35], s55 offen  lds
s_add_u32 m0, s57, 121088
s_nop 0
buffer_load_dwordx4 v15, s[32:35], s55 offen  lds
s_add_u32 m0, s56, 16640
s_nop 0
buffer_load_dwordx4 v6, s[28:31], s54 offen  lds
s_add_u32 m0, s56, 20800
s_nop 0
buffer_load_dwordx4 v7, s[28:31], s54 offen  lds
s_add_u32 m0, s56, 24960
s_nop 0
buffer_load_dwordx4 v8, s[28:31], s54 offen  lds
s_add_u32 m0, s56, 29120
s_nop 0
buffer_load_dwordx4 v9, s[28:31], s54 offen  lds
s_add_u32 m0, s56, 33280
s_nop 0
buffer_load_dwordx4 v10, s[28:31], s54 offen  lds
s_add_u32 m0, s56, 37440
s_nop 0
buffer_load_dwordx4 v11, s[28:31], s54 offen  lds
s_add_u32 s58, s49, 128
s_and_b32 s58, s58, 511
s_or_b32 s58, s58, 0
s_or_b32 s54, s58, s59
s_lshl_b32 s55, s58, 12
s_or_b32 s55, s55, s46
s_getpc_b64 s[50:51]
L_pc:
s_lshr_b32 s52, s2, 3
s_lshl_b32 s52, s52, 4
v_and_b32 v246, 15, v0
v_add_u32 v246, s52, v246
v_lshlrev_b32 v246, 7, v246
v_min_u32 v246, L_codeend-L_pc-4, v246
v_mov_b32 v245, s51
v_add_co_u32 v244, vcc, s50, v246
s_nop 1
v_addc_co_u32 v245, vcc, 0, v245, vcc
global_load_dword v246, v[244:245], off
s_cmp_lg_u32 s3, 0
s_cbranch_scc1 L_snapback
s_lshl_b32 s50, s43, 7
s_add_u32 s50, s50, 19922944
s_add_u32 s50, s18, s50
s_addc_u32 s51, s19, 0
v_and_b32 v242, 31, v0
v_lshlrev_b32 v242, 2, v242
global_load_dword v243, v242, s[50:51] sc1
L_snapped:
s_lshl_b32 s50, s43, 5
s_add_u32 s50, s50, s44
s_lshr_b32 s52, s50, 13
s_lshl_b32 s51, s50, 19
s_add_u32 s20, s6, s51
s_addc_u32 s21, s7, s52
s_mov_b32 s22, 524288
s_mov_b32 s23, 0x20000
s_add_u32 s24, s8, s51
s_addc_u32 s25, s9, s52
s_mov_b32 s26, 524288
s_mov_b32 s27, 0x20000
s_mul_i32 s51, s43, 1572864
s_lshl_b32 s52, s44, 12
s_add_u32 s51, s51, s52
s_add_u32 s36, s18, s51
s_addc_u32 s37, s19, 0
s_sub_u32 s38, 1572864, s52
s_mov_b32 s39, 0x20000
s_mul_i32 s47, s40, 4160
s_mul_i32 s48, s40, 4224
s_add_u32 s48, s48, 66560
s_lshl_b32 s45, s40, 12
v_and_b32 v252, 15, v0
v_bfe_u32 v253, v0, 3, 1
v_lshlrev_b32 v253, 2, v253
v_xor_b32 v252, v252, v253
v_bfe_u32 v253, v0, 4, 1
v_lshlrev_b32 v253, 7, v253
v_lshrrev_b32 v254, 5, v0
v_lshl_add_u32 v253, v254, 6, v253
v_mul_u32_u24 v254, 1040, v252
s_lshl_b32 s50, s42, 9
v_add3_u32 v2, v254, v253, s50
v_mul_u32_u24 v254, 272, v252
s_mul_i32 s51, s41, 4352
s_add_u32 s51, s51, 117248
v_add3_u32 v5, v254, v253, s51
s_lshl_b32 s52, s42, 7
s_add_u32 s51, s51, s52
v_lshrrev_b32 v253, 4, v0
v_lshlrev_b32 v253, 3, v253
v_add3_u32 v255, v254, v253, s51
v_subrev_u32 v250, 67328, v5
v_subrev_u32 v251, 67328, v255
v_lshrrev_b32 v252, 2, v0
v_lshrrev_b32 v253, 5, v0
v_lshlrev_b32 v253, 2, v253
v_xor_b32 v253, v252, v253
v_mul_u32_u24 v253, 1056, v253
v_and_b32 v254, 3, v0
v_lshl_add_u32 v253, v254, 3, v253
s_add_u32 s50, s50, 66560
s_add_u32 s51, s50, s52
s_sub_u32 s53, s50, s52
s_add_u32 s53, s53, 128
v_add_u32 v3, s51, v253
v_add_u32 v4, s53, v253
v_mul_u32_u24 v253, 1056, v252
v_lshl_add_u32 v253, v254, 3, v253
s_add_u32 s50, s52, 108416
v_add_u32 v254, s50, v253
v_and_b32 v252, 3, v0
s_mul_i32 s50, s41, 12
v_add_u32 v252, s50, v252
v_mul_u32_u24 v252, 1040, v252
v_bfe_u32 v253, v0, 2, 2
v_lshl_add_u32 v252, v253, 7, v252
v_bfe_u32 v253, v0, 4, 1
v_lshl_add_u32 v252, v253, 6, v252
v_lshrrev_b32 v253, 5, v0
v_lshl_add_u32 v252, v253, 5, v252
v_add_u32 v253, 83456, v252
v_add_u32 v252, 16640, v252
v_mov_b32 v96, 0
v_accvgpr_write_b32 a80, 0
v_mov_b32 v97, 0
v_accvgpr_write_b32 a81, 0
v_mov_b32 v98, 0
v_accvgpr_write_b32 a82, 0
v_mov_b32 v99, 0
v_accvgpr_write_b32 a83, 0
v_mov_b32 v100, 0
v_accvgpr_write_b32 a84, 0
v_mov_b32 v101, 0
v_accvgpr_write_b32 a85, 0
v_mov_b32 v102, 0
v_accvgpr_write_b32 a86, 0
v_mov_b32 v103, 0
v_accvgpr_write_b32 a87, 0
v_mov_b32 v104, 0
v_accvgpr_write_b32 a88, 0
v_mov_b32 v105, 0
v_accvgpr_write_b32 a89, 0
v_mov_b32 v106, 0
v_accvgpr_write_b32 a90, 0
v_mov_b32 v107, 0
v_accvgpr_write_b32 a91, 0
v_mov_b32 v108, 0
v_accvgpr_write_b32 a92, 0
v_mov_b32 v109, 0
v_accvgpr_write_b32 a93, 0
v_mov_b32 v110, 0
v_accvgpr_write_b32 a94, 0
v_mov_b32 v111, 0
v_accvgpr_write_b32 a95, 0
s_add_u32 m0, s57, 125312
s_nop 0
buffer_load_dwordx4 v12, s[32:35], s55 offen  lds
s_add_u32 m0, s57, 129536
s_nop 0
buffer_load_dwordx4 v13, s[32:35], s55 offen  lds
s_add_u32 m0, s57, 133760
s_nop 0
buffer_load_dwordx4 v14, s[32:35], s55 offen  lds
s_add_u32 m0, s57, 137984
s_nop 0
buffer_load_dwordx4 v15, s[32:35], s55 offen  lds
s_add_u32 m0, s56, 41600
s_nop 0
buffer_load_dwordx4 v6, s[28:31], s54 offen  lds
s_add_u32 m0, s56, 45760
s_nop 0
buffer_load_dwordx4 v7, s[28:31], s54 offen  lds
s_add_u32 m0, s56, 49920
s_nop 0
buffer_load_dwordx4 v8, s[28:31], s54 offen  lds
s_add_u32 m0, s56, 54080
s_nop 0
buffer_load_dwordx4 v9, s[28:31], s54 offen  lds
s_add_u32 m0, s56, 58240
s_nop 0
buffer_load_dwordx4 v10, s[28:31], s54 offen  lds
s_add_u32 m0, s56, 62400
s_nop 0
buffer_load_dwordx4 v11, s[28:31], s54 offen  lds
s_add_u32 s58, s49, 256
s_and_b32 s58, s58, 511
s_or_b32 s58, s58, 0
s_or_b32 s54, s58, s59
s_lshl_b32 s55, s58, 12
s_or_b32 s55, s55, s46
s_waitcnt vmcnt(11)
s_barrier
ds_read_b64_tr_b16 a[0:1], v254 offset:0
ds_read_b64_tr_b16 a[2:3], v254 offset:256
ds_read_b64_tr_b16 a[4:5], v254 offset:512
ds_read_b64_tr_b16 a[6:7], v254 offset:768
ds_read_b128 a[32:35], v252 offset:0
ds_read_b128 a[36:39], v252 offset:16
ds_read_b128 a[40:43], v252 offset:512
ds_read_b128 a[44:47], v252 offset:528
ds_read_b128 a[48:51], v252 offset:4160
ds_read_b128 a[52:55], v252 offset:4176
ds_read_b128 a[56:59], v252 offset:4672
ds_read_b128 a[60:63], v252 offset:4688
ds_read_b128 a[64:67], v252 offset:8320
ds_read_b128 a[68:71], v252 offset:8336
ds_read_b128 a[72:75], v252 offset:8832
ds_read_b128 a[76:79], v252 offset:8848
ds_read_b64_tr_b16 a[8:9], v254 offset:32
ds_read_b64_tr_b16 a[10:11], v254 offset:288
ds_read_b64_tr_b16 a[12:13], v254 offset:544
ds_read_b64_tr_b16 a[14:15], v254 offset:800
ds_read_b64_tr_b16 a[16:17], v254 offset:64
ds_read_b64_tr_b16 a[18:19], v254 offset:320
ds_read_b64_tr_b16 a[20:21], v254 offset:576
ds_read_b64_tr_b16 a[22:23], v254 offset:832
ds_read_b64_tr_b16 a[24:25], v254 offset:96
ds_read_b64_tr_b16 a[26:27], v254 offset:352
ds_read_b64_tr_b16 a[28:29], v254 offset:608
ds_read_b64_tr_b16 a[30:31], v254 offset:864
s_waitcnt lgkmcnt(12)
v_mfma_f32_16x16x32_bf16 v[112:115], a[0:3], a[32:35], 0
s_add_u32 m0, s57, 142208
v_mfma_f32_16x16x32_bf16 v[112:115], a[4:7], a[36:39], v[112:115]
buffer_load_dwordx4 v12, s[32:35], s55 offen  lds
s_add_u32 m0, s57, 146432
v_mfma_f32_16x16x32_bf16 v[128:131], a[0:3], a[40:43], 0
buffer_load_dwordx4 v13, s[32:35], s55 offen  lds
s_add_u32 m0, s57, 150656
v_mfma_f32_16x16x32_bf16 v[128:131], a[4:7], a[44:47], v[128:131]
buffer_load_dwordx4 v14, s[32:35], s55 offen  lds
s_add_u32 m0, s57, 154880
v_mfma_f32_16x16x32_bf16 v[144:147], a[0:3], a[48:51], 0
buffer_load_dwordx4 v15, s[32:35], s55 offen  lds
s_add_u32 m0, s56, 83456
v_mfma_f32_16x16x32_bf16 v[144:147], a[4:7], a[52:55], v[144:147]
buffer_load_dwordx4 v6, s[28:31], s54 offen  lds
s_add_u32 m0, s56, 87616
v_mfma_f32_16x16x32_bf16 v[160:163], a[0:3], a[56:59], 0
buffer_load_dwordx4 v7, s[28:31], s54 offen  lds
s_add_u32 m0, s56, 91776
v_mfma_f32_16x16x32_bf16 v[160:163], a[4:7], a[60:63], v[160:163]
buffer_load_dwordx4 v8, s[28:31], s54 offen  lds
s_add_u32 m0, s56, 95936
v_mfma_f32_16x16x32_bf16 v[176:179], a[0:3], a[64:67], 0
buffer_load_dwordx4 v9, s[28:31], s54 offen  lds
s_add_u32 m0, s56, 100096
v_mfma_f32_16x16x32_bf16 v[176:179], a[4:7], a[68:71], v[176:179]
buffer_load_dwordx4 v10, s[28:31], s54 offen  lds
s_add_u32 m0, s56, 104256
v_mfma_f32_16x16x32_bf16 v[192:195], a[0:3], a[72:75], 0
buffer_load_dwordx4 v11, s[28:31], s54 offen  lds
s_add_u32 s58, s49, 384
s_and_b32 s58, s58, 511
s_or_b32 s58, s58, 0
s_or_b32 s54, s58, s59
s_lshl_b32 s55, s58, 12
s_or_b32 s55, s55, s46
v_mfma_f32_16x16x32_bf16 v[192:195], a[4:7], a[76:79], v[192:195]
s_waitcnt lgkmcnt(0)
v_mfma_f32_16x16x32_bf16 v[116:119], a[8:11], a[32:35], 0
s_waitcnt vmcnt(10)
s_barrier
v_mfma_f32_16x16x32_bf16 v[116:119], a[12:15], a[36:39], v[116:119]
ds_read_b64_tr_b16 a[176:177], v254 offset:16896
s_add_u32 m0, s57, 108416
v_mfma_f32_16x16x32_bf16 v[132:135], a[8:11], a[40:43], 0
buffer_load_dwordx4 v12, s[32:35], s55 offen  lds
ds_read_b64_tr_b16 a[178:179], v254 offset:17152
v_mfma_f32_16x16x32_bf16 v[132:135], a[12:15], a[44:47], v[132:135]
ds_read_b64_tr_b16 a[180:181], v254 offset:17408
v_mfma_f32_16x16x32_bf16 v[148:151], a[8:11], a[48:51], 0
ds_read_b64_tr_b16 a[182:183], v254 offset:17664
v_mfma_f32_16x16x32_bf16 v[148:151], a[12:15], a[52:55], v[148:151]
ds_read_b64_tr_b16 a[184:185], v254 offset:16928
s_add_u32 m0, s57, 112640
v_mfma_f32_16x16x32_bf16 v[164:167], a[8:11], a[56:59], 0
buffer_load_dwordx4 v13, s[32:35], s55 offen  lds
ds_read_b64_tr_b16 a[186:187], v254 offset:17184
v_mfma_f32_16x16x32_bf16 v[164:167], a[12:15], a[60:63], v[164:167]
ds_read_b64_tr_b16 a[188:189], v254 offset:17440
v_mfma_f32_16x16x32_bf16 v[180:183], a[8:11], a[64:67], 0
ds_read_b64_tr_b16 a[190:191], v254 offset:17696
v_mfma_f32_16x16x32_bf16 v[180:183], a[12:15], a[68:71], v[180:183]
ds_read_b64_tr_b16 a[192:193], v254 offset:16960
v_mfma_f32_16x16x32_bf16 v[196:199], a[8:11], a[72:75], 0
ds_read_b64_tr_b16 a[194:195], v254 offset:17216
s_add_u32 m0, s57, 116864
v_mfma_f32_16x16x32_bf16 v[196:199], a[12:15], a[76:79], v[196:199]
buffer_load_dwordx4 v14, s[32:35], s55 offen  lds
v_mfma_f32_16x16x32_bf16 v[120:123], a[16:19], a[32:35], 0
ds_read_b64_tr_b16 a[196:197], v254 offset:17472
v_mfma_f32_16x16x32_bf16 v[120:123], a[20:23], a[36:39], v[120:123]
ds_read_b64_tr_b16 a[198:199], v254 offset:17728
v_mfma_f32_16x16x32_bf16 v[136:139], a[16:19], a[40:43], 0
ds_read_b64_tr_b16 a[200:201], v254 offset:16992
s_add_u32 m0, s57, 121088
v_mfma_f32_16x16x32_bf16 v[136:139], a[20:23], a[44:47], v[136:139]
buffer_load_dwordx4 v15, s[32:35], s55 offen  lds
ds_read_b64_tr_b16 a[202:203], v254 offset:17248
v_mfma_f32_16x16x32_bf16 v[152:155], a[16:19], a[48:51], 0
ds_read_b64_tr_b16 a[204:205], v254 offset:17504
v_mfma_f32_16x16x32_bf16 v[152:155], a[20:23], a[52:55], v[152:155]
ds_read_b64_tr_b16 a[206:207], v254 offset:17760
v_mfma_f32_16x16x32_bf16 v[168:171], a[16:19], a[56:59], 0
ds_read_b128 a[208:211], v252 offset:24960
v_mfma_f32_16x16x32_bf16 v[168:171], a[20:23], a[60:63], v[168:171]
ds_read_b128 a[212:215], v252 offset:24976
s_add_u32 m0, s56, 16640
v_mfma_f32_16x16x32_bf16 v[184:187], a[16:19], a[64:67], 0
buffer_load_dwordx4 v6, s[28:31], s54 offen  lds
ds_read_b128 a[216:219], v252 offset:25472
v_mfma_f32_16x16x32_bf16 v[184:187], a[20:23], a[68:71], v[184:187]
v_mfma_f32_16x16x32_bf16 v[200:203], a[16:19], a[72:75], 0
ds_read_b128 a[220:223], v252 offset:25488
v_mfma_f32_16x16x32_bf16 v[200:203], a[20:23], a[76:79], v[200:203]
ds_read_b128 a[224:227], v252 offset:29120
v_mfma_f32_16x16x32_bf16 v[124:127], a[24:27], a[32:35], 0
ds_read_b128 a[228:231], v252 offset:29136
s_add_u32 m0, s56, 20800
v_mfma_f32_16x16x32_bf16 v[124:127], a[28:31], a[36:39], v[124:127]
buffer_load_dwordx4 v7, s[28:31], s54 offen  lds
ds_read_b128 a[232:235], v252 offset:29632
v_mfma_f32_16x16x32_bf16 v[140:143], a[24:27], a[40:43], 0
ds_read_b128 a[236:239], v252 offset:29648
v_mfma_f32_16x16x32_bf16 v[140:143], a[28:31], a[44:47], v[140:143]
ds_read_b128 a[240:243], v252 offset:33280
v_mfma_f32_16x16x32_bf16 v[156:159], a[24:27], a[48:51], 0
ds_read_b128 a[244:247], v252 offset:33296
s_add_u32 m0, s56, 24960
v_mfma_f32_16x16x32_bf16 v[156:159], a[28:31], a[52:55], v[156:159]
buffer_load_dwordx4 v8, s[28:31], s54 offen  lds
ds_read_b128 a[248:251], v252 offset:33792
v_mfma_f32_16x16x32_bf16 v[172:175], a[24:27], a[56:59], 0
ds_read_b128 a[252:255], v252 offset:33808
v_mfma_f32_16x16x32_bf16 v[172:175], a[28:31], a[60:63], v[172:175]
v_mfma_f32_16x16x32_bf16 v[188:191], a[24:27], a[64:67], 0
v_mfma_f32_16x16x32_bf16 v[188:191], a[28:31], a[68:71], v[188:191]
s_add_u32 m0, s56, 29120
v_mfma_f32_16x16x32_bf16 v[204:207], a[24:27], a[72:75], 0
buffer_load_dwordx4 v9, s[28:31], s54 offen  lds
v_mfma_f32_16x16x32_bf16 v[204:207], a[28:31], a[76:79], v[204:207]
s_waitcnt lgkmcnt(0)
v_mfma_f32_16x16x32_bf16 v[112:115], a[176:179], a[208:211], v[112:115]
v_mfma_f32_16x16x32_bf16 v[112:115], a[180:183], a[212:215], v[112:115]
s_add_u32 m0, s56, 33280
v_mfma_f32_16x16x32_bf16 v[128:131], a[176:179], a[216:219], v[128:131]
buffer_load_dwordx4 v10, s[28:31], s54 offen  lds
v_mfma_f32_16x16x32_bf16 v[128:131], a[180:183], a[220:223], v[128:131]
v_mfma_f32_16x16x32_bf16 v[144:147], a[176:179], a[224:227], v[144:147]
v_mfma_f32_16x16x32_bf16 v[144:147], a[180:183], a[228:231], v[144:147]
v_mfma_f32_16x16x32_bf16 v[160:163], a[176:179], a[232:235], v[160:163]
s_add_u32 m0, s56, 37440
v_mfma_f32_16x16x32_bf16 v[160:163], a[180:183], a[236:239], v[160:163]
buffer_load_dwordx4 v11, s[28:31], s54 offen  lds
s_add_u32 s58, s49, 0
s_and_b32 s58, s58, 511
s_or_b32 s58, s58, 512
s_or_b32 s54, s58, s59
s_lshl_b32 s55, s58, 12
s_or_b32 s55, s55, s46
v_mfma_f32_16x16x32_bf16 v[176:179], a[176:179], a[240:243], v[176:179]
v_mfma_f32_16x16x32_bf16 v[176:179], a[180:183], a[244:247], v[176:179]
v_mfma_f32_16x16x32_bf16 v[192:195], a[176:179], a[248:251], v[192:195]
v_mfma_f32_16x16x32_bf16 v[192:195], a[180:183], a[252:255], v[192:195]
v_mfma_f32_16x16x32_bf16 v[116:119], a[184:187], a[208:211], v[116:119]
s_waitcnt vmcnt(10)
s_barrier
v_mfma_f32_16x16x32_bf16 v[116:119], a[188:191], a[212:215], v[116:119]
ds_read_b64_tr_b16 a[0:1], v254 offset:33792
s_add_u32 m0, s57, 125312
v_mfma_f32_16x16x32_bf16 v[132:135], a[184:187], a[216:219], v[132:135]
buffer_load_dwordx4 v12, s[32:35], s55 offen  lds
ds_read_b64_tr_b16 a[2:3], v254 offset:34048
v_mfma_f32_16x16x32_bf16 v[132:135], a[188:191], a[220:223], v[132:135]
ds_read_b64_tr_b16 a[4:5], v254 offset:34304
v_mfma_f32_16x16x32_bf16 v[148:151], a[184:187], a[224:227], v[148:151]
ds_read_b64_tr_b16 a[6:7], v254 offset:34560
v_mfma_f32_16x16x32_bf16 v[148:151], a[188:191], a[228:231], v[148:151]
ds_read_b64_tr_b16 a[8:9], v254 offset:33824
s_add_u32 m0, s57, 129536
v_mfma_f32_16x16x32_bf16 v[164:167], a[184:187], a[232:235], v[164:167]
buffer_load_dwordx4 v13, s[32:35], s55 offen  lds
ds_read_b64_tr_b16 a[10:11], v254 offset:34080
v_mfma_f32_16x16x32_bf16 v[164:167], a[188:191], a[236:239], v[164:167]
ds_read_b64_tr_b16 a[12:13], v254 offset:34336
v_mfma_f32_16x16x32_bf16 v[180:183], a[184:187], a[240:243], v[180:183]
ds_read_b64_tr_b16 a[14:15], v254 offset:34592
v_mfma_f32_16x16x32_bf16 v[180:183], a[188:191], a[244:247], v[180:183]
ds_read_b64_tr_b16 a[16:17], v254 offset:33856
v_mfma_f32_16x16x32_bf16 v[196:199], a[184:187], a[248:251], v[196:199]
ds_read_b64_tr_b16 a[18:19], v254 offset:34112
s_add_u32 m0, s57, 133760
v_mfma_f32_16x16x32_bf16 v[196:199], a[188:191], a[252:255], v[196:199]
buffer_load_dwordx4 v14, s[32:35], s55 offen  lds
v_mfma_f32_16x16x32_bf16 v[120:123], a[192:195], a[208:211], v[120:123]
ds_read_b64_tr_b16 a[20:21], v254 offset:34368
v_mfma_f32_16x16x32_bf16 v[120:123], a[196:199], a[212:215], v[120:123]
ds_read_b64_tr_b16 a[22:23], v254 offset:34624
v_mfma_f32_16x16x32_bf16 v[136:139], a[192:195], a[216:219], v[136:139]
ds_read_b64_tr_b16 a[24:25], v254 offset:33888
s_add_u32 m0, s57, 137984
v_mfma_f32_16x16x32_bf16 v[136:139], a[196:199], a[220:223], v[136:139]
buffer_load_dwordx4 v15, s[32:35], s55 offen  lds
ds_read_b64_tr_b16 a[26:27], v254 offset:34144
v_mfma_f32_16x16x32_bf16 v[152:155], a[192:195], a[224:227], v[152:155]
ds_read_b64_tr_b16 a[28:29], v254 offset:34400
v_mfma_f32_16x16x32_bf16 v[152:155], a[196:199], a[228:231], v[152:155]
ds_read_b64_tr_b16 a[30:31], v254 offset:34656
v_mfma_f32_16x16x32_bf16 v[168:171], a[192:195], a[232:235], v[168:171]
ds_read_b128 a[32:35], v253 offset:0
v_mfma_f32_16x16x32_bf16 v[168:171], a[196:199], a[236:239], v[168:171]
ds_read_b128 a[36:39], v253 offset:16
s_add_u32 m0, s56, 41600
v_mfma_f32_16x16x32_bf16 v[184:187], a[192:195], a[240:243], v[184:187]
buffer_load_dwordx4 v6, s[28:31], s54 offen  lds
ds_read_b128 a[40:43], v253 offset:512
v_mfma_f32_16x16x32_bf16 v[184:187], a[196:199], a[244:247], v[184:187]
v_mfma_f32_16x16x32_bf16 v[200:203], a[192:195], a[248:251], v[200:203]
ds_read_b128 a[44:47], v253 offset:528
v_mfma_f32_16x16x32_bf16 v[200:203], a[196:199], a[252:255], v[200:203]
ds_read_b128 a[48:51], v253 offset:4160
v_mfma_f32_16x16x32_bf16 v[124:127], a[200:203], a[208:211], v[124:127]
ds_read_b128 a[52:55], v253 offset:4176
s_add_u32 m0, s56, 45760
v_mfma_f32_16x16x32_bf16 v[124:127], a[204:207], a[212:215], v[124:127]
buffer_load_dwordx4 v7, s[28:31], s54 offen  lds
ds_read_b128 a[56:59], v253 offset:4672
v_mfma_f32_16x16x32_bf16 v[140:143], a[200:203], a[216:219], v[140:143]
ds_read_b128 a[60:63], v253 offset:4688
v_mfma_f32_16x16x32_bf16 v[140:143], a[204:207], a[220:223], v[140:143]
ds_read_b128 a[64:67], v253 offset:8320
v_mfma_f32_16x16x32_bf16 v[156:159], a[200:203], a[224:227], v[156:159]
ds_read_b128 a[68:71], v253 offset:8336
s_add_u32 m0, s56, 49920
v_mfma_f32_16x16x32_bf16 v[156:159], a[204:207], a[228:231], v[156:159]
buffer_load_dwordx4 v8, s[28:31], s54 offen  lds
ds_read_b128 a[72:75], v253 offset:8832
v_mfma_f32_16x16x32_bf16 v[172:175], a[200:203], a[232:235], v[172:175]
ds_read_b128 a[76:79], v253 offset:8848
v_mfma_f32_16x16x32_bf16 v[172:175], a[204:207], a[236:239], v[172:175]
v_mfma_f32_16x16x32_bf16 v[188:191], a[200:203], a[240:243], v[188:191]
v_mfma_f32_16x16x32_bf16 v[188:191], a[204:207], a[244:247], v[188:191]
s_add_u32 m0, s56, 54080
v_mfma_f32_16x16x32_bf16 v[204:207], a[200:203], a[248:251], v[204:207]
buffer_load_dwordx4 v9, s[28:31], s54 offen  lds
v_mfma_f32_16x16x32_bf16 v[204:207], a[204:207], a[252:255], v[204:207]
s_waitcnt lgkmcnt(0)
v_mfma_f32_16x16x32_bf16 v[112:115], a[0:3], a[32:35], v[112:115]
v_mfma_f32_16x16x32_bf16 v[112:115], a[4:7], a[36:39], v[112:115]
s_add_u32 m0, s56, 58240
v_mfma_f32_16x16x32_bf16 v[128:131], a[0:3], a[40:43], v[128:131]
buffer_load_dwordx4 v10, s[28:31], s54 offen  lds
v_mfma_f32_16x16x32_bf16 v[128:131], a[4:7], a[44:47], v[128:131]
v_mfma_f32_16x16x32_bf16 v[144:147], a[0:3], a[48:51], v[144:147]
v_mfma_f32_16x16x32_bf16 v[144:147], a[4:7], a[52:55], v[144:147]
v_mfma_f32_16x16x32_bf16 v[160:163], a[0:3], a[56:59], v[160:163]
s_add_u32 m0, s56, 62400
v_mfma_f32_16x16x32_bf16 v[160:163], a[4:7], a[60:63], v[160:163]
buffer_load_dwordx4 v11, s[28:31], s54 offen  lds
s_add_u32 s58, s49, 128
s_and_b32 s58, s58, 511
s_or_b32 s58, s58, 512
s_or_b32 s54, s58, s59
s_lshl_b32 s55, s58, 12
s_or_b32 s55, s55, s46
v_mfma_f32_16x16x32_bf16 v[176:179], a[0:3], a[64:67], v[176:179]
v_mfma_f32_16x16x32_bf16 v[176:179], a[4:7], a[68:71], v[176:179]
v_mfma_f32_16x16x32_bf16 v[192:195], a[0:3], a[72:75], v[192:195]
v_mfma_f32_16x16x32_bf16 v[192:195], a[4:7], a[76:79], v[192:195]
v_mfma_f32_16x16x32_bf16 v[116:119], a[8:11], a[32:35], v[116:119]
s_waitcnt vmcnt(10)
s_barrier
v_mfma_f32_16x16x32_bf16 v[116:119], a[12:15], a[36:39], v[116:119]
ds_read_b64_tr_b16 a[176:177], v254 offset:0
s_add_u32 m0, s57, 142208
v_mfma_f32_16x16x32_bf16 v[132:135], a[8:11], a[40:43], v[132:135]
buffer_load_dwordx4 v12, s[32:35], s55 offen  lds
ds_read_b64_tr_b16 a[178:179], v254 offset:256
v_mfma_f32_16x16x32_bf16 v[132:135], a[12:15], a[44:47], v[132:135]
ds_read_b64_tr_b16 a[180:181], v254 offset:512
v_mfma_f32_16x16x32_bf16 v[148:151], a[8:11], a[48:51], v[148:151]
ds_read_b64_tr_b16 a[182:183], v254 offset:768
v_mfma_f32_16x16x32_bf16 v[148:151], a[12:15], a[52:55], v[148:151]
ds_read_b64_tr_b16 a[184:185], v254 offset:32
s_add_u32 m0, s57, 146432
v_mfma_f32_16x16x32_bf16 v[164:167], a[8:11], a[56:59], v[164:167]
buffer_load_dwordx4 v13, s[32:35], s55 offen  lds
ds_read_b64_tr_b16 a[186:187], v254 offset:288
v_mfma_f32_16x16x32_bf16 v[164:167], a[12:15], a[60:63], v[164:167]
ds_read_b64_tr_b16 a[188:189], v254 offset:544
v_mfma_f32_16x16x32_bf16 v[180:183], a[8:11], a[64:67], v[180:183]
ds_read_b64_tr_b16 a[190:191], v254 offset:800
v_mfma_f32_16x16x32_bf16 v[180:183], a[12:15], a[68:71], v[180:183]
ds_read_b64_tr_b16 a[192:193], v254 offset:64
v_mfma_f32_16x16x32_bf16 v[196:199], a[8:11], a[72:75], v[196:199]
ds_read_b64_tr_b16 a[194:195], v254 offset:320
s_add_u32 m0, s57, 150656
v_mfma_f32_16x16x32_bf16 v[196:199], a[12:15], a[76:79], v[196:199]
buffer_load_dwordx4 v14, s[32:35], s55 offen  lds
v_mfma_f32_16x16x32_bf16 v[120:123], a[16:19], a[32:35], v[120:123]
ds_read_b64_tr_b16 a[196:197], v254 offset:576
v_mfma_f32_16x16x32_bf16 v[120:123], a[20:23], a[36:39], v[120:123]
ds_read_b64_tr_b16 a[198:199], v254 offset:832
v_mfma_f32_16x16x32_bf16 v[136:139], a[16:19], a[40:43], v[136:139]
ds_read_b64_tr_b16 a[200:201], v254 offset:96
s_add_u32 m0, s57, 154880
v_mfma_f32_16x16x32_bf16 v[136:139], a[20:23], a[44:47], v[136:139]
buffer_load_dwordx4 v15, s[32:35], s55 offen  lds
ds_read_b64_tr_b16 a[202:203], v254 offset:352
v_mfma_f32_16x16x32_bf16 v[152:155], a[16:19], a[48:51], v[152:155]
ds_read_b64_tr_b16 a[204:205], v254 offset:608
v_mfma_f32_16x16x32_bf16 v[152:155], a[20:23], a[52:55], v[152:155]
ds_read_b64_tr_b16 a[206:207], v254 offset:864
v_mfma_f32_16x16x32_bf16 v[168:171], a[16:19], a[56:59], v[168:171]
ds_read_b128 a[208:211], v252 offset:0
v_mfma_f32_16x16x32_bf16 v[168:171], a[20:23], a[60:63], v[168:171]
ds_read_b128 a[212:215], v252 offset:16
s_add_u32 m0, s56, 83456
v_mfma_f32_16x16x32_bf16 v[184:187], a[16:19], a[64:67], v[184:187]
buffer_load_dwordx4 v6, s[28:31], s54 offen  lds
ds_read_b128 a[216:219], v252 offset:512
v_mfma_f32_16x16x32_bf16 v[184:187], a[20:23], a[68:71], v[184:187]
v_mfma_f32_16x16x32_bf16 v[200:203], a[16:19], a[72:75], v[200:203]
ds_read_b128 a[220:223], v252 offset:528
v_mfma_f32_16x16x32_bf16 v[200:203], a[20:23], a[76:79], v[200:203]
ds_read_b128 a[224:227], v252 offset:4160
v_mfma_f32_16x16x32_bf16 v[124:127], a[24:27], a[32:35], v[124:127]
ds_read_b128 a[228:231], v252 offset:4176
s_add_u32 m0, s56, 87616
v_mfma_f32_16x16x32_bf16 v[124:127], a[28:31], a[36:39], v[124:127]
buffer_load_dwordx4 v7, s[28:31], s54 offen  lds
ds_read_b128 a[232:235], v252 offset:4672
v_mfma_f32_16x16x32_bf16 v[140:143], a[24:27], a[40:43], v[140:143]
ds_read_b128 a[236:239], v252 offset:4688
v_mfma_f32_16x16x32_bf16 v[140:143], a[28:31], a[44:47], v[140:143]
ds_read_b128 a[240:243], v252 offset:8320
v_mfma_f32_16x16x32_bf16 v[156:159], a[24:27], a[48:51], v[156:159]
ds_read_b128 a[244:247], v252 offset:8336
s_add_u32 m0, s56, 91776
v_mfma_f32_16x16x32_bf16 v[156:159], a[28:31], a[52:55], v[156:159]
buffer_load_dwordx4 v8, s[28:31], s54 offen  lds
ds_read_b128 a[248:251], v252 offset:8832
v_mfma_f32_16x16x32_bf16 v[172:175], a[24:27], a[56:59], v[172:175]
ds_read_b128 a[252:255], v252 offset:8848
v_mfma_f32_16x16x32_bf16 v[172:175], a[28:31], a[60:63], v[172:175]
v_mfma_f32_16x16x32_bf16 v[188:191], a[24:27], a[64:67], v[188:191]
v_mfma_f32_16x16x32_bf16 v[188:191], a[28:31], a[68:71], v[188:191]
s_add_u32 m0, s56, 95936
v_mfma_f32_16x16x32_bf16 v[204:207], a[24:27], a[72:75], v[204:207]
buffer_load_dwordx4 v9, s[28:31], s54 offen  lds
v_mfma_f32_16x16x32_bf16 v[204:207], a[28:31], a[76:79], v[204:207]
s_waitcnt lgkmcnt(0)
v_mfma_f32_16x16x32_bf16 v[112:115], a[176:179], a[208:211], v[112:115]
v_mfma_f32_16x16x32_bf16 v[112:115], a[180:183], a[212:215], v[112:115]
s_add_u32 m0, s56, 100096
v_mfma_f32_16x16x32_bf16 v[128:131], a[176:179], a[216:219], v[128:131]
buffer_load_dwordx4 v10, s[28:31], s54 offen  lds
v_mfma_f32_16x16x32_bf16 v[128:131], a[180:183], a[220:223], v[128:131]
v_mfma_f32_16x16x32_bf16 v[144:147], a[176:179], a[224:227], v[144:147]
v_mfma_f32_16x16x32_bf16 v[144:147], a[180:183], a[228:231], v[144:147]
v_mfma_f32_16x16x32_bf16 v[160:163], a[176:179], a[232:235], v[160:163]
s_add_u32 m0, s56, 104256
v_mfma_f32_16x16x32_bf16 v[160:163], a[180:183], a[236:239], v[160:163]
buffer_load_dwordx4 v11, s[28:31], s54 offen  lds
s_add_u32 s58, s49, 256
s_and_b32 s58, s58, 511
s_or_b32 s58, s58, 512
s_or_b32 s54, s58, s59
s_lshl_b32 s55, s58, 12
s_or_b32 s55, s55, s46
v_mfma_f32_16x16x32_bf16 v[176:179], a[176:179], a[240:243], v[176:179]
v_mfma_f32_16x16x32_bf16 v[176:179], a[180:183], a[244:247], v[176:179]
v_mfma_f32_16x16x32_bf16 v[192:195], a[176:179], a[248:251], v[192:195]
v_mfma_f32_16x16x32_bf16 v[192:195], a[180:183], a[252:255], v[192:195]
v_mfma_f32_16x16x32_bf16 v[116:119], a[184:187], a[208:211], v[116:119]
s_waitcnt vmcnt(10)
s_barrier
v_mfma_f32_16x16x32_bf16 v[116:119], a[188:191], a[212:215], v[116:119]
ds_read_b64_tr_b16 a[0:1], v254 offset:16896
s_add_u32 m0, s57, 108416
v_mfma_f32_16x16x32_bf16 v[132:135], a[184:187], a[216:219], v[132:135]
buffer_load_dwordx4 v12, s[32:35], s55 offen  lds
ds_read_b64_tr_b16 a[2:3], v254 offset:17152
v_mfma_f32_16x16x32_bf16 v[132:135], a[188:191], a[220:223], v[132:135]
ds_read_b64_tr_b16 a[4:5], v254 offset:17408
v_mfma_f32_16x16x32_bf16 v[148:151], a[184:187], a[224:227], v[148:151]
ds_read_b64_tr_b16 a[6:7], v254 offset:17664
v_mfma_f32_16x16x32_bf16 v[148:151], a[188:191], a[228:231], v[148:151]
ds_read_b64_tr_b16 a[8:9], v254 offset:16928
s_add_u32 m0, s57, 112640
v_mfma_f32_16x16x32_bf16 v[164:167], a[184:187], a[232:235], v[164:167]
buffer_load_dwordx4 v13, s[32:35], s55 offen  lds
ds_read_b64_tr_b16 a[10:11], v254 offset:17184
v_mfma_f32_16x16x32_bf16 v[164:167], a[188:191], a[236:239], v[164:167]
ds_read_b64_tr_b16 a[12:13], v254 offset:17440
v_mfma_f32_16x16x32_bf16 v[180:183], a[184:187], a[240:243], v[180:183]
ds_read_b64_tr_b16 a[14:15], v254 offset:17696
v_mfma_f32_16x16x32_bf16 v[180:183], a[188:191], a[244:247], v[180:183]
ds_read_b64_tr_b16 a[16:17], v254 offset:16960
v_mfma_f32_16x16x32_bf16 v[196:199], a[184:187], a[248:251], v[196:199]
ds_read_b64_tr_b16 a[18:19], v254 offset:17216
s_add_u32 m0, s57, 116864
v_mfma_f32_16x16x32_bf16 v[196:199], a[188:191], a[252:255], v[196:199]
buffer_load_dwordx4 v14, s[32:35], s55 offen  lds
v_mfma_f32_16x16x32_bf16 v[120:123], a[192:195], a[208:211], v[120:123]
ds_read_b64_tr_b16 a[20:21], v254 offset:17472
v_mfma_f32_16x16x32_bf16 v[120:123], a[196:199], a[212:215], v[120:123]
ds_read_b64_tr_b16 a[22:23], v254 offset:17728
v_mfma_f32_16x16x32_bf16 v[136:139], a[192:195], a[216:219], v[136:139]
ds_read_b64_tr_b16 a[24:25], v254 offset:16992
s_add_u32 m0, s57, 121088
v_mfma_f32_16x16x32_bf16 v[136:139], a[196:199], a[220:223], v[136:139]
buffer_load_dwordx4 v15, s[32:35], s55 offen  lds
ds_read_b64_tr_b16 a[26:27], v254 offset:17248
v_mfma_f32_16x16x32_bf16 v[152:155], a[192:195], a[224:227], v[152:155]
ds_read_b64_tr_b16 a[28:29], v254 offset:17504
v_mfma_f32_16x16x32_bf16 v[152:155], a[196:199], a[228:231], v[152:155]
ds_read_b64_tr_b16 a[30:31], v254 offset:17760
v_mfma_f32_16x16x32_bf16 v[168:171], a[192:195], a[232:235], v[168:171]
ds_read_b128 a[32:35], v252 offset:24960
v_mfma_f32_16x16x32_bf16 v[168:171], a[196:199], a[236:239], v[168:171]
ds_read_b128 a[36:39], v252 offset:24976
s_add_u32 m0, s56, 16640
v_mfma_f32_16x16x32_bf16 v[184:187], a[192:195], a[240:243], v[184:187]
buffer_load_dwordx4 v6, s[28:31], s54 offen  lds
ds_read_b128 a[40:43], v252 offset:25472
v_mfma_f32_16x16x32_bf16 v[184:187], a[196:199], a[244:247], v[184:187]
v_mfma_f32_16x16x32_bf16 v[200:203], a[192:195], a[248:251], v[200:203]
ds_read_b128 a[44:47], v252 offset:25488
v_mfma_f32_16x16x32_bf16 v[200:203], a[196:199], a[252:255], v[200:203]
ds_read_b128 a[48:51], v252 offset:29120
v_mfma_f32_16x16x32_bf16 v[124:127], a[200:203], a[208:211], v[124:127]
ds_read_b128 a[52:55], v252 offset:29136
s_add_u32 m0, s56, 20800
v_mfma_f32_16x16x32_bf16 v[124:127], a[204:207], a[212:215], v[124:127]
buffer_load_dwordx4 v7, s[28:31], s54 offen  lds
ds_read_b128 a[56:59], v252 offset:29632
v_mfma_f32_16x16x32_bf16 v[140:143], a[200:203], a[216:219], v[140:143]
ds_read_b128 a[60:63], v252 offset:29648
v_mfma_f32_16x16x32_bf16 v[140:143], a[204:207], a[220:223], v[140:143]
ds_read_b128 a[64:67], v252 offset:33280
v_mfma_f32_16x16x32_bf16 v[156:159], a[200:203], a[224:227], v[156:159]
ds_read_b128 a[68:71], v252 offset:33296
s_add_u32 m0, s56, 24960
v_mfma_f32_16x16x32_bf16 v[156:159], a[204:207], a[228:231], v[156:159]
buffer_load_dwordx4 v8, s[28:31], s54 offen  lds
ds_read_b128 a[72:75], v252 offset:33792
v_mfma_f32_16x16x32_bf16 v[172:175], a[200:203], a[232:235], v[172:175]
ds_read_b128 a[76:79], v252 offset:33808
v_mfma_f32_16x16x32_bf16 v[172:175], a[204:207], a[236:239], v[172:175]
v_mfma_f32_16x16x32_bf16 v[188:191], a[200:203], a[240:243], v[188:191]
v_mfma_f32_16x16x32_bf16 v[188:191], a[204:207], a[244:247], v[188:191]
s_add_u32 m0, s56, 29120
v_mfma_f32_16x16x32_bf16 v[204:207], a[200:203], a[248:251], v[204:207]
buffer_load_dwordx4 v9, s[28:31], s54 offen  lds
v_mfma_f32_16x16x32_bf16 v[204:207], a[204:207], a[252:255], v[204:207]
s_waitcnt lgkmcnt(0)
v_mfma_f32_16x16x32_bf16 v[112:115], a[0:3], a[32:35], v[112:115]
v_mfma_f32_16x16x32_bf16 v[112:115], a[4:7], a[36:39], v[112:115]
s_add_u32 m0, s56, 33280
v_mfma_f32_16x16x32_bf16 v[128:131], a[0:3], a[40:43], v[128:131]
buffer_load_dwordx4 v10, s[28:31], s54 offen  lds
v_mfma_f32_16x16x32_bf16 v[128:131], a[4:7], a[44:47], v[128:131]
v_mfma_f32_16x16x32_bf16 v[144:147], a[0:3], a[48:51], v[144:147]
v_mfma_f32_16x16x32_bf16 v[144:147], a[4:7], a[52:55], v[144:147]
v_mfma_f32_16x16x32_bf16 v[160:163], a[0:3], a[56:59], v[160:163]
s_add_u32 m0, s56, 37440
v_mfma_f32_16x16x32_bf16 v[160:163], a[4:7], a[60:63], v[160:163]
buffer_load_dwordx4 v11, s[28:31], s54 offen  lds
s_add_u32 s58, s49, 384
s_and_b32 s58, s58, 511
s_or_b32 s58, s58, 512
s_or_b32 s54, s58, s59
s_lshl_b32 s55, s58, 12
s_or_b32 s55, s55, s46
v_mfma_f32_16x16x32_bf16 v[176:179], a[0:3], a[64:67], v[176:179]
v_mfma_f32_16x16x32_bf16 v[176:179], a[4:7], a[68:71], v[176:179]
v_mfma_f32_16x16x32_bf16 v[192:195], a[0:3], a[72:75], v[192:195]
v_mfma_f32_16x16x32_bf16 v[192:195], a[4:7], a[76:79], v[192:195]
v_mfma_f32_16x16x32_bf16 v[116:119], a[8:11], a[32:35], v[116:119]
s_waitcnt vmcnt(10)
s_barrier
v_mfma_f32_16x16x32_bf16 v[116:119], a[12:15], a[36:39], v[116:119]
ds_read_b64_tr_b16 a[176:177], v254 offset:33792
s_add_u32 m0, s47, 0
v_mfma_f32_16x16x32_bf16 v[132:135], a[8:11], a[40:43], v[132:135]
buffer_load_dwordx4 v1, s[20:23], s45 offen offset:0 nt lds
ds_read_b64_tr_b16 a[178:179], v254 offset:34048
v_mfma_f32_16x16x32_bf16 v[132:135], a[12:15], a[44:47], v[132:135]
ds_read_b64_tr_b16 a[180:181], v254 offset:34304
s_add_u32 m0, s47, 16
v_mfma_f32_16x16x32_bf16 v[148:151], a[8:11], a[48:51], v[148:151]
buffer_load_dwordx4 v1, s[20:23], s45 offen offset:1024 nt lds
ds_read_b64_tr_b16 a[182:183], v254 offset:34560
v_mfma_f32_16x16x32_bf16 v[148:151], a[12:15], a[52:55], v[148:151]
ds_read_b64_tr_b16 a[184:185], v254 offset:33824
s_add_u32 m0, s47, 32
v_mfma_f32_16x16x32_bf16 v[164:167], a[8:11], a[56:59], v[164:167]
buffer_load_dwordx4 v1, s[20:23], s45 offen offset:2048 nt lds
ds_read_b64_tr_b16 a[186:187], v254 offset:34080
v_mfma_f32_16x16x32_bf16 v[164:167], a[12:15], a[60:63], v[164:167]
ds_read_b64_tr_b16 a[188:189], v254 offset:34336
s_add_u32 m0, s47, 48
v_mfma_f32_16x16x32_bf16 v[180:183], a[8:11], a[64:67], v[180:183]
buffer_load_dwordx4 v1, s[20:23], s45 offen offset:3072 nt lds
ds_read_b64_tr_b16 a[190:191], v254 offset:34592
v_mfma_f32_16x16x32_bf16 v[180:183], a[12:15], a[68:71], v[180:183]
ds_read_b64_tr_b16 a[192:193], v254 offset:33856
s_add_u32 m0, s57, 125312
v_mfma_f32_16x16x32_bf16 v[196:199], a[8:11], a[72:75], v[196:199]
buffer_load_dwordx4 v12, s[32:35], s55 offen  lds
ds_read_b64_tr_b16 a[194:195], v254 offset:34112
v_mfma_f32_16x16x32_bf16 v[196:199], a[12:15], a[76:79], v[196:199]
v_mfma_f32_16x16x32_bf16 v[120:123], a[16:19], a[32:35], v[120:123]
ds_read_b64_tr_b16 a[196:197], v254 offset:34368
s_add_u32 m0, s57, 129536
v_mfma_f32_16x16x32_bf16 v[120:123], a[20:23], a[36:39], v[120:123]
buffer_load_dwordx4 v13, s[32:35], s55 offen  lds
ds_read_b64_tr_b16 a[198:199], v254 offset:34624
v_mfma_f32_16x16x32_bf16 v[136:139], a[16:19], a[40:43], v[136:139]
ds_read_b64_tr_b16 a[200:201], v254 offset:33888
v_mfma_f32_16x16x32_bf16 v[136:139], a[20:23], a[44:47], v[136:139]
ds_read_b64_tr_b16 a[202:203], v254 offset:34144
v_mfma_f32_16x16x32_bf16 v[152:155], a[16:19], a[48:51], v[152:155]
ds_read_b64_tr_b16 a[204:205], v254 offset:34400
s_add_u32 m0, s57, 133760
v_mfma_f32_16x16x32_bf16 v[152:155], a[20:23], a[52:55], v[152:155]
buffer_load_dwordx4 v14, s[32:35], s55 offen  lds
ds_read_b64_tr_b16 a[206:207], v254 offset:34656
v_mfma_f32_16x16x32_bf16 v[168:171], a[16:19], a[56:59], v[168:171]
ds_read_b128 a[208:211], v253 offset:0
v_mfma_f32_16x16x32_bf16 v[168:171], a[20:23], a[60:63], v[168:171]
ds_read_b128 a[212:215], v253 offset:16
v_mfma_f32_16x16x32_bf16 v[184:187], a[16:19], a[64:67], v[184:187]
ds_read_b128 a[216:219], v253 offset:512
s_add_u32 m0, s57, 137984
v_mfma_f32_16x16x32_bf16 v[184:187], a[20:23], a[68:71], v[184:187]
buffer_load_dwordx4 v15, s[32:35], s55 offen  lds
v_mfma_f32_16x16x32_bf16 v[200:203], a[16:19], a[72:75], v[200:203]
ds_read_b128 a[220:223], v253 offset:528
v_mfma_f32_16x16x32_bf16 v[200:203], a[20:23], a[76:79], v[200:203]
ds_read_b128 a[224:227], v253 offset:4160
v_mfma_f32_16x16x32_bf16 v[124:127], a[24:27], a[32:35], v[124:127]
ds_read_b128 a[228:231], v253 offset:4176
s_add_u32 m0, s56, 41600
v_mfma_f32_16x16x32_bf16 v[124:127], a[28:31], a[36:39], v[124:127]
buffer_load_dwordx4 v6, s[28:31], s54 offen  lds
ds_read_b128 a[232:235], v253 offset:4672
v_mfma_f32_16x16x32_bf16 v[140:143], a[24:27], a[40:43], v[140:143]
ds_read_b128 a[236:239], v253 offset:4688
v_mfma_f32_16x16x32_bf16 v[140:143], a[28:31], a[44:47], v[140:143]
ds_read_b128 a[240:243], v253 offset:8320
v_mfma_f32_16x16x32_bf16 v[156:159], a[24:27], a[48:51], v[156:159]
ds_read_b128 a[244:247], v253 offset:8336
s_add_u32 m0, s56, 45760
v_mfma_f32_16x16x32_bf16 v[156:159], a[28:31], a[52:55], v[156:159]
buffer_load_dwordx4 v7, s[28:31], s54 offen  lds
ds_read_b128 a[248:251], v253 offset:8832
v_mfma_f32_16x16x32_bf16 v[172:175], a[24:27], a[56:59], v[172:175]
ds_read_b128 a[252:255], v253 offset:8848
v_mfma_f32_16x16x32_bf16 v[172:175], a[28:31], a[60:63], v[172:175]
s_add_u32 m0, s56, 49920
v_mfma_f32_16x16x32_bf16 v[188:191], a[24:27], a[64:67], v[188:191]
buffer_load_dwordx4 v8, s[28:31], s54 offen  lds
v_mfma_f32_16x16x32_bf16 v[188:191], a[28:31], a[68:71], v[188:191]
v_mfma_f32_16x16x32_bf16 v[204:207], a[24:27], a[72:75], v[204:207]
v_mfma_f32_16x16x32_bf16 v[204:207], a[28:31], a[76:79], v[204:207]
s_add_u32 m0, s56, 54080
s_waitcnt lgkmcnt(0)
v_mfma_f32_16x16x32_bf16 v[112:115], a[176:179], a[208:211], v[112:115]
buffer_load_dwordx4 v9, s[28:31], s54 offen  lds
v_mfma_f32_16x16x32_bf16 v[112:115], a[180:183], a[212:215], v[112:115]
v_mfma_f32_16x16x32_bf16 v[128:131], a[176:179], a[216:219], v[128:131]
v_mfma_f32_16x16x32_bf16 v[128:131], a[180:183], a[220:223], v[128:131]
s_add_u32 m0, s56, 58240
v_mfma_f32_16x16x32_bf16 v[144:147], a[176:179], a[224:227], v[144:147]
buffer_load_dwordx4 v10, s[28:31], s54 offen  lds
v_mfma_f32_16x16x32_bf16 v[144:147], a[180:183], a[228:231], v[144:147]
v_mfma_f32_16x16x32_bf16 v[160:163], a[176:179], a[232:235], v[160:163]
v_mfma_f32_16x16x32_bf16 v[160:163], a[180:183], a[236:239], v[160:163]
s_add_u32 m0, s56, 62400
v_mfma_f32_16x16x32_bf16 v[176:179], a[176:179], a[240:243], v[176:179]
buffer_load_dwordx4 v11, s[28:31], s54 offen  lds
v_mfma_f32_16x16x32_bf16 v[176:179], a[180:183], a[244:247], v[176:179]
v_mfma_f32_16x16x32_bf16 v[192:195], a[176:179], a[248:251], v[192:195]
v_mfma_f32_16x16x32_bf16 v[192:195], a[180:183], a[252:255], v[192:195]
v_mfma_f32_16x16x32_bf16 v[116:119], a[184:187], a[208:211], v[116:119]
s_waitcnt vmcnt(14)
s_barrier
v_mfma_f32_16x16x32_bf16 v[116:119], a[188:191], a[212:215], v[116:119]
ds_read_b64_tr_b16 a[0:1], v254 offset:0
s_add_u32 m0, s48, 0
v_mfma_f32_16x16x32_bf16 v[132:135], a[184:187], a[216:219], v[132:135]
buffer_load_dwordx4 v1, s[24:27], s45 offen offset:0 nt lds
ds_read_b64_tr_b16 a[2:3], v254 offset:256
v_mfma_f32_16x16x32_bf16 v[132:135], a[188:191], a[220:223], v[132:135]
ds_read_b64_tr_b16 a[4:5], v254 offset:512
s_bfe_u32 s52, s2, 0x10001
v_mfma_f32_16x16x32_bf16 v[148:151], a[184:187], a[224:227], v[148:151]
ds_read_b64_tr_b16 a[6:7], v254 offset:768
s_bfe_u32 s53, s2, 0x10002
v_mfma_f32_16x16x32_bf16 v[148:151], a[188:191], a[228:231], v[148:151]
ds_read_b64_tr_b16 a[8:9], v254 offset:32
s_add_u32 m0, s48, 32
v_mfma_f32_16x16x32_bf16 v[164:167], a[184:187], a[232:235], v[164:167]
buffer_load_dwordx4 v1, s[24:27], s45 offen offset:1024 nt lds
ds_read_b64_tr_b16 a[10:11], v254 offset:288
v_mfma_f32_16x16x32_bf16 v[164:167], a[188:191], a[236:239], v[164:167]
ds_read_b64_tr_b16 a[12:13], v254 offset:544
s_lshr_b32 s54, s2, 5
v_mfma_f32_16x16x32_bf16 v[180:183], a[184:187], a[240:243], v[180:183]
ds_read_b64_tr_b16 a[14:15], v254 offset:800
s_lshl_b32 s50, s54, 7
v_mfma_f32_16x16x32_bf16 v[180:183], a[188:191], a[244:247], v[180:183]
ds_read_b64_tr_b16 a[16:17], v254 offset:64
s_add_u32 m0, s48, 64
v_mfma_f32_16x16x32_bf16 v[196:199], a[184:187], a[248:251], v[196:199]
buffer_load_dwordx4 v1, s[24:27], s45 offen offset:2048 nt lds
ds_read_b64_tr_b16 a[18:19], v254 offset:320
v_mfma_f32_16x16x32_bf16 v[196:199], a[188:191], a[252:255], v[196:199]
s_lshl_b32 s51, s40, 19
s_add_u32 s50, s50, s51
v_mfma_f32_16x16x32_bf16 v[120:123], a[192:195], a[208:211], v[120:123]
ds_read_b64_tr_b16 a[20:21], v254 offset:576
s_lshl_b32 s51, s53, 21
v_mfma_f32_16x16x32_bf16 v[120:123], a[196:199], a[212:215], v[120:123]
ds_read_b64_tr_b16 a[22:23], v254 offset:832
s_add_u32 m0, s48, 96
v_mfma_f32_16x16x32_bf16 v[136:139], a[192:195], a[216:219], v[136:139]
buffer_load_dwordx4 v1, s[24:27], s45 offen offset:3072 nt lds
ds_read_b64_tr_b16 a[24:25], v254 offset:96
s_add_u32 s45, s45, 16384
v_mfma_f32_16x16x32_bf16 v[136:139], a[196:199], a[220:223], v[136:139]
ds_read_b64_tr_b16 a[26:27], v254 offset:352
s_add_u32 s50, s50, s51
v_mfma_f32_16x16x32_bf16 v[152:155], a[192:195], a[224:227], v[152:155]
ds_read_b64_tr_b16 a[28:29], v254 offset:608
s_add_u32 s28, s12, s50
s_addc_u32 s29, s13, 0
v_mfma_f32_16x16x32_bf16 v[152:155], a[196:199], a[228:231], v[152:155]
ds_read_b64_tr_b16 a[30:31], v254 offset:864
s_add_u32 m0, s48, 16896
v_mfma_f32_16x16x32_bf16 v[168:171], a[192:195], a[232:235], v[168:171]
buffer_load_dwordx4 v1, s[24:27], s45 offen offset:0 nt lds
ds_read_b128 a[32:35], v252 offset:0
v_mfma_f32_16x16x32_bf16 v[168:171], a[196:199], a[236:239], v[168:171]
ds_read_b128 a[36:39], v252 offset:16
s_sub_u32 s30, 4194304, s50
v_mfma_f32_16x16x32_bf16 v[184:187], a[192:195], a[240:243], v[184:187]
ds_read_b128 a[40:43], v252 offset:512
s_mov_b32 s31, 0x20000
v_mfma_f32_16x16x32_bf16 v[184:187], a[196:199], a[244:247], v[184:187]
s_add_u32 m0, s48, 16928
s_mul_i32 s50, s43, 12
v_mfma_f32_16x16x32_bf16 v[200:203], a[192:195], a[248:251], v[200:203]
buffer_load_dwordx4 v1, s[24:27], s45 offen offset:1024 nt lds
ds_read_b128 a[44:47], v252 offset:528
v_mfma_f32_16x16x32_bf16 v[200:203], a[196:199], a[252:255], v[200:203]
ds_read_b128 a[48:51], v252 offset:4160
s_mul_i32 s51, s52, 6
v_mfma_f32_16x16x32_bf16 v[124:127], a[200:203], a[208:211], v[124:127]
ds_read_b128 a[52:55], v252 offset:4176
s_add_u32 s50, s50, s51
v_mfma_f32_16x16x32_bf16 v[124:127], a[204:207], a[212:215], v[124:127]
ds_read_b128 a[56:59], v252 offset:4672
s_add_u32 m0, s48, 16960
v_mfma_f32_16x16x32_bf16 v[140:143], a[200:203], a[216:219], v[140:143]
buffer_load_dwordx4 v1, s[24:27], s45 offen offset:2048 nt lds
ds_read_b128 a[60:63], v252 offset:4688
v_mfma_f32_16x16x32_bf16 v[140:143], a[204:207], a[220:223], v[140:143]
ds_read_b128 a[64:67], v252 offset:8320
s_lshl_b32 s50, s50, 17
v_mfma_f32_16x16x32_bf16 v[156:159], a[200:203], a[224:227], v[156:159]
ds_read_b128 a[68:71], v252 offset:8336
s_lshl_b32 s51, s53, 16
v_mfma_f32_16x16x32_bf16 v[156:159], a[204:207], a[228:231], v[156:159]
ds_read_b128 a[72:75], v252 offset:8832
s_add_u32 m0, s48, 16992
v_mfma_f32_16x16x32_bf16 v[172:175], a[200:203], a[232:235], v[172:175]
buffer_load_dwordx4 v1, s[24:27], s45 offen offset:3072 nt lds
ds_read_b128 a[76:79], v252 offset:8848
v_mfma_f32_16x16x32_bf16 v[172:175], a[204:207], a[236:239], v[172:175]
s_add_u32 s50, s50, s51
s_lshl_b32 s51, s40, 14
v_mfma_f32_16x16x32_bf16 v[188:191], a[200:203], a[240:243], v[188:191]
s_add_u32 s50, s50, s51
s_add_u32 s32, s18, s50
s_addc_u32 s33, s19, 0
v_mfma_f32_16x16x32_bf16 v[188:191], a[204:207], a[244:247], v[188:191]
s_sub_u32 s34, 12582912, s50
s_mov_b32 s35, 0x20000
v_mfma_f32_16x16x32_bf16 v[204:207], a[200:203], a[248:251], v[204:207]
s_mul_i32 s50, s43, 192
s_mul_i32 s51, s52, 96
v_mfma_f32_16x16x32_bf16 v[204:207], a[204:207], a[252:255], v[204:207]
s_waitcnt vmcnt(8)
s_barrier
s_add_u32 s50, s50, s51
s_waitcnt lgkmcnt(0)
v_mfma_f32_16x16x32_bf16 v[112:115], a[0:3], a[32:35], v[112:115]
ds_read_b64_tr_b16 a[176:177], v254 offset:16896
ds_read_b64_tr_b16 a[178:179], v254 offset:17152
v_mfma_f32_16x16x32_bf16 v[112:115], a[4:7], a[36:39], v[112:115]
ds_read_b64_tr_b16 a[180:181], v254 offset:17408
ds_read_b64_tr_b16 a[182:183], v254 offset:17664
v_mfma_f32_16x16x32_bf16 v[116:119], a[8:11], a[32:35], v[116:119]
ds_read_b64_tr_b16 a[184:185], v254 offset:16928
ds_read_b64_tr_b16 a[186:187], v254 offset:17184
v_mfma_f32_16x16x32_bf16 v[116:119], a[12:15], a[36:39], v[116:119]
ds_read_b64_tr_b16 a[188:189], v254 offset:17440
ds_read_b64_tr_b16 a[190:191], v254 offset:17696
v_mfma_f32_16x16x32_bf16 v[120:123], a[16:19], a[32:35], v[120:123]
ds_read_b64_tr_b16 a[192:193], v254 offset:16960
ds_read_b64_tr_b16 a[194:195], v254 offset:17216
v_mfma_f32_16x16x32_bf16 v[120:123], a[20:23], a[36:39], v[120:123]
ds_read_b64_tr_b16 a[196:197], v254 offset:17472
ds_read_b64_tr_b16 a[198:199], v254 offset:17728
v_mfma_f32_16x16x32_bf16 v[124:127], a[24:27], a[32:35], v[124:127]
ds_read_b64_tr_b16 a[200:201], v254 offset:16992
ds_read_b64_tr_b16 a[202:203], v254 offset:17248
v_mfma_f32_16x16x32_bf16 v[124:127], a[28:31], a[36:39], v[124:127]
ds_read_b64_tr_b16 a[204:205], v254 offset:17504
ds_read_b64_tr_b16 a[206:207], v254 offset:17760
v_mfma_f32_16x16x32_bf16 v[128:131], a[0:3], a[40:43], v[128:131]
ds_read_b128 a[208:211], v252 offset:24960
ds_read_b128 a[212:215], v252 offset:24976
v_mfma_f32_16x16x32_bf16 v[128:131], a[4:7], a[44:47], v[128:131]
ds_read_b128 a[216:219], v252 offset:25472
ds_read_b128 a[220:223], v252 offset:25488
v_mfma_f32_16x16x32_bf16 v[132:135], a[8:11], a[40:43], v[132:135]
ds_read_b128 a[224:227], v252 offset:29120
ds_read_b128 a[228:231], v252 offset:29136
v_mfma_f32_16x16x32_bf16 v[132:135], a[12:15], a[44:47], v[132:135]
ds_read_b128 a[232:235], v252 offset:29632
ds_read_b128 a[236:239], v252 offset:29648
v_mfma_f32_16x16x32_bf16 v[136:139], a[16:19], a[40:43], v[136:139]
ds_read_b128 a[240:243], v252 offset:33280
ds_read_b128 a[244:247], v252 offset:33296
v_mfma_f32_16x16x32_bf16 v[136:139], a[20:23], a[44:47], v[136:139]
ds_read_b128 a[248:251], v252 offset:33792
ds_read_b128 a[252:255], v252 offset:33808
v_mfma_f32_16x16x32_bf16 v[140:143], a[24:27], a[40:43], v[140:143]
s_mul_i32 s51, s53, 48
s_add_u32 s50, s50, s51
v_mfma_f32_16x16x32_bf16 v[140:143], a[28:31], a[44:47], v[140:143]
s_waitcnt lgkmcnt(0)
s_barrier
v_mfma_f32_16x16x32_bf16 v[112:115], a[176:179], a[208:211], v[112:115]
s_lshl_b32 s50, s50, 10
s_lshl_b32 s51, s54, 7
v_mfma_f32_16x16x32_bf16 v[112:115], a[180:183], a[212:215], v[112:115]
s_add_u32 m0, s47, 16640
s_add_u32 s50, s50, s51
s_add_u32 s4, s14, s50
s_addc_u32 s5, s15, 0
s_sub_u32 s6, 1572864, s50
s_mov_b32 s7, 0x20000
s_mov_b32 s8, s16
s_mov_b32 s9, s17
s_mov_b32 s10, 256
s_mov_b32 s11, 0x20000
s_add_u32 s12, s18, 0x1000000
s_addc_u32 s13, s19, 0
s_mov_b32 s14, 3146752
s_mov_b32 s15, 0x20000
s_mul_i32 s50, s40, 3072
s_mul_i32 s16, s2, 12288
s_add_u32 s16, s16, s50
s_xor_b32 s51, s2, 4
s_mul_i32 s17, s51, 12288
s_add_u32 s17, s17, s50
s_and_b32 s50, s43, 3
s_lshl_b32 s55, s50, 17
s_lshl_b32 s56, s50, 12
s_lshl_b32 s58, s43, 7
s_add_u32 s58, s58, 3145728
s_mul_i32 s57, s53, 393216
s_mul_i32 s59, s41, 12672
s_mul_i32 s50, s42, 134144
s_add_u32 s59, s59, s50
s_mul_i32 s46, s40, 25344
s_add_u32 s46, s46, 25344
v_lshrrev_b32 v7, 3, v0
v_lshlrev_b32 v7, 12, v7
v_and_b32 v8, 7, v0
s_lshl_b32 s50, s40, 1
v_xor_b32 v8, s50, v8
v_lshl_add_u32 v6, v8, 4, v7
v_bfe_u32 v9, v0, 2, 2
v_mul_u32_u24 v9, 1056, v9
v_lshrrev_b32 v10, 4, v0
v_lshl_add_u32 v9, v10, 7, v9
v_and_b32 v10, 3, v0
v_lshl_add_u32 v9, v10, 3, v9
v_add_u32 v10, s59, v9
v_add_u32 v11, s46, v9
v_and_b32 v12, 15, v0
v_lshlrev_b32 v12, 10, v12
v_lshrrev_b32 v13, 4, v0
v_lshl_add_u32 v12, v13, 3, v12
s_lshl_b32 s50, s40, 5
v_add_u32 v12, s50, v12
v_mov_b32 v13, 0
v_mov_b32 v14, v243
v_and_b32 v15, 31, v0
v_lshlrev_b32 v15, 2, v15
s_mov_b32 s51, 0x3e0293ee
v_mfma_f32_16x16x32_bf16 v[116:119], a[184:187], a[208:211], v[116:119]
buffer_load_dwordx4 v1, s[20:23], s45 offen offset:0 nt lds
v_mfma_f32_16x16x32_bf16 v[116:119], a[188:191], a[212:215], v[116:119]
v_mfma_f32_16x16x32_bf16 v[120:123], a[192:195], a[208:211], v[120:123]
v_mfma_f32_16x16x32_bf16 v[120:123], a[196:199], a[212:215], v[120:123]
v_mul_f32 v112, s51, v112
v_mul_f32 v113, s51, v113
v_mul_f32 v114, s51, v114
v_mfma_f32_16x16x32_bf16 v[124:127], a[200:203], a[208:211], v[124:127]
v_mul_f32 v115, s51, v115
v_cvt_pk_bf16_f32 v112, v112, v113
v_cvt_pk_bf16_f32 v113, v114, v115
v_mfma_f32_16x16x32_bf16 v[124:127], a[204:207], a[212:215], v[124:127]
ds_write_b64 v255, v[112:113] offset:0
v_mul_f32 v116, s51, v116
v_mul_f32 v117, s51, v117
v_mfma_f32_16x16x32_bf16 v[128:131], a[176:179], a[216:219], v[128:131]
v_mul_f32 v118, s51, v118
v_mul_f32 v119, s51, v119
v_cvt_pk_bf16_f32 v116, v116, v117
v_mfma_f32_16x16x32_bf16 v[128:131], a[180:183], a[220:223], v[128:131]
v_cvt_pk_bf16_f32 v117, v118, v119
ds_write_b64 v255, v[116:117] offset:32
v_mul_f32 v120, s51, v120
v_mfma_f32_16x16x32_bf16 v[132:135], a[184:187], a[216:219], v[132:135]
s_add_u32 m0, s47, 16656
v_mul_f32 v121, s51, v121
v_mul_f32 v122, s51, v122
v_mfma_f32_16x16x32_bf16 v[132:135], a[188:191], a[220:223], v[132:135]
buffer_load_dwordx4 v1, s[20:23], s45 offen offset:1024 nt lds
v_mul_f32 v123, s51, v123
v_cvt_pk_bf16_f32 v120, v120, v121
v_mfma_f32_16x16x32_bf16 v[136:139], a[192:195], a[216:219], v[136:139]
v_cvt_pk_bf16_f32 v121, v122, v123
ds_write_b64 v255, v[120:121] offset:64
v_mul_f32 v124, s51, v124
v_mfma_f32_16x16x32_bf16 v[136:139], a[196:199], a[220:223], v[136:139]
v_mul_f32 v125, s51, v125
v_mul_f32 v126, s51, v126
v_mul_f32 v127, s51, v127
v_mfma_f32_16x16x32_bf16 v[140:143], a[200:203], a[216:219], v[140:143]
v_cvt_pk_bf16_f32 v124, v124, v125
v_cvt_pk_bf16_f32 v125, v126, v127
ds_write_b64 v255, v[124:125] offset:96
v_mfma_f32_16x16x32_bf16 v[140:143], a[204:207], a[220:223], v[140:143]
v_mul_f32 v128, s51, v128
v_mul_f32 v129, s51, v129
v_mul_f32 v130, s51, v130
v_mfma_f32_16x16x32_bf16 v[144:147], a[0:3], a[48:51], v[144:147]
v_mul_f32 v131, s51, v131
v_cvt_pk_bf16_f32 v128, v128, v129
v_cvt_pk_bf16_f32 v129, v130, v131
v_mfma_f32_16x16x32_bf16 v[144:147], a[4:7], a[52:55], v[144:147]
ds_write_b64 v255, v[128:129] offset:8704
v_mul_f32 v132, s51, v132
v_mul_f32 v133, s51, v133
v_mfma_f32_16x16x32_bf16 v[144:147], a[176:179], a[224:227], v[144:147]
v_mul_f32 v134, s51, v134
v_mul_f32 v135, s51, v135
v_cvt_pk_bf16_f32 v132, v132, v133
v_mfma_f32_16x16x32_bf16 v[144:147], a[180:183], a[228:231], v[144:147]
v_cvt_pk_bf16_f32 v133, v134, v135
ds_write_b64 v255, v[132:133] offset:8736
v_mul_f32 v136, s51, v136
v_mfma_f32_16x16x32_bf16 v[148:151], a[8:11], a[48:51], v[148:151]
s_add_u32 m0, s47, 16672
v_mul_f32 v137, s51, v137
v_mul_f32 v138, s51, v138
v_mfma_f32_16x16x32_bf16 v[148:151], a[12:15], a[52:55], v[148:151]
buffer_load_dwordx4 v1, s[20:23], s45 offen offset:2048 nt lds
v_mul_f32 v139, s51, v139
v_cvt_pk_bf16_f32 v136, v136, v137
v_mfma_f32_16x16x32_bf16 v[148:151], a[184:187], a[224:227], v[148:151]
v_cvt_pk_bf16_f32 v137, v138, v139
ds_write_b64 v255, v[136:137] offset:8768
v_mul_f32 v140, s51, v140
v_mfma_f32_16x16x32_bf16 v[148:151], a[188:191], a[228:231], v[148:151]
v_mul_f32 v141, s51, v141
v_mul_f32 v142, s51, v142
v_mul_f32 v143, s51, v143
v_mfma_f32_16x16x32_bf16 v[152:155], a[16:19], a[48:51], v[152:155]
v_cvt_pk_bf16_f32 v140, v140, v141
v_cvt_pk_bf16_f32 v141, v142, v143
ds_write_b64 v255, v[140:141] offset:8800
v_mfma_f32_16x16x32_bf16 v[152:155], a[20:23], a[52:55], v[152:155]
v_mul_f32 v144, s51, v144
v_mul_f32 v145, s51, v145
v_mul_f32 v146, s51, v146
v_mfma_f32_16x16x32_bf16 v[152:155], a[192:195], a[224:227], v[152:155]
v_mul_f32 v147, s51, v147
v_cvt_pk_bf16_f32 v144, v144, v145
v_cvt_pk_bf16_f32 v145, v146, v147
v_mfma_f32_16x16x32_bf16 v[152:155], a[196:199], a[228:231], v[152:155]
ds_write_b64 v255, v[144:145] offset:17408
v_mul_f32 v148, s51, v148
v_mul_f32 v149, s51, v149
v_mfma_f32_16x16x32_bf16 v[156:159], a[24:27], a[48:51], v[156:159]
v_mul_f32 v150, s51, v150
v_mul_f32 v151, s51, v151
v_cvt_pk_bf16_f32 v148, v148, v149
v_mfma_f32_16x16x32_bf16 v[156:159], a[28:31], a[52:55], v[156:159]
s_add_u32 m0, s47, 16688
v_cvt_pk_bf16_f32 v149, v150, v151
ds_write_b64 v255, v[148:149] offset:17440
v_mfma_f32_16x16x32_bf16 v[156:159], a[200:203], a[224:227], v[156:159]
buffer_load_dwordx4 v1, s[20:23], s45 offen offset:3072 nt lds
s_add_u32 s45, s45, 16384
v_mfma_f32_16x16x32_bf16 v[156:159], a[204:207], a[228:231], v[156:159]
v_mul_f32 v152, s51, v152
v_mul_f32 v153, s51, v153
v_mul_f32 v154, s51, v154
v_mfma_f32_16x16x32_bf16 v[160:163], a[0:3], a[56:59], v[160:163]
v_mul_f32 v155, s51, v155
v_cvt_pk_bf16_f32 v152, v152, v153
v_cvt_pk_bf16_f32 v153, v154, v155
v_mfma_f32_16x16x32_bf16 v[160:163], a[4:7], a[60:63], v[160:163]
ds_write_b64 v255, v[152:153] offset:17472
v_mfma_f32_16x16x32_bf16 v[160:163], a[176:179], a[232:235], v[160:163]
v_mfma_f32_16x16x32_bf16 v[160:163], a[180:183], a[236:239], v[160:163]
v_mul_f32 v156, s51, v156
v_mul_f32 v157, s51, v157
v_mul_f32 v158, s51, v158
v_mfma_f32_16x16x32_bf16 v[164:167], a[8:11], a[56:59], v[164:167]
v_mul_f32 v159, s51, v159
v_cvt_pk_bf16_f32 v156, v156, v157
v_cvt_pk_bf16_f32 v157, v158, v159
v_mfma_f32_16x16x32_bf16 v[164:167], a[12:15], a[60:63], v[164:167]
ds_write_b64 v255, v[156:157] offset:17504
s_waitcnt vmcnt(8) lgkmcnt(0)
s_barrier
v_mfma_f32_16x16x32_bf16 v[164:167], a[184:187], a[232:235], v[164:167]
ds_read_b128 v[220:223], v2 offset:0
v_mfma_f32_16x16x32_bf16 v[164:167], a[188:191], a[236:239], v[164:167]
s_add_u32 m0, s48, 33792
v_mul_f32 v160, s51, v160
ds_read_b128 v[224:227], v2 offset:16
v_mfma_f32_16x16x32_bf16 v[168:171], a[16:19], a[56:59], v[168:171]
buffer_load_dwordx4 v1, s[24:27], s45 offen offset:0 nt lds
v_mul_f32 v161, s51, v161
ds_read_b128 v[228:231], v2 offset:32
v_mfma_f32_16x16x32_bf16 v[168:171], a[20:23], a[60:63], v[168:171]
v_mul_f32 v162, s51, v162
v_mul_f32 v163, s51, v163
ds_read_b128 v[232:235], v2 offset:48
v_mfma_f32_16x16x32_bf16 v[168:171], a[192:195], a[232:235], v[168:171]
v_cvt_pk_bf16_f32 v160, v160, v161
v_cvt_pk_bf16_f32 v161, v162, v163
ds_read_b128 a[96:99], v5 offset:0
v_mfma_f32_16x16x32_bf16 v[168:171], a[196:199], a[236:239], v[168:171]
ds_write_b64 v255, v[160:161] offset:26112
v_mul_f32 v164, s51, v164
ds_read_b128 a[100:103], v5 offset:16
v_mfma_f32_16x16x32_bf16 v[172:175], a[24:27], a[56:59], v[172:175]
v_mul_f32 v165, s51, v165
v_mul_f32 v166, s51, v166
ds_read_b128 a[104:107], v5 offset:32
v_mfma_f32_16x16x32_bf16 v[172:175], a[28:31], a[60:63], v[172:175]
v_mul_f32 v167, s51, v167
v_cvt_pk_bf16_f32 v164, v164, v165
ds_read_b128 a[108:111], v5 offset:48
v_mfma_f32_16x16x32_bf16 v[172:175], a[200:203], a[232:235], v[172:175]
v_cvt_pk_bf16_f32 v165, v166, v167
ds_write_b64 v255, v[164:165] offset:26144
ds_read_b128 a[112:115], v5 offset:8704
v_mfma_f32_16x16x32_bf16 v[172:175], a[204:207], a[236:239], v[172:175]
v_mul_f32 v168, s51, v168
v_mul_f32 v169, s51, v169
ds_read_b128 a[116:119], v5 offset:8720
v_mfma_f32_16x16x32_bf16 v[176:179], a[0:3], a[64:67], v[176:179]
v_mul_f32 v170, s51, v170
v_mul_f32 v171, s51, v171
ds_read_b128 a[120:123], v5 offset:8736
v_mfma_f32_16x16x32_bf16 v[176:179], a[4:7], a[68:71], v[176:179]
s_add_u32 m0, s48, 33824
v_cvt_pk_bf16_f32 v168, v168, v169
ds_read_b128 a[124:127], v5 offset:8752
v_mfma_f32_16x16x32_bf16 v[176:179], a[176:179], a[240:243], v[176:179]
buffer_load_dwordx4 v1, s[24:27], s45 offen offset:1024 nt lds
v_cvt_pk_bf16_f32 v169, v170, v171
ds_read_b128 a[128:131], v5 offset:17408
v_mfma_f32_16x16x32_bf16 v[176:179], a[180:183], a[244:247], v[176:179]
ds_write_b64 v255, v[168:169] offset:26176
v_mul_f32 v172, s51, v172
ds_read_b128 a[132:135], v5 offset:17424
v_mfma_f32_16x16x32_bf16 v[180:183], a[8:11], a[64:67], v[180:183]
v_mul_f32 v173, s51, v173
v_mul_f32 v174, s51, v174
ds_read_b128 a[136:139], v5 offset:17440
v_mfma_f32_16x16x32_bf16 v[180:183], a[12:15], a[68:71], v[180:183]
v_mul_f32 v175, s51, v175
v_cvt_pk_bf16_f32 v172, v172, v173
ds_read_b128 a[140:143], v5 offset:17456
v_mfma_f32_16x16x32_bf16 v[180:183], a[184:187], a[240:243], v[180:183]
v_cvt_pk_bf16_f32 v173, v174, v175
ds_write_b64 v255, v[172:173] offset:26208
v_mfma_f32_16x16x32_bf16 v[180:183], a[188:191], a[244:247], v[180:183]
v_mul_f32 v176, s51, v176
v_mul_f32 v177, s51, v177
v_mul_f32 v178, s51, v178
v_mfma_f32_16x16x32_bf16 v[184:187], a[16:19], a[64:67], v[184:187]
v_mul_f32 v179, s51, v179
v_cvt_pk_bf16_f32 v176, v176, v177
v_cvt_pk_bf16_f32 v177, v178, v179
v_mfma_f32_16x16x32_bf16 v[184:187], a[20:23], a[68:71], v[184:187]
ds_write_b64 v255, v[176:177] offset:34816
v_mfma_f32_16x16x32_bf16 v[184:187], a[192:195], a[240:243], v[184:187]
s_add_u32 m0, s48, 33856
v_mfma_f32_16x16x32_bf16 v[184:187], a[196:199], a[244:247], v[184:187]
buffer_load_dwordx4 v1, s[24:27], s45 offen offset:2048 nt lds
v_mul_f32 v180, s51, v180
v_mul_f32 v181, s51, v181
v_mfma_f32_16x16x32_bf16 v[188:191], a[24:27], a[64:67], v[188:191]
v_mul_f32 v182, s51, v182
v_mul_f32 v183, s51, v183
v_cvt_pk_bf16_f32 v180, v180, v181
v_mfma_f32_16x16x32_bf16 v[188:191], a[28:31], a[68:71], v[188:191]
v_cvt_pk_bf16_f32 v181, v182, v183
ds_write_b64 v255, v[180:181] offset:34848
v_mfma_f32_16x16x32_bf16 v[188:191], a[200:203], a[240:243], v[188:191]
v_mfma_f32_16x16x32_bf16 v[188:191], a[204:207], a[244:247], v[188:191]
v_mul_f32 v184, s51, v184
v_mul_f32 v185, s51, v185
v_mul_f32 v186, s51, v186
v_mfma_f32_16x16x32_bf16 v[192:195], a[0:3], a[72:75], v[192:195]
v_mul_f32 v187, s51, v187
v_cvt_pk_bf16_f32 v184, v184, v185
v_cvt_pk_bf16_f32 v185, v186, v187
v_mfma_f32_16x16x32_bf16 v[192:195], a[4:7], a[76:79], v[192:195]
ds_write_b64 v255, v[184:185] offset:34880
v_mfma_f32_16x16x32_bf16 v[192:195], a[176:179], a[248:251], v[192:195]
v_mfma_f32_16x16x32_bf16 v[192:195], a[180:183], a[252:255], v[192:195]
v_mul_f32 v188, s51, v188
v_mul_f32 v189, s51, v189
v_mul_f32 v190, s51, v190
v_mfma_f32_16x16x32_bf16 v[196:199], a[8:11], a[72:75], v[196:199]
s_add_u32 m0, s48, 33888
v_mul_f32 v191, s51, v191
v_cvt_pk_bf16_f32 v188, v188, v189
v_mfma_f32_16x16x32_bf16 v[196:199], a[12:15], a[76:79], v[196:199]
buffer_load_dwordx4 v1, s[24:27], s45 offen offset:3072 nt lds
v_cvt_pk_bf16_f32 v189, v190, v191
ds_write_b64 v255, v[188:189] offset:34912
v_mfma_f32_16x16x32_bf16 v[196:199], a[184:187], a[248:251], v[196:199]
v_mfma_f32_16x16x32_bf16 v[196:199], a[188:191], a[252:255], v[196:199]
v_mul_f32 v192, s51, v192
v_mul_f32 v193, s51, v193
v_mul_f32 v194, s51, v194
v_mfma_f32_16x16x32_bf16 v[200:203], a[16:19], a[72:75], v[200:203]
v_mul_f32 v195, s51, v195
v_cvt_pk_bf16_f32 v192, v192, v193
v_cvt_pk_bf16_f32 v193, v194, v195
v_mfma_f32_16x16x32_bf16 v[200:203], a[20:23], a[76:79], v[200:203]
ds_write_b64 v251, v[192:193] offset:0
v_mfma_f32_16x16x32_bf16 v[200:203], a[192:195], a[248:251], v[200:203]
v_mfma_f32_16x16x32_bf16 v[200:203], a[196:199], a[252:255], v[200:203]
v_mul_f32 v196, s51, v196
v_mul_f32 v197, s51, v197
v_mul_f32 v198, s51, v198
v_mfma_f32_16x16x32_bf16 v[204:207], a[24:27], a[72:75], v[204:207]
v_mul_f32 v199, s51, v199
v_cvt_pk_bf16_f32 v196, v196, v197
v_cvt_pk_bf16_f32 v197, v198, v199
v_mfma_f32_16x16x32_bf16 v[204:207], a[28:31], a[76:79], v[204:207]
ds_write_b64 v251, v[196:197] offset:32
v_mfma_f32_16x16x32_bf16 v[204:207], a[200:203], a[248:251], v[204:207]
v_mfma_f32_16x16x32_bf16 v[204:207], a[204:207], a[252:255], v[204:207]
v_mul_f32 v200, s51, v200
v_mul_f32 v201, s51, v201
v_mul_f32 v202, s51, v202
s_waitcnt lgkmcnt(0)
v_mfma_f32_16x16x32_bf16 v[16:19], v[220:223], a[96:99], 0
v_mul_f32 v203, s51, v203
v_cvt_pk_bf16_f32 v200, v200, v201
v_cvt_pk_bf16_f32 v201, v202, v203
v_mfma_f32_16x16x32_bf16 v[16:19], v[224:227], a[100:103], v[16:19]
ds_write_b64 v251, v[200:201] offset:64
v_mul_f32 v204, s51, v204
v_mul_f32 v205, s51, v205
v_mfma_f32_16x16x32_bf16 v[16:19], v[228:231], a[104:107], v[16:19]
v_mul_f32 v206, s51, v206
v_mul_f32 v207, s51, v207
v_cvt_pk_bf16_f32 v204, v204, v205
v_mfma_f32_16x16x32_bf16 v[16:19], v[232:235], a[108:111], v[16:19]
v_cvt_pk_bf16_f32 v205, v206, v207
ds_write_b64 v251, v[204:205] offset:96
s_waitcnt lgkmcnt(0)
v_mfma_f32_16x16x32_bf16 v[20:23], v[220:223], a[112:115], 0
s_barrier
ds_read_b128 a[144:147], v5 offset:26112
ds_read_b128 a[148:151], v5 offset:26128
v_mfma_f32_16x16x32_bf16 v[20:23], v[224:227], a[116:119], v[20:23]
ds_read_b128 a[152:155], v5 offset:26144
ds_read_b128 a[156:159], v5 offset:26160
ds_read_b128 a[160:163], v5 offset:34816
v_mfma_f32_16x16x32_bf16 v[20:23], v[228:231], a[120:123], v[20:23]
ds_read_b128 a[164:167], v5 offset:34832
ds_read_b128 a[168:171], v5 offset:34848
ds_read_b128 a[172:175], v5 offset:34864
v_mfma_f32_16x16x32_bf16 v[20:23], v[232:235], a[124:127], v[20:23]
ds_read_b128 a[176:179], v250 offset:0
ds_read_b128 a[180:183], v250 offset:16
ds_read_b128 a[184:187], v250 offset:32
v_mfma_f32_16x16x32_bf16 v[24:27], v[220:223], a[128:131], 0
ds_read_b128 a[188:191], v250 offset:48
v_mfma_f32_16x16x32_bf16 v[24:27], v[224:227], a[132:135], v[24:27]
v_mfma_f32_16x16x32_bf16 v[24:27], v[228:231], a[136:139], v[24:27]
v_mfma_f32_16x16x32_bf16 v[24:27], v[232:235], a[140:143], v[24:27]
v_and_b32 v252, 3, v0
v_cmp_eq_u32 vcc, 0, v252
v_mov_b32 v253, 0x3f803f80
s_mov_b32 s49, 0
v_cndmask_b32 v184, 0, v253, vcc
v_cndmask_b32 v185, 0, v253, vcc
v_cndmask_b32 v186, 0, v253, vcc
v_cndmask_b32 v187, 0, v253, vcc
v_mov_b32 v180, 0
v_mov_b32 v181, 0
v_mov_b32 v182, 0
v_mov_b32 v183, 0
v_max3_f32 v112, v16, v17, v18
v_max_f32 v112, v112, v19
v_max3_f32 v113, v20, v21, v22
v_max_f32 v113, v113, v23
v_max3_f32 v114, v24, v25, v26
v_max_f32 v114, v114, v27
s_waitcnt lgkmcnt(0)
s_add_u32 m0, s47, 33280
v_mfma_f32_16x16x32_bf16 v[28:31], v[220:223], a[144:147], 0
buffer_load_dwordx4 v1, s[20:23], s45 offen offset:0 nt lds
ds_read_b128 v[188:191], v2 offset:0
ds_read_b128 v[192:195], v2 offset:16
v_mfma_f32_16x16x32_bf16 v[28:31], v[224:227], a[148:151], v[28:31]
ds_read_b128 v[196:199], v2 offset:32
ds_read_b128 v[200:203], v2 offset:48
v_mfma_f32_16x16x32_bf16 v[28:31], v[228:231], a[152:155], v[28:31]
ds_read_b128 v[204:207], v2 offset:256
ds_read_b128 v[208:211], v2 offset:272
s_add_u32 m0, s47, 33296
v_mfma_f32_16x16x32_bf16 v[28:31], v[232:235], a[156:159], v[28:31]
buffer_load_dwordx4 v1, s[20:23], s45 offen offset:1024 nt lds
ds_read_b128 v[212:215], v2 offset:288
ds_read_b128 v[216:219], v2 offset:304
v_mfma_f32_16x16x32_bf16 v[32:35], v[220:223], a[160:163], 0
ds_read_b64_tr_b16 a[192:193], v3 offset:0
ds_read_b64_tr_b16 a[194:195], v3 offset:256
v_mfma_f32_16x16x32_bf16 v[32:35], v[224:227], a[164:167], v[32:35]
ds_read_b64_tr_b16 a[196:197], v3 offset:32
ds_read_b64_tr_b16 a[198:199], v3 offset:288
v_mfma_f32_16x16x32_bf16 v[32:35], v[228:231], a[168:171], v[32:35]
ds_read_b64_tr_b16 a[200:201], v3 offset:64
ds_read_b64_tr_b16 a[202:203], v3 offset:320
s_add_u32 m0, s47, 33312
v_mfma_f32_16x16x32_bf16 v[32:35], v[232:235], a[172:175], v[32:35]
buffer_load_dwordx4 v1, s[20:23], s45 offen offset:2048 nt lds
ds_read_b64_tr_b16 a[204:205], v3 offset:96
ds_read_b64_tr_b16 a[206:207], v3 offset:352
v_mfma_f32_16x16x32_bf16 v[36:39], v[220:223], a[176:179], 0
ds_read_b64_tr_b16 a[208:209], v4 offset:0
ds_read_b64_tr_b16 a[210:211], v4 offset:256
v_mfma_f32_16x16x32_bf16 v[36:39], v[224:227], a[180:183], v[36:39]
ds_read_b64_tr_b16 a[212:213], v4 offset:32
ds_read_b64_tr_b16 a[214:215], v4 offset:288
v_mfma_f32_16x16x32_bf16 v[36:39], v[228:231], a[184:187], v[36:39]
ds_read_b64_tr_b16 a[216:217], v4 offset:64
ds_read_b64_tr_b16 a[218:219], v4 offset:320
s_add_u32 m0, s47, 33328
v_mfma_f32_16x16x32_bf16 v[36:39], v[232:235], a[188:191], v[36:39]
buffer_load_dwordx4 v1, s[20:23], s45 offen offset:3072 nt lds
ds_read_b64_tr_b16 a[220:221], v4 offset:96
ds_read_b64_tr_b16 a[222:223], v4 offset:352
s_add_u32 s45, s45, 16384
v_max3_f32 v115, v28, v29, v30
v_max_f32 v115, v115, v31
v_max3_f32 v116, v32, v33, v34
v_max_f32 v116, v116, v35
s_nop 1
v_max3_f32 v117, v36, v37, v38
v_max_f32 v117, v117, v39
s_cmp_lg_u32 s3, 0
s_cbranch_scc1 L_fullmax
L_maxdone:
v_mov_b32 v244, v112
v_mov_b32 v245, v113
v_mov_b32 v246, v114
v_mov_b32 v247, v115
v_mov_b32 v248, v116
v_mov_b32 v249, v117
v_permlane16_swap_b32 v112, v244
v_permlane16_swap_b32 v113, v245
v_permlane16_swap_b32 v114, v246
v_permlane16_swap_b32 v115, v247
v_permlane16_swap_b32 v116, v248
v_permlane16_swap_b32 v117, v249
v_max_f32 v112, v112, v244
v_max_f32 v113, v113, v245
v_max_f32 v114, v114, v246
v_max_f32 v115, v115, v247
v_max_f32 v116, v116, v248
v_max_f32 v117, v117, v249
v_mov_b32 v244, v112
v_mov_b32 v245, v113
v_mov_b32 v246, v114
v_mov_b32 v247, v115
v_mov_b32 v248, v116
v_mov_b32 v249, v117
v_permlane32_swap_b32 v112, v244
v_permlane32_swap_b32 v113, v245
v_permlane32_swap_b32 v114, v246
v_permlane32_swap_b32 v115, v247
v_permlane32_swap_b32 v116, v248
v_permlane32_swap_b32 v117, v249
v_max_f32 v112, v112, v244
v_max_f32 v113, v113, v245
v_max_f32 v114, v114, v246
v_max_f32 v115, v115, v247
v_max_f32 v116, v116, v248
v_max_f32 v117, v117, v249
v_sub_f32 v136, 0, v112
v_sub_f32 v137, 0, v112
v_sub_f32 v138, 0, v112
v_sub_f32 v139, 0, v112
v_sub_f32 v140, 0, v113
v_sub_f32 v141, 0, v113
v_sub_f32 v142, 0, v113
v_sub_f32 v143, 0, v113
v_sub_f32 v144, 0, v114
v_sub_f32 v145, 0, v114
v_sub_f32 v146, 0, v114
v_sub_f32 v147, 0, v114
v_sub_f32 v148, 0, v115
v_sub_f32 v149, 0, v115
v_sub_f32 v150, 0, v115
v_sub_f32 v151, 0, v115
v_sub_f32 v152, 0, v116
v_sub_f32 v153, 0, v116
v_sub_f32 v154, 0, v116
v_sub_f32 v155, 0, v116
v_sub_f32 v156, 0, v117
v_sub_f32 v157, 0, v117
v_sub_f32 v158, 0, v117
v_sub_f32 v159, 0, v117
s_waitcnt vmcnt(8) lgkmcnt(0)
s_barrier
v_mfma_f32_16x16x32_bf16 v[112:115], v[188:191], a[96:99], v[136:139]
ds_read_b128 v[220:223], v2 offset:16640
ds_read_b128 v[224:227], v2 offset:16656
v_mfma_f32_16x16x32_bf16 v[112:115], v[192:195], a[100:103], v[112:115]
v_mfma_f32_16x16x32_bf16 v[112:115], v[196:199], a[104:107], v[112:115]
v_mfma_f32_16x16x32_bf16 v[112:115], v[200:203], a[108:111], v[112:115]
v_mfma_f32_16x16x32_bf16 v[116:119], v[204:207], a[96:99], v[136:139]
ds_read_b128 v[228:231], v2 offset:16672
ds_read_b128 v[232:235], v2 offset:16688
v_mfma_f32_16x16x32_bf16 v[116:119], v[208:211], a[100:103], v[116:119]
v_mfma_f32_16x16x32_bf16 v[116:119], v[212:215], a[104:107], v[116:119]
s_add_u32 m0, s47, 49920
v_mfma_f32_16x16x32_bf16 v[116:119], v[216:219], a[108:111], v[116:119]
s_waitcnt vmcnt(4)
buffer_load_dwordx4 v1, s[20:23], s45 offen offset:0 nt lds
v_exp_f32 v112, v112
ds_read_b128 v[236:239], v2 offset:16896
ds_read_b128 v[240:243], v2 offset:16912
v_exp_f32 v113, v113
s_nop 0
v_cvt_pk_bf16_f32 v128, v112, v113
v_exp_f32 v114, v114
ds_read_b128 v[244:247], v2 offset:16928
ds_read_b128 v[248:251], v2 offset:16944
v_exp_f32 v115, v115
s_nop 0
v_cvt_pk_bf16_f32 v129, v114, v115
v_exp_f32 v116, v116
v_mfma_f32_16x16x32_bf16 v[120:123], v[188:191], a[112:115], v[140:143]
ds_read_b64_tr_b16 a[224:225], v3 offset:16896
v_mfma_f32_16x16x32_bf16 v[120:123], v[192:195], a[116:119], v[120:123]
v_exp_f32 v117, v117
v_mfma_f32_16x16x32_bf16 v[120:123], v[196:199], a[120:123], v[120:123]
v_cvt_pk_bf16_f32 v130, v116, v117
v_mfma_f32_16x16x32_bf16 v[120:123], v[200:203], a[124:127], v[120:123]
v_exp_f32 v118, v118
v_mfma_f32_16x16x32_bf16 v[124:127], v[204:207], a[112:115], v[140:143]
ds_read_b64_tr_b16 a[226:227], v3 offset:17152
v_mfma_f32_16x16x32_bf16 v[124:127], v[208:211], a[116:119], v[124:127]
v_exp_f32 v119, v119
v_mfma_f32_16x16x32_bf16 v[124:127], v[212:215], a[120:123], v[124:127]
v_cvt_pk_bf16_f32 v131, v118, v119
s_add_u32 m0, s47, 49936
v_mfma_f32_16x16x32_bf16 v[124:127], v[216:219], a[124:127], v[124:127]
s_waitcnt vmcnt(4)
buffer_load_dwordx4 v1, s[20:23], s45 offen offset:1024 nt lds
v_mfma_f32_16x16x32_bf16 v[16:19], a[192:195], v[128:131], 0
v_exp_f32 v120, v120
v_mfma_f32_16x16x32_bf16 v[20:23], a[196:199], v[128:131], 0
ds_read_b64_tr_b16 a[228:229], v3 offset:16928
v_mfma_f32_16x16x32_bf16 v[24:27], a[200:203], v[128:131], 0
v_exp_f32 v121, v121
v_mfma_f32_16x16x32_bf16 v[28:31], a[204:207], v[128:131], 0
v_cvt_pk_bf16_f32 v132, v120, v121
s_add_u32 m0, s47, 49952
v_mfma_f32_16x16x32_bf16 a[0:3], a[208:211], v[128:131], 0
v_exp_f32 v122, v122
v_mfma_f32_16x16x32_bf16 a[4:7], a[212:215], v[128:131], 0
ds_read_b64_tr_b16 a[230:231], v3 offset:17184
s_waitcnt vmcnt(4)
buffer_load_dwordx4 v1, s[20:23], s45 offen offset:2048 nt lds
v_mfma_f32_16x16x32_bf16 a[8:11], a[216:219], v[128:131], 0
v_exp_f32 v123, v123
v_mfma_f32_16x16x32_bf16 a[12:15], a[220:223], v[128:131], 0
v_cvt_pk_bf16_f32 v133, v122, v123
v_mfma_f32_16x16x32_bf16 v[160:163], v[184:187], v[128:131], 0
v_exp_f32 v124, v124
v_mfma_f32_16x16x32_bf16 v[112:115], v[188:191], a[128:131], v[144:147]
ds_read_b64_tr_b16 a[232:233], v3 offset:16960
v_mfma_f32_16x16x32_bf16 v[112:115], v[192:195], a[132:135], v[112:115]
v_exp_f32 v125, v125
v_mfma_f32_16x16x32_bf16 v[112:115], v[196:199], a[136:139], v[112:115]
v_cvt_pk_bf16_f32 v134, v124, v125
v_mfma_f32_16x16x32_bf16 v[112:115], v[200:203], a[140:143], v[112:115]
v_exp_f32 v126, v126
v_mfma_f32_16x16x32_bf16 v[116:119], v[204:207], a[128:131], v[144:147]
ds_read_b64_tr_b16 a[234:235], v3 offset:17216
v_mfma_f32_16x16x32_bf16 v[116:119], v[208:211], a[132:135], v[116:119]
v_exp_f32 v127, v127
v_mfma_f32_16x16x32_bf16 v[116:119], v[212:215], a[136:139], v[116:119]
v_cvt_pk_bf16_f32 v135, v126, v127
s_add_u32 m0, s47, 49968
v_mfma_f32_16x16x32_bf16 v[116:119], v[216:219], a[140:143], v[116:119]
s_waitcnt vmcnt(4)
buffer_load_dwordx4 v1, s[20:23], s45 offen offset:3072 nt lds
v_mfma_f32_16x16x32_bf16 v[32:35], a[192:195], v[132:135], 0
v_exp_f32 v112, v112
v_mfma_f32_16x16x32_bf16 v[36:39], a[196:199], v[132:135], 0
ds_read_b64_tr_b16 a[236:237], v3 offset:16992
v_mfma_f32_16x16x32_bf16 v[40:43], a[200:203], v[132:135], 0
v_exp_f32 v113, v113
v_mfma_f32_16x16x32_bf16 v[44:47], a[204:207], v[132:135], 0
v_cvt_pk_bf16_f32 v128, v112, v113
v_mfma_f32_16x16x32_bf16 a[16:19], a[208:211], v[132:135], 0
v_exp_f32 v114, v114
v_mfma_f32_16x16x32_bf16 a[20:23], a[212:215], v[132:135], 0
ds_read_b64_tr_b16 a[238:239], v3 offset:17248
v_mfma_f32_16x16x32_bf16 a[24:27], a[216:219], v[132:135], 0
v_exp_f32 v115, v115
v_mfma_f32_16x16x32_bf16 a[28:31], a[220:223], v[132:135], 0
v_cvt_pk_bf16_f32 v129, v114, v115
v_mfma_f32_16x16x32_bf16 v[164:167], v[184:187], v[132:135], 0
v_exp_f32 v116, v116
v_mfma_f32_16x16x32_bf16 v[120:123], v[188:191], a[144:147], v[148:151]
ds_read_b64_tr_b16 a[240:241], v4 offset:16896
v_mfma_f32_16x16x32_bf16 v[120:123], v[192:195], a[148:151], v[120:123]
v_exp_f32 v117, v117
v_mfma_f32_16x16x32_bf16 v[120:123], v[196:199], a[152:155], v[120:123]
v_cvt_pk_bf16_f32 v130, v116, v117
v_mfma_f32_16x16x32_bf16 v[120:123], v[200:203], a[156:159], v[120:123]
v_exp_f32 v118, v118
v_mfma_f32_16x16x32_bf16 v[124:127], v[204:207], a[144:147], v[148:151]
ds_read_b64_tr_b16 a[242:243], v4 offset:17152
v_mfma_f32_16x16x32_bf16 v[124:127], v[208:211], a[148:151], v[124:127]
v_exp_f32 v119, v119
v_mfma_f32_16x16x32_bf16 v[124:127], v[212:215], a[152:155], v[124:127]
v_cvt_pk_bf16_f32 v131, v118, v119
s_add_u32 m0, s48, 50688
v_mfma_f32_16x16x32_bf16 v[124:127], v[216:219], a[156:159], v[124:127]
s_waitcnt vmcnt(4)
buffer_load_dwordx4 v1, s[24:27], s45 offen offset:0 nt lds
v_mfma_f32_16x16x32_bf16 v[48:51], a[192:195], v[128:131], 0
v_exp_f32 v120, v120
v_mfma_f32_16x16x32_bf16 v[52:55], a[196:199], v[128:131], 0
ds_read_b64_tr_b16 a[244:245], v4 offset:16928
v_mfma_f32_16x16x32_bf16 v[56:59], a[200:203], v[128:131], 0
v_exp_f32 v121, v121
v_mfma_f32_16x16x32_bf16 v[60:63], a[204:207], v[128:131], 0
v_cvt_pk_bf16_f32 v132, v120, v121
v_mfma_f32_16x16x32_bf16 a[32:35], a[208:211], v[128:131], 0
v_exp_f32 v122, v122
v_mfma_f32_16x16x32_bf16 a[36:39], a[212:215], v[128:131], 0
ds_read_b64_tr_b16 a[246:247], v4 offset:17184
v_mfma_f32_16x16x32_bf16 a[40:43], a[216:219], v[128:131], 0
v_exp_f32 v123, v123
v_mfma_f32_16x16x32_bf16 a[44:47], a[220:223], v[128:131], 0
v_cvt_pk_bf16_f32 v133, v122, v123
v_mfma_f32_16x16x32_bf16 v[168:171], v[184:187], v[128:131], 0
v_exp_f32 v124, v124
v_mfma_f32_16x16x32_bf16 v[112:115], v[188:191], a[160:163], v[152:155]
ds_read_b64_tr_b16 a[248:249], v4 offset:16960
v_mfma_f32_16x16x32_bf16 v[112:115], v[192:195], a[164:167], v[112:115]
v_exp_f32 v125, v125
v_mfma_f32_16x16x32_bf16 v[112:115], v[196:199], a[168:171], v[112:115]
v_cvt_pk_bf16_f32 v134, v124, v125
v_mfma_f32_16x16x32_bf16 v[112:115], v[200:203], a[172:175], v[112:115]
v_exp_f32 v126, v126
v_mfma_f32_16x16x32_bf16 v[116:119], v[204:207], a[160:163], v[152:155]
ds_read_b64_tr_b16 a[250:251], v4 offset:17216
v_mfma_f32_16x16x32_bf16 v[116:119], v[208:211], a[164:167], v[116:119]
v_exp_f32 v127, v127
v_mfma_f32_16x16x32_bf16 v[116:119], v[212:215], a[168:171], v[116:119]
v_cvt_pk_bf16_f32 v135, v126, v127
s_add_u32 m0, s48, 50720
v_mfma_f32_16x16x32_bf16 v[116:119], v[216:219], a[172:175], v[116:119]
s_waitcnt vmcnt(4)
buffer_load_dwordx4 v1, s[24:27], s45 offen offset:1024 nt lds
v_mfma_f32_16x16x32_bf16 v[64:67], a[192:195], v[132:135], 0
v_exp_f32 v112, v112
v_mfma_f32_16x16x32_bf16 v[68:71], a[196:199], v[132:135], 0
ds_read_b64_tr_b16 a[252:253], v4 offset:16992
v_mfma_f32_16x16x32_bf16 v[72:75], a[200:203], v[132:135], 0
v_exp_f32 v113, v113
v_mfma_f32_16x16x32_bf16 v[76:79], a[204:207], v[132:135], 0
v_cvt_pk_bf16_f32 v128, v112, v113
s_add_u32 m0, s48, 50752
v_mfma_f32_16x16x32_bf16 a[48:51], a[208:211], v[132:135], 0
v_exp_f32 v114, v114
v_mfma_f32_16x16x32_bf16 a[52:55], a[212:215], v[132:135], 0
ds_read_b64_tr_b16 a[254:255], v4 offset:17248
s_waitcnt vmcnt(4)
buffer_load_dwordx4 v1, s[24:27], s45 offen offset:2048 nt lds
v_mfma_f32_16x16x32_bf16 a[56:59], a[216:219], v[132:135], 0
v_exp_f32 v115, v115
v_mfma_f32_16x16x32_bf16 a[60:63], a[220:223], v[132:135], 0
v_cvt_pk_bf16_f32 v129, v114, v115
v_mfma_f32_16x16x32_bf16 v[172:175], v[184:187], v[132:135], 0
v_exp_f32 v116, v116
v_mfma_f32_16x16x32_bf16 v[120:123], v[188:191], a[176:179], v[156:159]
v_mfma_f32_16x16x32_bf16 v[120:123], v[192:195], a[180:183], v[120:123]
v_exp_f32 v117, v117
v_mfma_f32_16x16x32_bf16 v[120:123], v[196:199], a[184:187], v[120:123]
v_cvt_pk_bf16_f32 v130, v116, v117
v_mfma_f32_16x16x32_bf16 v[120:123], v[200:203], a[188:191], v[120:123]
v_exp_f32 v118, v118
v_mfma_f32_16x16x32_bf16 v[124:127], v[204:207], a[176:179], v[156:159]
v_mfma_f32_16x16x32_bf16 v[124:127], v[208:211], a[180:183], v[124:127]
v_exp_f32 v119, v119
v_mfma_f32_16x16x32_bf16 v[124:127], v[212:215], a[184:187], v[124:127]
v_cvt_pk_bf16_f32 v131, v118, v119
s_add_u32 m0, s48, 50784
v_mfma_f32_16x16x32_bf16 v[124:127], v[216:219], a[188:191], v[124:127]
s_waitcnt vmcnt(4)
buffer_load_dwordx4 v1, s[24:27], s45 offen offset:3072 nt lds
v_mfma_f32_16x16x32_bf16 v[80:83], a[192:195], v[128:131], 0
v_exp_f32 v120, v120
v_mfma_f32_16x16x32_bf16 v[84:87], a[196:199], v[128:131], 0
v_mfma_f32_16x16x32_bf16 v[88:91], a[200:203], v[128:131], 0
v_exp_f32 v121, v121
v_mfma_f32_16x16x32_bf16 v[92:95], a[204:207], v[128:131], 0
v_cvt_pk_bf16_f32 v132, v120, v121
s_add_u32 s45, s45, 16384
v_mfma_f32_16x16x32_bf16 a[64:67], a[208:211], v[128:131], 0
v_exp_f32 v122, v122
v_mfma_f32_16x16x32_bf16 a[68:71], a[212:215], v[128:131], 0
v_mfma_f32_16x16x32_bf16 a[72:75], a[216:219], v[128:131], 0
v_exp_f32 v123, v123
v_mfma_f32_16x16x32_bf16 a[76:79], a[220:223], v[128:131], 0
v_cvt_pk_bf16_f32 v133, v122, v123
v_mfma_f32_16x16x32_bf16 v[176:179], v[184:187], v[128:131], 0
v_exp_f32 v124, v124
.p2align 6
L_loop0:
s_waitcnt vmcnt(8) lgkmcnt(0)
s_barrier
v_mfma_f32_16x16x32_bf16 v[112:115], v[220:223], a[96:99], v[136:139]
ds_read_b128 v[188:191], v2 offset:33280
ds_read_b128 v[192:195], v2 offset:33296
v_mfma_f32_16x16x32_bf16 v[112:115], v[224:227], a[100:103], v[112:115]
v_exp_f32 v125, v125
v_mfma_f32_16x16x32_bf16 v[112:115], v[228:231], a[104:107], v[112:115]
v_cvt_pk_bf16_f32 v134, v124, v125
v_mfma_f32_16x16x32_bf16 v[112:115], v[232:235], a[108:111], v[112:115]
v_exp_f32 v126, v126
v_mfma_f32_16x16x32_bf16 v[116:119], v[236:239], a[96:99], v[136:139]
ds_read_b128 v[196:199], v2 offset:33312
ds_read_b128 v[200:203], v2 offset:33328
v_mfma_f32_16x16x32_bf16 v[116:119], v[240:243], a[100:103], v[116:119]
v_exp_f32 v127, v127
v_mfma_f32_16x16x32_bf16 v[116:119], v[244:247], a[104:107], v[116:119]
v_cvt_pk_bf16_f32 v135, v126, v127
s_add_u32 m0, s47, 0
v_mfma_f32_16x16x32_bf16 v[116:119], v[248:251], a[108:111], v[116:119]
s_waitcnt vmcnt(4)
buffer_load_dwordx4 v1, s[20:23], s45 offen offset:0 nt lds
v_mfma_f32_16x16x32_bf16 v[96:99], a[192:195], v[132:135], v[96:99]
v_exp_f32 v112, v112
v_mfma_f32_16x16x32_bf16 v[100:103], a[196:199], v[132:135], v[100:103]
ds_read_b128 v[204:207], v2 offset:33536
ds_read_b128 v[208:211], v2 offset:33552
v_mfma_f32_16x16x32_bf16 v[104:107], a[200:203], v[132:135], v[104:107]
v_exp_f32 v113, v113
v_mfma_f32_16x16x32_bf16 v[108:111], a[204:207], v[132:135], v[108:111]
v_cvt_pk_bf16_f32 v128, v112, v113
v_mfma_f32_16x16x32_bf16 a[80:83], a[208:211], v[132:135], a[80:83]
v_exp_f32 v114, v114
v_mfma_f32_16x16x32_bf16 a[84:87], a[212:215], v[132:135], a[84:87]
ds_read_b128 v[212:215], v2 offset:33568
ds_read_b128 v[216:219], v2 offset:33584
v_mfma_f32_16x16x32_bf16 a[88:91], a[216:219], v[132:135], a[88:91]
v_exp_f32 v115, v115
v_mfma_f32_16x16x32_bf16 a[92:95], a[220:223], v[132:135], a[92:95]
v_cvt_pk_bf16_f32 v129, v114, v115
v_mfma_f32_16x16x32_bf16 v[180:183], v[184:187], v[132:135], v[180:183]
v_exp_f32 v116, v116
v_mfma_f32_16x16x32_bf16 v[120:123], v[220:223], a[112:115], v[140:143]
ds_read_b64_tr_b16 a[192:193], v3 offset:33792
v_mfma_f32_16x16x32_bf16 v[120:123], v[224:227], a[116:119], v[120:123]
v_exp_f32 v117, v117
v_mfma_f32_16x16x32_bf16 v[120:123], v[228:231], a[120:123], v[120:123]
v_cvt_pk_bf16_f32 v130, v116, v117
v_mfma_f32_16x16x32_bf16 v[120:123], v[232:235], a[124:127], v[120:123]
v_exp_f32 v118, v118
v_mfma_f32_16x16x32_bf16 v[124:127], v[236:239], a[112:115], v[140:143]
ds_read_b64_tr_b16 a[194:195], v3 offset:34048
v_mfma_f32_16x16x32_bf16 v[124:127], v[240:243], a[116:119], v[124:127]
v_exp_f32 v119, v119
v_mfma_f32_16x16x32_bf16 v[124:127], v[244:247], a[120:123], v[124:127]
v_cvt_pk_bf16_f32 v131, v118, v119
s_add_u32 m0, s47, 16
v_mfma_f32_16x16x32_bf16 v[124:127], v[248:251], a[124:127], v[124:127]
s_waitcnt vmcnt(4)
buffer_load_dwordx4 v1, s[20:23], s45 offen offset:1024 nt lds
v_mfma_f32_16x16x32_bf16 v[16:19], a[224:227], v[128:131], v[16:19]
v_exp_f32 v120, v120
v_mfma_f32_16x16x32_bf16 v[20:23], a[228:231], v[128:131], v[20:23]
ds_read_b64_tr_b16 a[196:197], v3 offset:33824
v_mfma_f32_16x16x32_bf16 v[24:27], a[232:235], v[128:131], v[24:27]
v_exp_f32 v121, v121
v_mfma_f32_16x16x32_bf16 v[28:31], a[236:239], v[128:131], v[28:31]
v_cvt_pk_bf16_f32 v132, v120, v121
s_add_u32 m0, s47, 32
v_mfma_f32_16x16x32_bf16 a[0:3], a[240:243], v[128:131], a[0:3]
v_exp_f32 v122, v122
v_mfma_f32_16x16x32_bf16 a[4:7], a[244:247], v[128:131], a[4:7]
ds_read_b64_tr_b16 a[198:199], v3 offset:34080
s_waitcnt vmcnt(4)
buffer_load_dwordx4 v1, s[20:23], s45 offen offset:2048 nt lds
v_mfma_f32_16x16x32_bf16 a[8:11], a[248:251], v[128:131], a[8:11]
v_exp_f32 v123, v123
v_mfma_f32_16x16x32_bf16 a[12:15], a[252:255], v[128:131], a[12:15]
v_cvt_pk_bf16_f32 v133, v122, v123
v_mfma_f32_16x16x32_bf16 v[160:163], v[184:187], v[128:131], v[160:163]
v_exp_f32 v124, v124
v_mfma_f32_16x16x32_bf16 v[112:115], v[220:223], a[128:131], v[144:147]
ds_read_b64_tr_b16 a[200:201], v3 offset:33856
v_mfma_f32_16x16x32_bf16 v[112:115], v[224:227], a[132:135], v[112:115]
v_exp_f32 v125, v125
v_mfma_f32_16x16x32_bf16 v[112:115], v[228:231], a[136:139], v[112:115]
v_cvt_pk_bf16_f32 v134, v124, v125
v_mfma_f32_16x16x32_bf16 v[112:115], v[232:235], a[140:143], v[112:115]
v_exp_f32 v126, v126
v_mfma_f32_16x16x32_bf16 v[116:119], v[236:239], a[128:131], v[144:147]
ds_read_b64_tr_b16 a[202:203], v3 offset:34112
v_mfma_f32_16x16x32_bf16 v[116:119], v[240:243], a[132:135], v[116:119]
v_exp_f32 v127, v127
v_mfma_f32_16x16x32_bf16 v[116:119], v[244:247], a[136:139], v[116:119]
v_cvt_pk_bf16_f32 v135, v126, v127
s_add_u32 m0, s47, 48
v_mfma_f32_16x16x32_bf16 v[116:119], v[248:251], a[140:143], v[116:119]
s_waitcnt vmcnt(4)
buffer_load_dwordx4 v1, s[20:23], s45 offen offset:3072 nt lds
v_mfma_f32_16x16x32_bf16 v[32:35], a[224:227], v[132:135], v[32:35]
v_exp_f32 v112, v112
v_mfma_f32_16x16x32_bf16 v[36:39], a[228:231], v[132:135], v[36:39]
ds_read_b64_tr_b16 a[204:205], v3 offset:33888
v_mfma_f32_16x16x32_bf16 v[40:43], a[232:235], v[132:135], v[40:43]
v_exp_f32 v113, v113
v_mfma_f32_16x16x32_bf16 v[44:47], a[236:239], v[132:135], v[44:47]
v_cvt_pk_bf16_f32 v128, v112, v113
v_mfma_f32_16x16x32_bf16 a[16:19], a[240:243], v[132:135], a[16:19]
v_exp_f32 v114, v114
v_mfma_f32_16x16x32_bf16 a[20:23], a[244:247], v[132:135], a[20:23]
ds_read_b64_tr_b16 a[206:207], v3 offset:34144
v_mfma_f32_16x16x32_bf16 a[24:27], a[248:251], v[132:135], a[24:27]
v_exp_f32 v115, v115
v_mfma_f32_16x16x32_bf16 a[28:31], a[252:255], v[132:135], a[28:31]
v_cvt_pk_bf16_f32 v129, v114, v115
v_mfma_f32_16x16x32_bf16 v[164:167], v[184:187], v[132:135], v[164:167]
v_exp_f32 v116, v116
v_mfma_f32_16x16x32_bf16 v[120:123], v[220:223], a[144:147], v[148:151]
ds_read_b64_tr_b16 a[208:209], v4 offset:33792
v_mfma_f32_16x16x32_bf16 v[120:123], v[224:227], a[148:151], v[120:123]
v_exp_f32 v117, v117
v_mfma_f32_16x16x32_bf16 v[120:123], v[228:231], a[152:155], v[120:123]
v_cvt_pk_bf16_f32 v130, v116, v117
v_mfma_f32_16x16x32_bf16 v[120:123], v[232:235], a[156:159], v[120:123]
v_exp_f32 v118, v118
v_mfma_f32_16x16x32_bf16 v[124:127], v[236:239], a[144:147], v[148:151]
ds_read_b64_tr_b16 a[210:211], v4 offset:34048
v_mfma_f32_16x16x32_bf16 v[124:127], v[240:243], a[148:151], v[124:127]
v_exp_f32 v119, v119
v_mfma_f32_16x16x32_bf16 v[124:127], v[244:247], a[152:155], v[124:127]
v_cvt_pk_bf16_f32 v131, v118, v119
s_add_u32 m0, s48, 0
v_mfma_f32_16x16x32_bf16 v[124:127], v[248:251], a[156:159], v[124:127]
s_waitcnt vmcnt(4)
buffer_load_dwordx4 v1, s[24:27], s45 offen offset:0 nt lds
v_mfma_f32_16x16x32_bf16 v[48:51], a[224:227], v[128:131], v[48:51]
v_exp_f32 v120, v120
v_mfma_f32_16x16x32_bf16 v[52:55], a[228:231], v[128:131], v[52:55]
ds_read_b64_tr_b16 a[212:213], v4 offset:33824
v_mfma_f32_16x16x32_bf16 v[56:59], a[232:235], v[128:131], v[56:59]
v_exp_f32 v121, v121
v_mfma_f32_16x16x32_bf16 v[60:63], a[236:239], v[128:131], v[60:63]
v_cvt_pk_bf16_f32 v132, v120, v121
v_mfma_f32_16x16x32_bf16 a[32:35], a[240:243], v[128:131], a[32:35]
v_exp_f32 v122, v122
v_mfma_f32_16x16x32_bf16 a[36:39], a[244:247], v[128:131], a[36:39]
ds_read_b64_tr_b16 a[214:215], v4 offset:34080
v_mfma_f32_16x16x32_bf16 a[40:43], a[248:251], v[128:131], a[40:43]
v_exp_f32 v123, v123
v_mfma_f32_16x16x32_bf16 a[44:47], a[252:255], v[128:131], a[44:47]
v_cvt_pk_bf16_f32 v133, v122, v123
v_mfma_f32_16x16x32_bf16 v[168:171], v[184:187], v[128:131], v[168:171]
v_exp_f32 v124, v124
v_mfma_f32_16x16x32_bf16 v[112:115], v[220:223], a[160:163], v[152:155]
ds_read_b64_tr_b16 a[216:217], v4 offset:33856
v_mfma_f32_16x16x32_bf16 v[112:115], v[224:227], a[164:167], v[112:115]
v_exp_f32 v125, v125
v_mfma_f32_16x16x32_bf16 v[112:115], v[228:231], a[168:171], v[112:115]
v_cvt_pk_bf16_f32 v134, v124, v125
v_mfma_f32_16x16x32_bf16 v[112:115], v[232:235], a[172:175], v[112:115]
v_exp_f32 v126, v126
v_mfma_f32_16x16x32_bf16 v[116:119], v[236:239], a[160:163], v[152:155]
ds_read_b64_tr_b16 a[218:219], v4 offset:34112
v_mfma_f32_16x16x32_bf16 v[116:119], v[240:243], a[164:167], v[116:119]
v_exp_f32 v127, v127
v_mfma_f32_16x16x32_bf16 v[116:119], v[244:247], a[168:171], v[116:119]
v_cvt_pk_bf16_f32 v135, v126, v127
s_add_u32 m0, s48, 32
v_mfma_f32_16x16x32_bf16 v[116:119], v[248:251], a[172:175], v[116:119]
s_waitcnt vmcnt(4)
buffer_load_dwordx4 v1, s[24:27], s45 offen offset:1024 nt lds
v_mfma_f32_16x16x32_bf16 v[64:67], a[224:227], v[132:135], v[64:67]
v_exp_f32 v112, v112
v_mfma_f32_16x16x32_bf16 v[68:71], a[228:231], v[132:135], v[68:71]
ds_read_b64_tr_b16 a[220:221], v4 offset:33888
v_mfma_f32_16x16x32_bf16 v[72:75], a[232:235], v[132:135], v[72:75]
v_exp_f32 v113, v113
v_mfma_f32_16x16x32_bf16 v[76:79], a[236:239], v[132:135], v[76:79]
v_cvt_pk_bf16_f32 v128, v112, v113
s_add_u32 m0, s48, 64
v_mfma_f32_16x16x32_bf16 a[48:51], a[240:243], v[132:135], a[48:51]
v_exp_f32 v114, v114
v_mfma_f32_16x16x32_bf16 a[52:55], a[244:247], v[132:135], a[52:55]
ds_read_b64_tr_b16 a[222:223], v4 offset:34144
s_waitcnt vmcnt(4)
buffer_load_dwordx4 v1, s[24:27], s45 offen offset:2048 nt lds
v_mfma_f32_16x16x32_bf16 a[56:59], a[248:251], v[132:135], a[56:59]
v_exp_f32 v115, v115
v_mfma_f32_16x16x32_bf16 a[60:63], a[252:255], v[132:135], a[60:63]
v_cvt_pk_bf16_f32 v129, v114, v115
v_mfma_f32_16x16x32_bf16 v[172:175], v[184:187], v[132:135], v[172:175]
v_exp_f32 v116, v116
v_mfma_f32_16x16x32_bf16 v[120:123], v[220:223], a[176:179], v[156:159]
v_mfma_f32_16x16x32_bf16 v[120:123], v[224:227], a[180:183], v[120:123]
v_exp_f32 v117, v117
v_mfma_f32_16x16x32_bf16 v[120:123], v[228:231], a[184:187], v[120:123]
v_cvt_pk_bf16_f32 v130, v116, v117
v_mfma_f32_16x16x32_bf16 v[120:123], v[232:235], a[188:191], v[120:123]
v_exp_f32 v118, v118
v_mfma_f32_16x16x32_bf16 v[124:127], v[236:239], a[176:179], v[156:159]
v_mfma_f32_16x16x32_bf16 v[124:127], v[240:243], a[180:183], v[124:127]
v_exp_f32 v119, v119
v_mfma_f32_16x16x32_bf16 v[124:127], v[244:247], a[184:187], v[124:127]
v_cvt_pk_bf16_f32 v131, v118, v119
s_add_u32 m0, s48, 96
v_mfma_f32_16x16x32_bf16 v[124:127], v[248:251], a[188:191], v[124:127]
s_waitcnt vmcnt(4)
buffer_load_dwordx4 v1, s[24:27], s45 offen offset:3072 nt lds
v_mfma_f32_16x16x32_bf16 v[80:83], a[224:227], v[128:131], v[80:83]
v_exp_f32 v120, v120
v_mfma_f32_16x16x32_bf16 v[84:87], a[228:231], v[128:131], v[84:87]
v_mfma_f32_16x16x32_bf16 v[88:91], a[232:235], v[128:131], v[88:91]
v_exp_f32 v121, v121
v_mfma_f32_16x16x32_bf16 v[92:95], a[236:239], v[128:131], v[92:95]
v_cvt_pk_bf16_f32 v132, v120, v121
s_add_u32 s45, s45, 16384
v_mfma_f32_16x16x32_bf16 a[64:67], a[240:243], v[128:131], a[64:67]
v_exp_f32 v122, v122
v_mfma_f32_16x16x32_bf16 a[68:71], a[244:247], v[128:131], a[68:71]
v_mfma_f32_16x16x32_bf16 a[72:75], a[248:251], v[128:131], a[72:75]
v_exp_f32 v123, v123
v_mfma_f32_16x16x32_bf16 a[76:79], a[252:255], v[128:131], a[76:79]
v_cvt_pk_bf16_f32 v133, v122, v123
v_mfma_f32_16x16x32_bf16 v[176:179], v[184:187], v[128:131], v[176:179]
v_exp_f32 v124, v124
s_waitcnt vmcnt(8) lgkmcnt(0)
s_barrier
v_mfma_f32_16x16x32_bf16 v[112:115], v[188:191], a[96:99], v[136:139]
ds_read_b128 v[220:223], v2 offset:49920
ds_read_b128 v[224:227], v2 offset:49936
v_mfma_f32_16x16x32_bf16 v[112:115], v[192:195], a[100:103], v[112:115]
v_exp_f32 v125, v125
v_mfma_f32_16x16x32_bf16 v[112:115], v[196:199], a[104:107], v[112:115]
v_cvt_pk_bf16_f32 v134, v124, v125
v_mfma_f32_16x16x32_bf16 v[112:115], v[200:203], a[108:111], v[112:115]
v_exp_f32 v126, v126
v_mfma_f32_16x16x32_bf16 v[116:119], v[204:207], a[96:99], v[136:139]
ds_read_b128 v[228:231], v2 offset:49952
ds_read_b128 v[232:235], v2 offset:49968
v_mfma_f32_16x16x32_bf16 v[116:119], v[208:211], a[100:103], v[116:119]
v_exp_f32 v127, v127
v_mfma_f32_16x16x32_bf16 v[116:119], v[212:215], a[104:107], v[116:119]
v_cvt_pk_bf16_f32 v135, v126, v127
s_add_u32 m0, s47, 16640
v_mfma_f32_16x16x32_bf16 v[116:119], v[216:219], a[108:111], v[116:119]
s_waitcnt vmcnt(4)
buffer_load_dwordx4 v1, s[20:23], s45 offen offset:0 nt lds
v_mfma_f32_16x16x32_bf16 v[96:99], a[224:227], v[132:135], v[96:99]
v_exp_f32 v112, v112
v_mfma_f32_16x16x32_bf16 v[100:103], a[228:231], v[132:135], v[100:103]
ds_read_b128 v[236:239], v2 offset:50176
ds_read_b128 v[240:243], v2 offset:50192
v_mfma_f32_16x16x32_bf16 v[104:107], a[232:235], v[132:135], v[104:107]
v_exp_f32 v113, v113
v_mfma_f32_16x16x32_bf16 v[108:111], a[236:239], v[132:135], v[108:111]
v_cvt_pk_bf16_f32 v128, v112, v113
v_mfma_f32_16x16x32_bf16 a[80:83], a[240:243], v[132:135], a[80:83]
v_exp_f32 v114, v114
v_mfma_f32_16x16x32_bf16 a[84:87], a[244:247], v[132:135], a[84:87]
ds_read_b128 v[244:247], v2 offset:50208
ds_read_b128 v[248:251], v2 offset:50224
v_mfma_f32_16x16x32_bf16 a[88:91], a[248:251], v[132:135], a[88:91]
v_exp_f32 v115, v115
v_mfma_f32_16x16x32_bf16 a[92:95], a[252:255], v[132:135], a[92:95]
v_cvt_pk_bf16_f32 v129, v114, v115
v_mfma_f32_16x16x32_bf16 v[180:183], v[184:187], v[132:135], v[180:183]
v_exp_f32 v116, v116
v_mfma_f32_16x16x32_bf16 v[120:123], v[188:191], a[112:115], v[140:143]
ds_read_b64_tr_b16 a[224:225], v3 offset:50688
v_mfma_f32_16x16x32_bf16 v[120:123], v[192:195], a[116:119], v[120:123]
v_exp_f32 v117, v117
v_mfma_f32_16x16x32_bf16 v[120:123], v[196:199], a[120:123], v[120:123]
v_cvt_pk_bf16_f32 v130, v116, v117
v_mfma_f32_16x16x32_bf16 v[120:123], v[200:203], a[124:127], v[120:123]
v_exp_f32 v118, v118
v_mfma_f32_16x16x32_bf16 v[124:127], v[204:207], a[112:115], v[140:143]
ds_read_b64_tr_b16 a[226:227], v3 offset:50944
v_mfma_f32_16x16x32_bf16 v[124:127], v[208:211], a[116:119], v[124:127]
v_exp_f32 v119, v119
v_mfma_f32_16x16x32_bf16 v[124:127], v[212:215], a[120:123], v[124:127]
v_cvt_pk_bf16_f32 v131, v118, v119
s_add_u32 m0, s47, 16656
v_mfma_f32_16x16x32_bf16 v[124:127], v[216:219], a[124:127], v[124:127]
s_waitcnt vmcnt(4)
buffer_load_dwordx4 v1, s[20:23], s45 offen offset:1024 nt lds
v_mfma_f32_16x16x32_bf16 v[16:19], a[192:195], v[128:131], v[16:19]
v_exp_f32 v120, v120
v_mfma_f32_16x16x32_bf16 v[20:23], a[196:199], v[128:131], v[20:23]
ds_read_b64_tr_b16 a[228:229], v3 offset:50720
v_mfma_f32_16x16x32_bf16 v[24:27], a[200:203], v[128:131], v[24:27]
v_exp_f32 v121, v121
v_mfma_f32_16x16x32_bf16 v[28:31], a[204:207], v[128:131], v[28:31]
v_cvt_pk_bf16_f32 v132, v120, v121
s_add_u32 m0, s47, 16672
v_mfma_f32_16x16x32_bf16 a[0:3], a[208:211], v[128:131], a[0:3]
v_exp_f32 v122, v122
v_mfma_f32_16x16x32_bf16 a[4:7], a[212:215], v[128:131], a[4:7]
ds_read_b64_tr_b16 a[230:231], v3 offset:50976
s_waitcnt vmcnt(4)
buffer_load_dwordx4 v1, s[20:23], s45 offen offset:2048 nt lds
v_mfma_f32_16x16x32_bf16 a[8:11], a[216:219], v[128:131], a[8:11]
v_exp_f32 v123, v123
v_mfma_f32_16x16x32_bf16 a[12:15], a[220:223], v[128:131], a[12:15]
v_cvt_pk_bf16_f32 v133, v122, v123
v_mfma_f32_16x16x32_bf16 v[160:163], v[184:187], v[128:131], v[160:163]
v_exp_f32 v124, v124
v_mfma_f32_16x16x32_bf16 v[112:115], v[188:191], a[128:131], v[144:147]
ds_read_b64_tr_b16 a[232:233], v3 offset:50752
v_mfma_f32_16x16x32_bf16 v[112:115], v[192:195], a[132:135], v[112:115]
v_exp_f32 v125, v125
v_mfma_f32_16x16x32_bf16 v[112:115], v[196:199], a[136:139], v[112:115]
v_cvt_pk_bf16_f32 v134, v124, v125
v_mfma_f32_16x16x32_bf16 v[112:115], v[200:203], a[140:143], v[112:115]
v_exp_f32 v126, v126
v_mfma_f32_16x16x32_bf16 v[116:119], v[204:207], a[128:131], v[144:147]
ds_read_b64_tr_b16 a[234:235], v3 offset:51008
v_mfma_f32_16x16x32_bf16 v[116:119], v[208:211], a[132:135], v[116:119]
v_exp_f32 v127, v127
v_mfma_f32_16x16x32_bf16 v[116:119], v[212:215], a[136:139], v[116:119]
v_cvt_pk_bf16_f32 v135, v126, v127
s_add_u32 m0, s47, 16688
v_mfma_f32_16x16x32_bf16 v[116:119], v[216:219], a[140:143], v[116:119]
s_waitcnt vmcnt(4)
buffer_load_dwordx4 v1, s[20:23], s45 offen offset:3072 nt lds
v_mfma_f32_16x16x32_bf16 v[32:35], a[192:195], v[132:135], v[32:35]
v_exp_f32 v112, v112
v_mfma_f32_16x16x32_bf16 v[36:39], a[196:199], v[132:135], v[36:39]
ds_read_b64_tr_b16 a[236:237], v3 offset:50784
v_mfma_f32_16x16x32_bf16 v[40:43], a[200:203], v[132:135], v[40:43]
v_exp_f32 v113, v113
v_mfma_f32_16x16x32_bf16 v[44:47], a[204:207], v[132:135], v[44:47]
v_cvt_pk_bf16_f32 v128, v112, v113
v_mfma_f32_16x16x32_bf16 a[16:19], a[208:211], v[132:135], a[16:19]
v_exp_f32 v114, v114
v_mfma_f32_16x16x32_bf16 a[20:23], a[212:215], v[132:135], a[20:23]
ds_read_b64_tr_b16 a[238:239], v3 offset:51040
v_mfma_f32_16x16x32_bf16 a[24:27], a[216:219], v[132:135], a[24:27]
v_exp_f32 v115, v115
v_mfma_f32_16x16x32_bf16 a[28:31], a[220:223], v[132:135], a[28:31]
v_cvt_pk_bf16_f32 v129, v114, v115
v_mfma_f32_16x16x32_bf16 v[164:167], v[184:187], v[132:135], v[164:167]
v_exp_f32 v116, v116
v_mfma_f32_16x16x32_bf16 v[120:123], v[188:191], a[144:147], v[148:151]
ds_read_b64_tr_b16 a[240:241], v4 offset:50688
v_mfma_f32_16x16x32_bf16 v[120:123], v[192:195], a[148:151], v[120:123]
v_exp_f32 v117, v117
v_mfma_f32_16x16x32_bf16 v[120:123], v[196:199], a[152:155], v[120:123]
v_cvt_pk_bf16_f32 v130, v116, v117
v_mfma_f32_16x16x32_bf16 v[120:123], v[200:203], a[156:159], v[120:123]
v_exp_f32 v118, v118
v_mfma_f32_16x16x32_bf16 v[124:127], v[204:207], a[144:147], v[148:151]
ds_read_b64_tr_b16 a[242:243], v4 offset:50944
v_mfma_f32_16x16x32_bf16 v[124:127], v[208:211], a[148:151], v[124:127]
v_exp_f32 v119, v119
v_mfma_f32_16x16x32_bf16 v[124:127], v[212:215], a[152:155], v[124:127]
v_cvt_pk_bf16_f32 v131, v118, v119
s_add_u32 m0, s48, 16896
v_mfma_f32_16x16x32_bf16 v[124:127], v[216:219], a[156:159], v[124:127]
s_waitcnt vmcnt(4)
buffer_load_dwordx4 v1, s[24:27], s45 offen offset:0 nt lds
v_mfma_f32_16x16x32_bf16 v[48:51], a[192:195], v[128:131], v[48:51]
v_exp_f32 v120, v120
v_mfma_f32_16x16x32_bf16 v[52:55], a[196:199], v[128:131], v[52:55]
ds_read_b64_tr_b16 a[244:245], v4 offset:50720
v_mfma_f32_16x16x32_bf16 v[56:59], a[200:203], v[128:131], v[56:59]
v_exp_f32 v121, v121
v_mfma_f32_16x16x32_bf16 v[60:63], a[204:207], v[128:131], v[60:63]
v_cvt_pk_bf16_f32 v132, v120, v121
v_mfma_f32_16x16x32_bf16 a[32:35], a[208:211], v[128:131], a[32:35]
v_exp_f32 v122, v122
v_mfma_f32_16x16x32_bf16 a[36:39], a[212:215], v[128:131], a[36:39]
ds_read_b64_tr_b16 a[246:247], v4 offset:50976
v_mfma_f32_16x16x32_bf16 a[40:43], a[216:219], v[128:131], a[40:43]
v_exp_f32 v123, v123
v_mfma_f32_16x16x32_bf16 a[44:47], a[220:223], v[128:131], a[44:47]
v_cvt_pk_bf16_f32 v133, v122, v123
v_mfma_f32_16x16x32_bf16 v[168:171], v[184:187], v[128:131], v[168:171]
v_exp_f32 v124, v124
v_mfma_f32_16x16x32_bf16 v[112:115], v[188:191], a[160:163], v[152:155]
ds_read_b64_tr_b16 a[248:249], v4 offset:50752
v_mfma_f32_16x16x32_bf16 v[112:115], v[192:195], a[164:167], v[112:115]
v_exp_f32 v125, v125
v_mfma_f32_16x16x32_bf16 v[112:115], v[196:199], a[168:171], v[112:115]
v_cvt_pk_bf16_f32 v134, v124, v125
v_mfma_f32_16x16x32_bf16 v[112:115], v[200:203], a[172:175], v[112:115]
v_exp_f32 v126, v126
v_mfma_f32_16x16x32_bf16 v[116:119], v[204:207], a[160:163], v[152:155]
ds_read_b64_tr_b16 a[250:251], v4 offset:51008
v_mfma_f32_16x16x32_bf16 v[116:119], v[208:211], a[164:167], v[116:119]
v_exp_f32 v127, v127
v_mfma_f32_16x16x32_bf16 v[116:119], v[212:215], a[168:171], v[116:119]
v_cvt_pk_bf16_f32 v135, v126, v127
s_add_u32 m0, s48, 16928
v_mfma_f32_16x16x32_bf16 v[116:119], v[216:219], a[172:175], v[116:119]
s_waitcnt vmcnt(4)
buffer_load_dwordx4 v1, s[24:27], s45 offen offset:1024 nt lds
v_mfma_f32_16x16x32_bf16 v[64:67], a[192:195], v[132:135], v[64:67]
v_exp_f32 v112, v112
v_mfma_f32_16x16x32_bf16 v[68:71], a[196:199], v[132:135], v[68:71]
ds_read_b64_tr_b16 a[252:253], v4 offset:50784
v_mfma_f32_16x16x32_bf16 v[72:75], a[200:203], v[132:135], v[72:75]
v_exp_f32 v113, v113
v_mfma_f32_16x16x32_bf16 v[76:79], a[204:207], v[132:135], v[76:79]
v_cvt_pk_bf16_f32 v128, v112, v113
s_add_u32 m0, s48, 16960
v_mfma_f32_16x16x32_bf16 a[48:51], a[208:211], v[132:135], a[48:51]
v_exp_f32 v114, v114
v_mfma_f32_16x16x32_bf16 a[52:55], a[212:215], v[132:135], a[52:55]
ds_read_b64_tr_b16 a[254:255], v4 offset:51040
s_waitcnt vmcnt(4)
buffer_load_dwordx4 v1, s[24:27], s45 offen offset:2048 nt lds
v_mfma_f32_16x16x32_bf16 a[56:59], a[216:219], v[132:135], a[56:59]
v_exp_f32 v115, v115
v_mfma_f32_16x16x32_bf16 a[60:63], a[220:223], v[132:135], a[60:63]
v_cvt_pk_bf16_f32 v129, v114, v115
v_mfma_f32_16x16x32_bf16 v[172:175], v[184:187], v[132:135], v[172:175]
v_exp_f32 v116, v116
v_mfma_f32_16x16x32_bf16 v[120:123], v[188:191], a[176:179], v[156:159]
v_mfma_f32_16x16x32_bf16 v[120:123], v[192:195], a[180:183], v[120:123]
v_exp_f32 v117, v117
v_mfma_f32_16x16x32_bf16 v[120:123], v[196:199], a[184:187], v[120:123]
v_cvt_pk_bf16_f32 v130, v116, v117
v_mfma_f32_16x16x32_bf16 v[120:123], v[200:203], a[188:191], v[120:123]
v_exp_f32 v118, v118
v_mfma_f32_16x16x32_bf16 v[124:127], v[204:207], a[176:179], v[156:159]
v_mfma_f32_16x16x32_bf16 v[124:127], v[208:211], a[180:183], v[124:127]
v_exp_f32 v119, v119
v_mfma_f32_16x16x32_bf16 v[124:127], v[212:215], a[184:187], v[124:127]
v_cvt_pk_bf16_f32 v131, v118, v119
s_add_u32 m0, s48, 16992
v_mfma_f32_16x16x32_bf16 v[124:127], v[216:219], a[188:191], v[124:127]
s_waitcnt vmcnt(4)
buffer_load_dwordx4 v1, s[24:27], s45 offen offset:3072 nt lds
v_mfma_f32_16x16x32_bf16 v[80:83], a[192:195], v[128:131], v[80:83]
v_exp_f32 v120, v120
v_mfma_f32_16x16x32_bf16 v[84:87], a[196:199], v[128:131], v[84:87]
v_mfma_f32_16x16x32_bf16 v[88:91], a[200:203], v[128:131], v[88:91]
v_exp_f32 v121, v121
v_mfma_f32_16x16x32_bf16 v[92:95], a[204:207], v[128:131], v[92:95]
v_cvt_pk_bf16_f32 v132, v120, v121
s_add_u32 s45, s45, 16384
v_mfma_f32_16x16x32_bf16 a[64:67], a[208:211], v[128:131], a[64:67]
v_exp_f32 v122, v122
v_mfma_f32_16x16x32_bf16 a[68:71], a[212:215], v[128:131], a[68:71]
v_mfma_f32_16x16x32_bf16 a[72:75], a[216:219], v[128:131], a[72:75]
v_exp_f32 v123, v123
v_mfma_f32_16x16x32_bf16 a[76:79], a[220:223], v[128:131], a[76:79]
v_cvt_pk_bf16_f32 v133, v122, v123
v_mfma_f32_16x16x32_bf16 v[176:179], v[184:187], v[128:131], v[176:179]
v_exp_f32 v124, v124
s_waitcnt vmcnt(8) lgkmcnt(0)
s_barrier
v_mfma_f32_16x16x32_bf16 v[112:115], v[220:223], a[96:99], v[136:139]
ds_read_b128 v[188:191], v2 offset:0
ds_read_b128 v[192:195], v2 offset:16
v_mfma_f32_16x16x32_bf16 v[112:115], v[224:227], a[100:103], v[112:115]
v_exp_f32 v125, v125
v_mfma_f32_16x16x32_bf16 v[112:115], v[228:231], a[104:107], v[112:115]
v_cvt_pk_bf16_f32 v134, v124, v125
v_mfma_f32_16x16x32_bf16 v[112:115], v[232:235], a[108:111], v[112:115]
v_exp_f32 v126, v126
v_mfma_f32_16x16x32_bf16 v[116:119], v[236:239], a[96:99], v[136:139]
ds_read_b128 v[196:199], v2 offset:32
ds_read_b128 v[200:203], v2 offset:48
v_mfma_f32_16x16x32_bf16 v[116:119], v[240:243], a[100:103], v[116:119]
v_exp_f32 v127, v127
v_mfma_f32_16x16x32_bf16 v[116:119], v[244:247], a[104:107], v[116:119]
v_cvt_pk_bf16_f32 v135, v126, v127
s_add_u32 m0, s47, 33280
v_mfma_f32_16x16x32_bf16 v[116:119], v[248:251], a[108:111], v[116:119]
s_waitcnt vmcnt(4)
buffer_load_dwordx4 v1, s[20:23], s45 offen offset:0 nt lds
v_mfma_f32_16x16x32_bf16 v[96:99], a[192:195], v[132:135], v[96:99]
v_exp_f32 v112, v112
v_mfma_f32_16x16x32_bf16 v[100:103], a[196:199], v[132:135], v[100:103]
ds_read_b128 v[204:207], v2 offset:256
ds_read_b128 v[208:211], v2 offset:272
v_mfma_f32_16x16x32_bf16 v[104:107], a[200:203], v[132:135], v[104:107]
v_exp_f32 v113, v113
v_mfma_f32_16x16x32_bf16 v[108:111], a[204:207], v[132:135], v[108:111]
v_cvt_pk_bf16_f32 v128, v112, v113
v_mfma_f32_16x16x32_bf16 a[80:83], a[208:211], v[132:135], a[80:83]
v_exp_f32 v114, v114
v_mfma_f32_16x16x32_bf16 a[84:87], a[212:215], v[132:135], a[84:87]
ds_read_b128 v[212:215], v2 offset:288
ds_read_b128 v[216:219], v2 offset:304
v_mfma_f32_16x16x32_bf16 a[88:91], a[216:219], v[132:135], a[88:91]
v_exp_f32 v115, v115
v_mfma_f32_16x16x32_bf16 a[92:95], a[220:223], v[132:135], a[92:95]
v_cvt_pk_bf16_f32 v129, v114, v115
v_mfma_f32_16x16x32_bf16 v[180:183], v[184:187], v[132:135], v[180:183]
v_exp_f32 v116, v116
v_mfma_f32_16x16x32_bf16 v[120:123], v[220:223], a[112:115], v[140:143]
ds_read_b64_tr_b16 a[192:193], v3 offset:0
v_mfma_f32_16x16x32_bf16 v[120:123], v[224:227], a[116:119], v[120:123]
v_exp_f32 v117, v117
v_mfma_f32_16x16x32_bf16 v[120:123], v[228:231], a[120:123], v[120:123]
v_cvt_pk_bf16_f32 v130, v116, v117
v_mfma_f32_16x16x32_bf16 v[120:123], v[232:235], a[124:127], v[120:123]
v_exp_f32 v118, v118
v_mfma_f32_16x16x32_bf16 v[124:127], v[236:239], a[112:115], v[140:143]
ds_read_b64_tr_b16 a[194:195], v3 offset:256
v_mfma_f32_16x16x32_bf16 v[124:127], v[240:243], a[116:119], v[124:127]
v_exp_f32 v119, v119
v_mfma_f32_16x16x32_bf16 v[124:127], v[244:247], a[120:123], v[124:127]
v_cvt_pk_bf16_f32 v131, v118, v119
s_add_u32 m0, s47, 33296
v_mfma_f32_16x16x32_bf16 v[124:127], v[248:251], a[124:127], v[124:127]
s_waitcnt vmcnt(4)
buffer_load_dwordx4 v1, s[20:23], s45 offen offset:1024 nt lds
v_mfma_f32_16x16x32_bf16 v[16:19], a[224:227], v[128:131], v[16:19]
v_exp_f32 v120, v120
v_mfma_f32_16x16x32_bf16 v[20:23], a[228:231], v[128:131], v[20:23]
ds_read_b64_tr_b16 a[196:197], v3 offset:32
v_mfma_f32_16x16x32_bf16 v[24:27], a[232:235], v[128:131], v[24:27]
v_exp_f32 v121, v121
v_mfma_f32_16x16x32_bf16 v[28:31], a[236:239], v[128:131], v[28:31]
v_cvt_pk_bf16_f32 v132, v120, v121
s_add_u32 m0, s47, 33312
v_mfma_f32_16x16x32_bf16 a[0:3], a[240:243], v[128:131], a[0:3]
v_exp_f32 v122, v122
v_mfma_f32_16x16x32_bf16 a[4:7], a[244:247], v[128:131], a[4:7]
ds_read_b64_tr_b16 a[198:199], v3 offset:288
s_waitcnt vmcnt(4)
buffer_load_dwordx4 v1, s[20:23], s45 offen offset:2048 nt lds
v_mfma_f32_16x16x32_bf16 a[8:11], a[248:251], v[128:131], a[8:11]
v_exp_f32 v123, v123
v_mfma_f32_16x16x32_bf16 a[12:15], a[252:255], v[128:131], a[12:15]
v_cvt_pk_bf16_f32 v133, v122, v123
v_mfma_f32_16x16x32_bf16 v[160:163], v[184:187], v[128:131], v[160:163]
v_exp_f32 v124, v124
v_mfma_f32_16x16x32_bf16 v[112:115], v[220:223], a[128:131], v[144:147]
ds_read_b64_tr_b16 a[200:201], v3 offset:64
v_mfma_f32_16x16x32_bf16 v[112:115], v[224:227], a[132:135], v[112:115]
v_exp_f32 v125, v125
v_mfma_f32_16x16x32_bf16 v[112:115], v[228:231], a[136:139], v[112:115]
v_cvt_pk_bf16_f32 v134, v124, v125
v_mfma_f32_16x16x32_bf16 v[112:115], v[232:235], a[140:143], v[112:115]
v_exp_f32 v126, v126
v_mfma_f32_16x16x32_bf16 v[116:119], v[236:239], a[128:131], v[144:147]
ds_read_b64_tr_b16 a[202:203], v3 offset:320
v_mfma_f32_16x16x32_bf16 v[116:119], v[240:243], a[132:135], v[116:119]
v_exp_f32 v127, v127
v_mfma_f32_16x16x32_bf16 v[116:119], v[244:247], a[136:139], v[116:119]
v_cvt_pk_bf16_f32 v135, v126, v127
s_add_u32 m0, s47, 33328
v_mfma_f32_16x16x32_bf16 v[116:119], v[248:251], a[140:143], v[116:119]
s_waitcnt vmcnt(4)
buffer_load_dwordx4 v1, s[20:23], s45 offen offset:3072 nt lds
v_mfma_f32_16x16x32_bf16 v[32:35], a[224:227], v[132:135], v[32:35]
v_exp_f32 v112, v112
v_mfma_f32_16x16x32_bf16 v[36:39], a[228:231], v[132:135], v[36:39]
ds_read_b64_tr_b16 a[204:205], v3 offset:96
v_mfma_f32_16x16x32_bf16 v[40:43], a[232:235], v[132:135], v[40:43]
v_exp_f32 v113, v113
v_mfma_f32_16x16x32_bf16 v[44:47], a[236:239], v[132:135], v[44:47]
v_cvt_pk_bf16_f32 v128, v112, v113
v_mfma_f32_16x16x32_bf16 a[16:19], a[240:243], v[132:135], a[16:19]
v_exp_f32 v114, v114
v_mfma_f32_16x16x32_bf16 a[20:23], a[244:247], v[132:135], a[20:23]
ds_read_b64_tr_b16 a[206:207], v3 offset:352
v_mfma_f32_16x16x32_bf16 a[24:27], a[248:251], v[132:135], a[24:27]
v_exp_f32 v115, v115
v_mfma_f32_16x16x32_bf16 a[28:31], a[252:255], v[132:135], a[28:31]
v_cvt_pk_bf16_f32 v129, v114, v115
v_mfma_f32_16x16x32_bf16 v[164:167], v[184:187], v[132:135], v[164:167]
v_exp_f32 v116, v116
v_mfma_f32_16x16x32_bf16 v[120:123], v[220:223], a[144:147], v[148:151]
ds_read_b64_tr_b16 a[208:209], v4 offset:0
v_mfma_f32_16x16x32_bf16 v[120:123], v[224:227], a[148:151], v[120:123]
v_exp_f32 v117, v117
v_mfma_f32_16x16x32_bf16 v[120:123], v[228:231], a[152:155], v[120:123]
v_cvt_pk_bf16_f32 v130, v116, v117
v_mfma_f32_16x16x32_bf16 v[120:123], v[232:235], a[156:159], v[120:123]
v_exp_f32 v118, v118
v_mfma_f32_16x16x32_bf16 v[124:127], v[236:239], a[144:147], v[148:151]
ds_read_b64_tr_b16 a[210:211], v4 offset:256
v_mfma_f32_16x16x32_bf16 v[124:127], v[240:243], a[148:151], v[124:127]
v_exp_f32 v119, v119
v_mfma_f32_16x16x32_bf16 v[124:127], v[244:247], a[152:155], v[124:127]
v_cvt_pk_bf16_f32 v131, v118, v119
s_add_u32 m0, s48, 33792
v_mfma_f32_16x16x32_bf16 v[124:127], v[248:251], a[156:159], v[124:127]
s_waitcnt vmcnt(4)
buffer_load_dwordx4 v1, s[24:27], s45 offen offset:0 nt lds
v_mfma_f32_16x16x32_bf16 v[48:51], a[224:227], v[128:131], v[48:51]
v_exp_f32 v120, v120
v_mfma_f32_16x16x32_bf16 v[52:55], a[228:231], v[128:131], v[52:55]
ds_read_b64_tr_b16 a[212:213], v4 offset:32
v_mfma_f32_16x16x32_bf16 v[56:59], a[232:235], v[128:131], v[56:59]
v_exp_f32 v121, v121
v_mfma_f32_16x16x32_bf16 v[60:63], a[236:239], v[128:131], v[60:63]
v_cvt_pk_bf16_f32 v132, v120, v121
v_mfma_f32_16x16x32_bf16 a[32:35], a[240:243], v[128:131], a[32:35]
v_exp_f32 v122, v122
v_mfma_f32_16x16x32_bf16 a[36:39], a[244:247], v[128:131], a[36:39]
ds_read_b64_tr_b16 a[214:215], v4 offset:288
v_mfma_f32_16x16x32_bf16 a[40:43], a[248:251], v[128:131], a[40:43]
v_exp_f32 v123, v123
v_mfma_f32_16x16x32_bf16 a[44:47], a[252:255], v[128:131], a[44:47]
v_cvt_pk_bf16_f32 v133, v122, v123
v_mfma_f32_16x16x32_bf16 v[168:171], v[184:187], v[128:131], v[168:171]
v_exp_f32 v124, v124
v_mfma_f32_16x16x32_bf16 v[112:115], v[220:223], a[160:163], v[152:155]
ds_read_b64_tr_b16 a[216:217], v4 offset:64
v_mfma_f32_16x16x32_bf16 v[112:115], v[224:227], a[164:167], v[112:115]
v_exp_f32 v125, v125
v_mfma_f32_16x16x32_bf16 v[112:115], v[228:231], a[168:171], v[112:115]
v_cvt_pk_bf16_f32 v134, v124, v125
v_mfma_f32_16x16x32_bf16 v[112:115], v[232:235], a[172:175], v[112:115]
v_exp_f32 v126, v126
v_mfma_f32_16x16x32_bf16 v[116:119], v[236:239], a[160:163], v[152:155]
ds_read_b64_tr_b16 a[218:219], v4 offset:320
v_mfma_f32_16x16x32_bf16 v[116:119], v[240:243], a[164:167], v[116:119]
v_exp_f32 v127, v127
v_mfma_f32_16x16x32_bf16 v[116:119], v[244:247], a[168:171], v[116:119]
v_cvt_pk_bf16_f32 v135, v126, v127
s_add_u32 m0, s48, 33824
v_mfma_f32_16x16x32_bf16 v[116:119], v[248:251], a[172:175], v[116:119]
s_waitcnt vmcnt(4)
buffer_load_dwordx4 v1, s[24:27], s45 offen offset:1024 nt lds
v_mfma_f32_16x16x32_bf16 v[64:67], a[224:227], v[132:135], v[64:67]
v_exp_f32 v112, v112
v_mfma_f32_16x16x32_bf16 v[68:71], a[228:231], v[132:135], v[68:71]
ds_read_b64_tr_b16 a[220:221], v4 offset:96
v_mfma_f32_16x16x32_bf16 v[72:75], a[232:235], v[132:135], v[72:75]
v_exp_f32 v113, v113
v_mfma_f32_16x16x32_bf16 v[76:79], a[236:239], v[132:135], v[76:79]
v_cvt_pk_bf16_f32 v128, v112, v113
s_add_u32 m0, s48, 33856
v_mfma_f32_16x16x32_bf16 a[48:51], a[240:243], v[132:135], a[48:51]
v_exp_f32 v114, v114
v_mfma_f32_16x16x32_bf16 a[52:55], a[244:247], v[132:135], a[52:55]
ds_read_b64_tr_b16 a[222:223], v4 offset:352
s_waitcnt vmcnt(4)
buffer_load_dwordx4 v1, s[24:27], s45 offen offset:2048 nt lds
v_mfma_f32_16x16x32_bf16 a[56:59], a[248:251], v[132:135], a[56:59]
v_exp_f32 v115, v115
v_mfma_f32_16x16x32_bf16 a[60:63], a[252:255], v[132:135], a[60:63]
v_cvt_pk_bf16_f32 v129, v114, v115
v_mfma_f32_16x16x32_bf16 v[172:175], v[184:187], v[132:135], v[172:175]
v_exp_f32 v116, v116
v_mfma_f32_16x16x32_bf16 v[120:123], v[220:223], a[176:179], v[156:159]
v_mfma_f32_16x16x32_bf16 v[120:123], v[224:227], a[180:183], v[120:123]
v_exp_f32 v117, v117
v_mfma_f32_16x16x32_bf16 v[120:123], v[228:231], a[184:187], v[120:123]
v_cvt_pk_bf16_f32 v130, v116, v117
v_mfma_f32_16x16x32_bf16 v[120:123], v[232:235], a[188:191], v[120:123]
v_exp_f32 v118, v118
v_mfma_f32_16x16x32_bf16 v[124:127], v[236:239], a[176:179], v[156:159]
v_mfma_f32_16x16x32_bf16 v[124:127], v[240:243], a[180:183], v[124:127]
v_exp_f32 v119, v119
v_mfma_f32_16x16x32_bf16 v[124:127], v[244:247], a[184:187], v[124:127]
v_cvt_pk_bf16_f32 v131, v118, v119
s_add_u32 m0, s48, 33888
v_mfma_f32_16x16x32_bf16 v[124:127], v[248:251], a[188:191], v[124:127]
s_waitcnt vmcnt(4)
buffer_load_dwordx4 v1, s[24:27], s45 offen offset:3072 nt lds
v_mfma_f32_16x16x32_bf16 v[80:83], a[224:227], v[128:131], v[80:83]
v_exp_f32 v120, v120
v_mfma_f32_16x16x32_bf16 v[84:87], a[228:231], v[128:131], v[84:87]
v_mfma_f32_16x16x32_bf16 v[88:91], a[232:235], v[128:131], v[88:91]
v_exp_f32 v121, v121
v_mfma_f32_16x16x32_bf16 v[92:95], a[236:239], v[128:131], v[92:95]
v_cvt_pk_bf16_f32 v132, v120, v121
s_add_u32 s45, s45, 16384
v_mfma_f32_16x16x32_bf16 a[64:67], a[240:243], v[128:131], a[64:67]
v_exp_f32 v122, v122
v_mfma_f32_16x16x32_bf16 a[68:71], a[244:247], v[128:131], a[68:71]
v_mfma_f32_16x16x32_bf16 a[72:75], a[248:251], v[128:131], a[72:75]
v_exp_f32 v123, v123
v_mfma_f32_16x16x32_bf16 a[76:79], a[252:255], v[128:131], a[76:79]
v_cvt_pk_bf16_f32 v133, v122, v123
v_mfma_f32_16x16x32_bf16 v[176:179], v[184:187], v[128:131], v[176:179]
v_exp_f32 v124, v124
s_waitcnt vmcnt(8) lgkmcnt(0)
s_barrier
v_mfma_f32_16x16x32_bf16 v[112:115], v[188:191], a[96:99], v[136:139]
ds_read_b128 v[220:223], v2 offset:16640
ds_read_b128 v[224:227], v2 offset:16656
v_mfma_f32_16x16x32_bf16 v[112:115], v[192:195], a[100:103], v[112:115]
v_exp_f32 v125, v125
v_mfma_f32_16x16x32_bf16 v[112:115], v[196:199], a[104:107], v[112:115]
v_cvt_pk_bf16_f32 v134, v124, v125
v_mfma_f32_16x16x32_bf16 v[112:115], v[200:203], a[108:111], v[112:115]
v_exp_f32 v126, v126
v_mfma_f32_16x16x32_bf16 v[116:119], v[204:207], a[96:99], v[136:139]
ds_read_b128 v[228:231], v2 offset:16672
ds_read_b128 v[232:235], v2 offset:16688
v_mfma_f32_16x16x32_bf16 v[116:119], v[208:211], a[100:103], v[116:119]
v_exp_f32 v127, v127
v_mfma_f32_16x16x32_bf16 v[116:119], v[212:215], a[104:107], v[116:119]
v_cvt_pk_bf16_f32 v135, v126, v127
s_add_u32 m0, s47, 49920
v_mfma_f32_16x16x32_bf16 v[116:119], v[216:219], a[108:111], v[116:119]
s_waitcnt vmcnt(4)
buffer_load_dwordx4 v1, s[20:23], s45 offen offset:0 nt lds
v_mfma_f32_16x16x32_bf16 v[96:99], a[224:227], v[132:135], v[96:99]
v_exp_f32 v112, v112
v_mfma_f32_16x16x32_bf16 v[100:103], a[228:231], v[132:135], v[100:103]
ds_read_b128 v[236:239], v2 offset:16896
ds_read_b128 v[240:243], v2 offset:16912
v_mfma_f32_16x16x32_bf16 v[104:107], a[232:235], v[132:135], v[104:107]
v_exp_f32 v113, v113
v_mfma_f32_16x16x32_bf16 v[108:111], a[236:239], v[132:135], v[108:111]
v_cvt_pk_bf16_f32 v128, v112, v113
v_mfma_f32_16x16x32_bf16 a[80:83], a[240:243], v[132:135], a[80:83]
v_exp_f32 v114, v114
v_mfma_f32_16x16x32_bf16 a[84:87], a[244:247], v[132:135], a[84:87]
ds_read_b128 v[244:247], v2 offset:16928
ds_read_b128 v[248:251], v2 offset:16944
v_mfma_f32_16x16x32_bf16 a[88:91], a[248:251], v[132:135], a[88:91]
v_exp_f32 v115, v115
v_mfma_f32_16x16x32_bf16 a[92:95], a[252:255], v[132:135], a[92:95]
v_cvt_pk_bf16_f32 v129, v114, v115
v_mfma_f32_16x16x32_bf16 v[180:183], v[184:187], v[132:135], v[180:183]
v_exp_f32 v116, v116
v_mfma_f32_16x16x32_bf16 v[120:123], v[188:191], a[112:115], v[140:143]
ds_read_b64_tr_b16 a[224:225], v3 offset:16896
v_mfma_f32_16x16x32_bf16 v[120:123], v[192:195], a[116:119], v[120:123]
v_exp_f32 v117, v117
v_mfma_f32_16x16x32_bf16 v[120:123], v[196:199], a[120:123], v[120:123]
v_cvt_pk_bf16_f32 v130, v116, v117
v_mfma_f32_16x16x32_bf16 v[120:123], v[200:203], a[124:127], v[120:123]
v_exp_f32 v118, v118
v_mfma_f32_16x16x32_bf16 v[124:127], v[204:207], a[112:115], v[140:143]
ds_read_b64_tr_b16 a[226:227], v3 offset:17152
v_mfma_f32_16x16x32_bf16 v[124:127], v[208:211], a[116:119], v[124:127]
v_exp_f32 v119, v119
v_mfma_f32_16x16x32_bf16 v[124:127], v[212:215], a[120:123], v[124:127]
v_cvt_pk_bf16_f32 v131, v118, v119
s_add_u32 m0, s47, 49936
v_mfma_f32_16x16x32_bf16 v[124:127], v[216:219], a[124:127], v[124:127]
s_waitcnt vmcnt(4)
buffer_load_dwordx4 v1, s[20:23], s45 offen offset:1024 nt lds
v_mfma_f32_16x16x32_bf16 v[16:19], a[192:195], v[128:131], v[16:19]
v_exp_f32 v120, v120
v_mfma_f32_16x16x32_bf16 v[20:23], a[196:199], v[128:131], v[20:23]
ds_read_b64_tr_b16 a[228:229], v3 offset:16928
v_mfma_f32_16x16x32_bf16 v[24:27], a[200:203], v[128:131], v[24:27]
v_exp_f32 v121, v121
v_mfma_f32_16x16x32_bf16 v[28:31], a[204:207], v[128:131], v[28:31]
v_cvt_pk_bf16_f32 v132, v120, v121
s_add_u32 m0, s47, 49952
v_mfma_f32_16x16x32_bf16 a[0:3], a[208:211], v[128:131], a[0:3]
v_exp_f32 v122, v122
v_mfma_f32_16x16x32_bf16 a[4:7], a[212:215], v[128:131], a[4:7]
ds_read_b64_tr_b16 a[230:231], v3 offset:17184
s_waitcnt vmcnt(4)
buffer_load_dwordx4 v1, s[20:23], s45 offen offset:2048 nt lds
v_mfma_f32_16x16x32_bf16 a[8:11], a[216:219], v[128:131], a[8:11]
v_exp_f32 v123, v123
v_mfma_f32_16x16x32_bf16 a[12:15], a[220:223], v[128:131], a[12:15]
v_cvt_pk_bf16_f32 v133, v122, v123
v_mfma_f32_16x16x32_bf16 v[160:163], v[184:187], v[128:131], v[160:163]
v_exp_f32 v124, v124
v_mfma_f32_16x16x32_bf16 v[112:115], v[188:191], a[128:131], v[144:147]
ds_read_b64_tr_b16 a[232:233], v3 offset:16960
v_mfma_f32_16x16x32_bf16 v[112:115], v[192:195], a[132:135], v[112:115]
v_exp_f32 v125, v125
v_mfma_f32_16x16x32_bf16 v[112:115], v[196:199], a[136:139], v[112:115]
v_cvt_pk_bf16_f32 v134, v124, v125
v_mfma_f32_16x16x32_bf16 v[112:115], v[200:203], a[140:143], v[112:115]
v_exp_f32 v126, v126
v_mfma_f32_16x16x32_bf16 v[116:119], v[204:207], a[128:131], v[144:147]
ds_read_b64_tr_b16 a[234:235], v3 offset:17216
v_mfma_f32_16x16x32_bf16 v[116:119], v[208:211], a[132:135], v[116:119]
v_exp_f32 v127, v127
v_mfma_f32_16x16x32_bf16 v[116:119], v[212:215], a[136:139], v[116:119]
v_cvt_pk_bf16_f32 v135, v126, v127
s_add_u32 m0, s47, 49968
v_mfma_f32_16x16x32_bf16 v[116:119], v[216:219], a[140:143], v[116:119]
s_waitcnt vmcnt(4)
buffer_load_dwordx4 v1, s[20:23], s45 offen offset:3072 nt lds
v_mfma_f32_16x16x32_bf16 v[32:35], a[192:195], v[132:135], v[32:35]
v_exp_f32 v112, v112
v_mfma_f32_16x16x32_bf16 v[36:39], a[196:199], v[132:135], v[36:39]
ds_read_b64_tr_b16 a[236:237], v3 offset:16992
v_mfma_f32_16x16x32_bf16 v[40:43], a[200:203], v[132:135], v[40:43]
v_exp_f32 v113, v113
v_mfma_f32_16x16x32_bf16 v[44:47], a[204:207], v[132:135], v[44:47]
v_cvt_pk_bf16_f32 v128, v112, v113
v_mfma_f32_16x16x32_bf16 a[16:19], a[208:211], v[132:135], a[16:19]
v_exp_f32 v114, v114
v_mfma_f32_16x16x32_bf16 a[20:23], a[212:215], v[132:135], a[20:23]
ds_read_b64_tr_b16 a[238:239], v3 offset:17248
v_mfma_f32_16x16x32_bf16 a[24:27], a[216:219], v[132:135], a[24:27]
v_exp_f32 v115, v115
v_mfma_f32_16x16x32_bf16 a[28:31], a[220:223], v[132:135], a[28:31]
v_cvt_pk_bf16_f32 v129, v114, v115
v_mfma_f32_16x16x32_bf16 v[164:167], v[184:187], v[132:135], v[164:167]
v_exp_f32 v116, v116
v_mfma_f32_16x16x32_bf16 v[120:123], v[188:191], a[144:147], v[148:151]
ds_read_b64_tr_b16 a[240:241], v4 offset:16896
v_mfma_f32_16x16x32_bf16 v[120:123], v[192:195], a[148:151], v[120:123]
v_exp_f32 v117, v117
v_mfma_f32_16x16x32_bf16 v[120:123], v[196:199], a[152:155], v[120:123]
v_cvt_pk_bf16_f32 v130, v116, v117
v_mfma_f32_16x16x32_bf16 v[120:123], v[200:203], a[156:159], v[120:123]
v_exp_f32 v118, v118
v_mfma_f32_16x16x32_bf16 v[124:127], v[204:207], a[144:147], v[148:151]
ds_read_b64_tr_b16 a[242:243], v4 offset:17152
v_mfma_f32_16x16x32_bf16 v[124:127], v[208:211], a[148:151], v[124:127]
v_exp_f32 v119, v119
v_mfma_f32_16x16x32_bf16 v[124:127], v[212:215], a[152:155], v[124:127]
v_cvt_pk_bf16_f32 v131, v118, v119
s_add_u32 m0, s48, 50688
v_mfma_f32_16x16x32_bf16 v[124:127], v[216:219], a[156:159], v[124:127]
s_waitcnt vmcnt(4)
buffer_load_dwordx4 v1, s[24:27], s45 offen offset:0 nt lds
v_mfma_f32_16x16x32_bf16 v[48:51], a[192:195], v[128:131], v[48:51]
v_exp_f32 v120, v120
v_mfma_f32_16x16x32_bf16 v[52:55], a[196:199], v[128:131], v[52:55]
ds_read_b64_tr_b16 a[244:245], v4 offset:16928
v_mfma_f32_16x16x32_bf16 v[56:59], a[200:203], v[128:131], v[56:59]
v_exp_f32 v121, v121
v_mfma_f32_16x16x32_bf16 v[60:63], a[204:207], v[128:131], v[60:63]
v_cvt_pk_bf16_f32 v132, v120, v121
v_mfma_f32_16x16x32_bf16 a[32:35], a[208:211], v[128:131], a[32:35]
v_exp_f32 v122, v122
v_mfma_f32_16x16x32_bf16 a[36:39], a[212:215], v[128:131], a[36:39]
ds_read_b64_tr_b16 a[246:247], v4 offset:17184
v_mfma_f32_16x16x32_bf16 a[40:43], a[216:219], v[128:131], a[40:43]
v_exp_f32 v123, v123
v_mfma_f32_16x16x32_bf16 a[44:47], a[220:223], v[128:131], a[44:47]
v_cvt_pk_bf16_f32 v133, v122, v123
v_mfma_f32_16x16x32_bf16 v[168:171], v[184:187], v[128:131], v[168:171]
v_exp_f32 v124, v124
v_mfma_f32_16x16x32_bf16 v[112:115], v[188:191], a[160:163], v[152:155]
ds_read_b64_tr_b16 a[248:249], v4 offset:16960
v_mfma_f32_16x16x32_bf16 v[112:115], v[192:195], a[164:167], v[112:115]
v_exp_f32 v125, v125
v_mfma_f32_16x16x32_bf16 v[112:115], v[196:199], a[168:171], v[112:115]
v_cvt_pk_bf16_f32 v134, v124, v125
v_mfma_f32_16x16x32_bf16 v[112:115], v[200:203], a[172:175], v[112:115]
v_exp_f32 v126, v126
v_mfma_f32_16x16x32_bf16 v[116:119], v[204:207], a[160:163], v[152:155]
ds_read_b64_tr_b16 a[250:251], v4 offset:17216
v_mfma_f32_16x16x32_bf16 v[116:119], v[208:211], a[164:167], v[116:119]
v_exp_f32 v127, v127
v_mfma_f32_16x16x32_bf16 v[116:119], v[212:215], a[168:171], v[116:119]
v_cvt_pk_bf16_f32 v135, v126, v127
s_add_u32 m0, s48, 50720
v_mfma_f32_16x16x32_bf16 v[116:119], v[216:219], a[172:175], v[116:119]
s_waitcnt vmcnt(4)
buffer_load_dwordx4 v1, s[24:27], s45 offen offset:1024 nt lds
v_mfma_f32_16x16x32_bf16 v[64:67], a[192:195], v[132:135], v[64:67]
v_exp_f32 v112, v112
v_mfma_f32_16x16x32_bf16 v[68:71], a[196:199], v[132:135], v[68:71]
ds_read_b64_tr_b16 a[252:253], v4 offset:16992
v_mfma_f32_16x16x32_bf16 v[72:75], a[200:203], v[132:135], v[72:75]
v_exp_f32 v113, v113
v_mfma_f32_16x16x32_bf16 v[76:79], a[204:207], v[132:135], v[76:79]
v_cvt_pk_bf16_f32 v128, v112, v113
s_add_u32 m0, s48, 50752
v_mfma_f32_16x16x32_bf16 a[48:51], a[208:211], v[132:135], a[48:51]
v_exp_f32 v114, v114
v_mfma_f32_16x16x32_bf16 a[52:55], a[212:215], v[132:135], a[52:55]
ds_read_b64_tr_b16 a[254:255], v4 offset:17248
s_waitcnt vmcnt(4)
buffer_load_dwordx4 v1, s[24:27], s45 offen offset:2048 nt lds
v_mfma_f32_16x16x32_bf16 a[56:59], a[216:219], v[132:135], a[56:59]
v_exp_f32 v115, v115
v_mfma_f32_16x16x32_bf16 a[60:63], a[220:223], v[132:135], a[60:63]
v_cvt_pk_bf16_f32 v129, v114, v115
v_mfma_f32_16x16x32_bf16 v[172:175], v[184:187], v[132:135], v[172:175]
v_exp_f32 v116, v116
v_mfma_f32_16x16x32_bf16 v[120:123], v[188:191], a[176:179], v[156:159]
v_mfma_f32_16x16x32_bf16 v[120:123], v[192:195], a[180:183], v[120:123]
v_exp_f32 v117, v117
v_mfma_f32_16x16x32_bf16 v[120:123], v[196:199], a[184:187], v[120:123]
v_cvt_pk_bf16_f32 v130, v116, v117
v_mfma_f32_16x16x32_bf16 v[120:123], v[200:203], a[188:191], v[120:123]
v_exp_f32 v118, v118
v_mfma_f32_16x16x32_bf16 v[124:127], v[204:207], a[176:179], v[156:159]
v_mfma_f32_16x16x32_bf16 v[124:127], v[208:211], a[180:183], v[124:127]
v_exp_f32 v119, v119
v_mfma_f32_16x16x32_bf16 v[124:127], v[212:215], a[184:187], v[124:127]
v_cvt_pk_bf16_f32 v131, v118, v119
s_add_u32 m0, s48, 50784
v_mfma_f32_16x16x32_bf16 v[124:127], v[216:219], a[188:191], v[124:127]
s_waitcnt vmcnt(4)
buffer_load_dwordx4 v1, s[24:27], s45 offen offset:3072 nt lds
v_mfma_f32_16x16x32_bf16 v[80:83], a[192:195], v[128:131], v[80:83]
v_exp_f32 v120, v120
v_mfma_f32_16x16x32_bf16 v[84:87], a[196:199], v[128:131], v[84:87]
v_mfma_f32_16x16x32_bf16 v[88:91], a[200:203], v[128:131], v[88:91]
v_exp_f32 v121, v121
v_mfma_f32_16x16x32_bf16 v[92:95], a[204:207], v[128:131], v[92:95]
v_cvt_pk_bf16_f32 v132, v120, v121
s_add_u32 s45, s45, 16384
v_mfma_f32_16x16x32_bf16 a[64:67], a[208:211], v[128:131], a[64:67]
v_exp_f32 v122, v122
v_mfma_f32_16x16x32_bf16 a[68:71], a[212:215], v[128:131], a[68:71]
v_mfma_f32_16x16x32_bf16 a[72:75], a[216:219], v[128:131], a[72:75]
v_exp_f32 v123, v123
v_mfma_f32_16x16x32_bf16 a[76:79], a[220:223], v[128:131], a[76:79]
v_cvt_pk_bf16_f32 v133, v122, v123
v_mfma_f32_16x16x32_bf16 v[176:179], v[184:187], v[128:131], v[176:179]
v_exp_f32 v124, v124
s_add_u32 s49, s49, 1
s_cmp_lt_u32 s49, 2
s_cbranch_scc1 L_loop0
.p2align 6
L_loop1:
s_waitcnt vmcnt(8) lgkmcnt(0)
s_barrier
v_mfma_f32_16x16x32_bf16 v[112:115], v[220:223], a[96:99], v[136:139]
ds_read_b128 v[188:191], v2 offset:33280
ds_read_b128 v[192:195], v2 offset:33296
v_mfma_f32_16x16x32_bf16 v[112:115], v[224:227], a[100:103], v[112:115]
v_exp_f32 v125, v125
v_mfma_f32_16x16x32_bf16 v[112:115], v[228:231], a[104:107], v[112:115]
v_cvt_pk_bf16_f32 v134, v124, v125
v_mfma_f32_16x16x32_bf16 v[112:115], v[232:235], a[108:111], v[112:115]
v_exp_f32 v126, v126
v_mfma_f32_16x16x32_bf16 v[116:119], v[236:239], a[96:99], v[136:139]
ds_read_b128 v[196:199], v2 offset:33312
ds_read_b128 v[200:203], v2 offset:33328
v_mfma_f32_16x16x32_bf16 v[116:119], v[240:243], a[100:103], v[116:119]
v_exp_f32 v127, v127
v_mfma_f32_16x16x32_bf16 v[116:119], v[244:247], a[104:107], v[116:119]
v_cvt_pk_bf16_f32 v135, v126, v127
s_add_u32 m0, s47, 0
v_mfma_f32_16x16x32_bf16 v[116:119], v[248:251], a[108:111], v[116:119]
s_waitcnt vmcnt(4)
buffer_load_dwordx4 v1, s[20:23], s45 offen offset:0 nt lds
v_mfma_f32_16x16x32_bf16 v[96:99], a[192:195], v[132:135], v[96:99]
v_exp_f32 v112, v112
v_mfma_f32_16x16x32_bf16 v[100:103], a[196:199], v[132:135], v[100:103]
ds_read_b128 v[204:207], v2 offset:33536
ds_read_b128 v[208:211], v2 offset:33552
v_mfma_f32_16x16x32_bf16 v[104:107], a[200:203], v[132:135], v[104:107]
v_exp_f32 v113, v113
v_mfma_f32_16x16x32_bf16 v[108:111], a[204:207], v[132:135], v[108:111]
v_cvt_pk_bf16_f32 v128, v112, v113
v_mfma_f32_16x16x32_bf16 a[80:83], a[208:211], v[132:135], a[80:83]
v_exp_f32 v114, v114
v_mfma_f32_16x16x32_bf16 a[84:87], a[212:215], v[132:135], a[84:87]
ds_read_b128 v[212:215], v2 offset:33568
ds_read_b128 v[216:219], v2 offset:33584
v_mfma_f32_16x16x32_bf16 a[88:91], a[216:219], v[132:135], a[88:91]
v_exp_f32 v115, v115
v_mfma_f32_16x16x32_bf16 a[92:95], a[220:223], v[132:135], a[92:95]
v_cvt_pk_bf16_f32 v129, v114, v115
v_mfma_f32_16x16x32_bf16 v[180:183], v[184:187], v[132:135], v[180:183]
v_exp_f32 v116, v116
v_mfma_f32_16x16x32_bf16 v[120:123], v[220:223], a[112:115], v[140:143]
ds_read_b64_tr_b16 a[192:193], v3 offset:33792
v_mfma_f32_16x16x32_bf16 v[120:123], v[224:227], a[116:119], v[120:123]
v_exp_f32 v117, v117
v_mfma_f32_16x16x32_bf16 v[120:123], v[228:231], a[120:123], v[120:123]
v_cvt_pk_bf16_f32 v130, v116, v117
v_mfma_f32_16x16x32_bf16 v[120:123], v[232:235], a[124:127], v[120:123]
v_exp_f32 v118, v118
v_mfma_f32_16x16x32_bf16 v[124:127], v[236:239], a[112:115], v[140:143]
ds_read_b64_tr_b16 a[194:195], v3 offset:34048
v_mfma_f32_16x16x32_bf16 v[124:127], v[240:243], a[116:119], v[124:127]
v_exp_f32 v119, v119
v_mfma_f32_16x16x32_bf16 v[124:127], v[244:247], a[120:123], v[124:127]
v_cvt_pk_bf16_f32 v131, v118, v119
s_add_u32 m0, s47, 16
v_mfma_f32_16x16x32_bf16 v[124:127], v[248:251], a[124:127], v[124:127]
s_waitcnt vmcnt(4)
buffer_load_dwordx4 v1, s[20:23], s45 offen offset:1024 nt lds
v_mfma_f32_16x16x32_bf16 v[16:19], a[224:227], v[128:131], v[16:19]
v_exp_f32 v120, v120
v_mfma_f32_16x16x32_bf16 v[20:23], a[228:231], v[128:131], v[20:23]
ds_read_b64_tr_b16 a[196:197], v3 offset:33824
v_mfma_f32_16x16x32_bf16 v[24:27], a[232:235], v[128:131], v[24:27]
v_exp_f32 v121, v121
v_mfma_f32_16x16x32_bf16 v[28:31], a[236:239], v[128:131], v[28:31]
v_cvt_pk_bf16_f32 v132, v120, v121
s_add_u32 m0, s47, 32
v_mfma_f32_16x16x32_bf16 a[0:3], a[240:243], v[128:131], a[0:3]
v_exp_f32 v122, v122
v_mfma_f32_16x16x32_bf16 a[4:7], a[244:247], v[128:131], a[4:7]
ds_read_b64_tr_b16 a[198:199], v3 offset:34080
s_waitcnt vmcnt(4)
buffer_load_dwordx4 v1, s[20:23], s45 offen offset:2048 nt lds
v_mfma_f32_16x16x32_bf16 a[8:11], a[248:251], v[128:131], a[8:11]
v_exp_f32 v123, v123
v_mfma_f32_16x16x32_bf16 a[12:15], a[252:255], v[128:131], a[12:15]
v_cvt_pk_bf16_f32 v133, v122, v123
v_mfma_f32_16x16x32_bf16 v[160:163], v[184:187], v[128:131], v[160:163]
v_exp_f32 v124, v124
v_mfma_f32_16x16x32_bf16 v[112:115], v[220:223], a[128:131], v[144:147]
ds_read_b64_tr_b16 a[200:201], v3 offset:33856
v_mfma_f32_16x16x32_bf16 v[112:115], v[224:227], a[132:135], v[112:115]
v_exp_f32 v125, v125
v_mfma_f32_16x16x32_bf16 v[112:115], v[228:231], a[136:139], v[112:115]
v_cvt_pk_bf16_f32 v134, v124, v125
v_mfma_f32_16x16x32_bf16 v[112:115], v[232:235], a[140:143], v[112:115]
v_exp_f32 v126, v126
v_mfma_f32_16x16x32_bf16 v[116:119], v[236:239], a[128:131], v[144:147]
ds_read_b64_tr_b16 a[202:203], v3 offset:34112
v_mfma_f32_16x16x32_bf16 v[116:119], v[240:243], a[132:135], v[116:119]
v_exp_f32 v127, v127
v_mfma_f32_16x16x32_bf16 v[116:119], v[244:247], a[136:139], v[116:119]
v_cvt_pk_bf16_f32 v135, v126, v127
s_add_u32 m0, s47, 48
v_mfma_f32_16x16x32_bf16 v[116:119], v[248:251], a[140:143], v[116:119]
s_waitcnt vmcnt(4)
buffer_load_dwordx4 v1, s[20:23], s45 offen offset:3072 nt lds
v_mfma_f32_16x16x32_bf16 v[32:35], a[224:227], v[132:135], v[32:35]
v_exp_f32 v112, v112
v_mfma_f32_16x16x32_bf16 v[36:39], a[228:231], v[132:135], v[36:39]
ds_read_b64_tr_b16 a[204:205], v3 offset:33888
v_mfma_f32_16x16x32_bf16 v[40:43], a[232:235], v[132:135], v[40:43]
v_exp_f32 v113, v113
v_mfma_f32_16x16x32_bf16 v[44:47], a[236:239], v[132:135], v[44:47]
v_cvt_pk_bf16_f32 v128, v112, v113
v_mfma_f32_16x16x32_bf16 a[16:19], a[240:243], v[132:135], a[16:19]
v_exp_f32 v114, v114
v_mfma_f32_16x16x32_bf16 a[20:23], a[244:247], v[132:135], a[20:23]
ds_read_b64_tr_b16 a[206:207], v3 offset:34144
v_mfma_f32_16x16x32_bf16 a[24:27], a[248:251], v[132:135], a[24:27]
v_exp_f32 v115, v115
v_mfma_f32_16x16x32_bf16 a[28:31], a[252:255], v[132:135], a[28:31]
v_cvt_pk_bf16_f32 v129, v114, v115
v_mfma_f32_16x16x32_bf16 v[164:167], v[184:187], v[132:135], v[164:167]
v_exp_f32 v116, v116
v_mfma_f32_16x16x32_bf16 v[120:123], v[220:223], a[144:147], v[148:151]
ds_read_b64_tr_b16 a[208:209], v4 offset:33792
v_mfma_f32_16x16x32_bf16 v[120:123], v[224:227], a[148:151], v[120:123]
v_exp_f32 v117, v117
v_mfma_f32_16x16x32_bf16 v[120:123], v[228:231], a[152:155], v[120:123]
v_cvt_pk_bf16_f32 v130, v116, v117
v_mfma_f32_16x16x32_bf16 v[120:123], v[232:235], a[156:159], v[120:123]
v_exp_f32 v118, v118
v_mfma_f32_16x16x32_bf16 v[124:127], v[236:239], a[144:147], v[148:151]
ds_read_b64_tr_b16 a[210:211], v4 offset:34048
v_mfma_f32_16x16x32_bf16 v[124:127], v[240:243], a[148:151], v[124:127]
v_exp_f32 v119, v119
v_mfma_f32_16x16x32_bf16 v[124:127], v[244:247], a[152:155], v[124:127]
v_cvt_pk_bf16_f32 v131, v118, v119
s_add_u32 m0, s48, 0
v_mfma_f32_16x16x32_bf16 v[124:127], v[248:251], a[156:159], v[124:127]
s_waitcnt vmcnt(4)
buffer_load_dwordx4 v1, s[24:27], s45 offen offset:0 nt lds
v_mfma_f32_16x16x32_bf16 v[48:51], a[224:227], v[128:131], v[48:51]
v_exp_f32 v120, v120
v_mfma_f32_16x16x32_bf16 v[52:55], a[228:231], v[128:131], v[52:55]
ds_read_b64_tr_b16 a[212:213], v4 offset:33824
v_mfma_f32_16x16x32_bf16 v[56:59], a[232:235], v[128:131], v[56:59]
v_exp_f32 v121, v121
v_mfma_f32_16x16x32_bf16 v[60:63], a[236:239], v[128:131], v[60:63]
v_cvt_pk_bf16_f32 v132, v120, v121
v_mfma_f32_16x16x32_bf16 a[32:35], a[240:243], v[128:131], a[32:35]
v_exp_f32 v122, v122
v_mfma_f32_16x16x32_bf16 a[36:39], a[244:247], v[128:131], a[36:39]
ds_read_b64_tr_b16 a[214:215], v4 offset:34080
v_mfma_f32_16x16x32_bf16 a[40:43], a[248:251], v[128:131], a[40:43]
v_exp_f32 v123, v123
v_mfma_f32_16x16x32_bf16 a[44:47], a[252:255], v[128:131], a[44:47]
v_cvt_pk_bf16_f32 v133, v122, v123
v_mfma_f32_16x16x32_bf16 v[168:171], v[184:187], v[128:131], v[168:171]
v_exp_f32 v124, v124
v_mfma_f32_16x16x32_bf16 v[112:115], v[220:223], a[160:163], v[152:155]
ds_read_b64_tr_b16 a[216:217], v4 offset:33856
v_mfma_f32_16x16x32_bf16 v[112:115], v[224:227], a[164:167], v[112:115]
v_exp_f32 v125, v125
v_mfma_f32_16x16x32_bf16 v[112:115], v[228:231], a[168:171], v[112:115]
v_cvt_pk_bf16_f32 v134, v124, v125
v_mfma_f32_16x16x32_bf16 v[112:115], v[232:235], a[172:175], v[112:115]
v_exp_f32 v126, v126
v_mfma_f32_16x16x32_bf16 v[116:119], v[236:239], a[160:163], v[152:155]
ds_read_b64_tr_b16 a[218:219], v4 offset:34112
v_mfma_f32_16x16x32_bf16 v[116:119], v[240:243], a[164:167], v[116:119]
v_exp_f32 v127, v127
v_mfma_f32_16x16x32_bf16 v[116:119], v[244:247], a[168:171], v[116:119]
v_cvt_pk_bf16_f32 v135, v126, v127
s_add_u32 m0, s48, 32
v_mfma_f32_16x16x32_bf16 v[116:119], v[248:251], a[172:175], v[116:119]
s_waitcnt vmcnt(4)
buffer_load_dwordx4 v1, s[24:27], s45 offen offset:1024 nt lds
v_mfma_f32_16x16x32_bf16 v[64:67], a[224:227], v[132:135], v[64:67]
v_exp_f32 v112, v112
v_mfma_f32_16x16x32_bf16 v[68:71], a[228:231], v[132:135], v[68:71]
ds_read_b64_tr_b16 a[220:221], v4 offset:33888
v_mfma_f32_16x16x32_bf16 v[72:75], a[232:235], v[132:135], v[72:75]
v_exp_f32 v113, v113
v_mfma_f32_16x16x32_bf16 v[76:79], a[236:239], v[132:135], v[76:79]
v_cvt_pk_bf16_f32 v128, v112, v113
s_add_u32 m0, s48, 64
v_mfma_f32_16x16x32_bf16 a[48:51], a[240:243], v[132:135], a[48:51]
v_exp_f32 v114, v114
v_mfma_f32_16x16x32_bf16 a[52:55], a[244:247], v[132:135], a[52:55]
ds_read_b64_tr_b16 a[222:223], v4 offset:34144
s_waitcnt vmcnt(3)
buffer_load_dwordx4 v1, s[24:27], s45 offen offset:2048 nt lds
v_mfma_f32_16x16x32_bf16 a[56:59], a[248:251], v[132:135], a[56:59]
v_exp_f32 v115, v115
v_mfma_f32_16x16x32_bf16 a[60:63], a[252:255], v[132:135], a[60:63]
v_cvt_pk_bf16_f32 v129, v114, v115
v_mfma_f32_16x16x32_bf16 v[172:175], v[184:187], v[132:135], v[172:175]
v_exp_f32 v116, v116
v_mfma_f32_16x16x32_bf16 v[120:123], v[220:223], a[176:179], v[156:159]
v_mfma_f32_16x16x32_bf16 v[120:123], v[224:227], a[180:183], v[120:123]
v_exp_f32 v117, v117
v_mfma_f32_16x16x32_bf16 v[120:123], v[228:231], a[184:187], v[120:123]
v_cvt_pk_bf16_f32 v130, v116, v117
v_mfma_f32_16x16x32_bf16 v[120:123], v[232:235], a[188:191], v[120:123]
v_exp_f32 v118, v118
v_mfma_f32_16x16x32_bf16 v[124:127], v[236:239], a[176:179], v[156:159]
v_mfma_f32_16x16x32_bf16 v[124:127], v[240:243], a[180:183], v[124:127]
v_exp_f32 v119, v119
v_mfma_f32_16x16x32_bf16 v[124:127], v[244:247], a[184:187], v[124:127]
v_cvt_pk_bf16_f32 v131, v118, v119
s_add_u32 m0, s48, 96
v_mfma_f32_16x16x32_bf16 v[124:127], v[248:251], a[188:191], v[124:127]
s_waitcnt vmcnt(3)
buffer_load_dwordx4 v1, s[24:27], s45 offen offset:3072 nt lds
v_mfma_f32_16x16x32_bf16 v[80:83], a[224:227], v[128:131], v[80:83]
v_exp_f32 v120, v120
v_mfma_f32_16x16x32_bf16 v[84:87], a[228:231], v[128:131], v[84:87]
v_mfma_f32_16x16x32_bf16 v[88:91], a[232:235], v[128:131], v[88:91]
v_exp_f32 v121, v121
v_mfma_f32_16x16x32_bf16 v[92:95], a[236:239], v[128:131], v[92:95]
v_cvt_pk_bf16_f32 v132, v120, v121
s_add_u32 s45, s45, 16384
v_mfma_f32_16x16x32_bf16 a[64:67], a[240:243], v[128:131], a[64:67]
v_exp_f32 v122, v122
v_mfma_f32_16x16x32_bf16 a[68:71], a[244:247], v[128:131], a[68:71]
v_mfma_f32_16x16x32_bf16 a[72:75], a[248:251], v[128:131], a[72:75]
v_exp_f32 v123, v123
v_mfma_f32_16x16x32_bf16 a[76:79], a[252:255], v[128:131], a[76:79]
v_cvt_pk_bf16_f32 v133, v122, v123
v_mfma_f32_16x16x32_bf16 v[176:179], v[184:187], v[128:131], v[176:179]
v_exp_f32 v124, v124
s_waitcnt vmcnt(8) lgkmcnt(0)
s_barrier
v_mfma_f32_16x16x32_bf16 v[112:115], v[188:191], a[96:99], v[136:139]
ds_read_b128 v[220:223], v2 offset:49920
ds_read_b128 v[224:227], v2 offset:49936
v_mfma_f32_16x16x32_bf16 v[112:115], v[192:195], a[100:103], v[112:115]
v_exp_f32 v125, v125
v_mfma_f32_16x16x32_bf16 v[112:115], v[196:199], a[104:107], v[112:115]
v_cvt_pk_bf16_f32 v134, v124, v125
v_mfma_f32_16x16x32_bf16 v[112:115], v[200:203], a[108:111], v[112:115]
v_exp_f32 v126, v126
v_mfma_f32_16x16x32_bf16 v[116:119], v[204:207], a[96:99], v[136:139]
ds_read_b128 v[228:231], v2 offset:49952
ds_read_b128 v[232:235], v2 offset:49968
v_mfma_f32_16x16x32_bf16 v[116:119], v[208:211], a[100:103], v[116:119]
v_exp_f32 v127, v127
v_mfma_f32_16x16x32_bf16 v[116:119], v[212:215], a[104:107], v[116:119]
v_cvt_pk_bf16_f32 v135, v126, v127
s_add_u32 m0, s47, 16640
v_mfma_f32_16x16x32_bf16 v[116:119], v[216:219], a[108:111], v[116:119]
s_waitcnt vmcnt(4)
buffer_load_dwordx4 v1, s[20:23], s45 offen offset:0 nt lds
v_mfma_f32_16x16x32_bf16 v[96:99], a[224:227], v[132:135], v[96:99]
v_exp_f32 v112, v112
v_mfma_f32_16x16x32_bf16 v[100:103], a[228:231], v[132:135], v[100:103]
ds_read_b128 v[236:239], v2 offset:50176
ds_read_b128 v[240:243], v2 offset:50192
v_mfma_f32_16x16x32_bf16 v[104:107], a[232:235], v[132:135], v[104:107]
v_exp_f32 v113, v113
v_mfma_f32_16x16x32_bf16 v[108:111], a[236:239], v[132:135], v[108:111]
v_cvt_pk_bf16_f32 v128, v112, v113
v_mfma_f32_16x16x32_bf16 a[80:83], a[240:243], v[132:135], a[80:83]
v_exp_f32 v114, v114
v_mfma_f32_16x16x32_bf16 a[84:87], a[244:247], v[132:135], a[84:87]
ds_read_b128 v[244:247], v2 offset:50208
ds_read_b128 v[248:251], v2 offset:50224
v_mfma_f32_16x16x32_bf16 a[88:91], a[248:251], v[132:135], a[88:91]
v_exp_f32 v115, v115
v_mfma_f32_16x16x32_bf16 a[92:95], a[252:255], v[132:135], a[92:95]
v_cvt_pk_bf16_f32 v129, v114, v115
v_mfma_f32_16x16x32_bf16 v[180:183], v[184:187], v[132:135], v[180:183]
v_exp_f32 v116, v116
v_mfma_f32_16x16x32_bf16 v[120:123], v[188:191], a[112:115], v[140:143]
ds_read_b64_tr_b16 a[224:225], v3 offset:50688
v_mfma_f32_16x16x32_bf16 v[120:123], v[192:195], a[116:119], v[120:123]
v_exp_f32 v117, v117
v_mfma_f32_16x16x32_bf16 v[120:123], v[196:199], a[120:123], v[120:123]
v_cvt_pk_bf16_f32 v130, v116, v117
v_mfma_f32_16x16x32_bf16 v[120:123], v[200:203], a[124:127], v[120:123]
v_exp_f32 v118, v118
v_mfma_f32_16x16x32_bf16 v[124:127], v[204:207], a[112:115], v[140:143]
ds_read_b64_tr_b16 a[226:227], v3 offset:50944
v_mfma_f32_16x16x32_bf16 v[124:127], v[208:211], a[116:119], v[124:127]
v_exp_f32 v119, v119
v_mfma_f32_16x16x32_bf16 v[124:127], v[212:215], a[120:123], v[124:127]
v_cvt_pk_bf16_f32 v131, v118, v119
s_add_u32 m0, s47, 16656
v_mfma_f32_16x16x32_bf16 v[124:127], v[216:219], a[124:127], v[124:127]
s_waitcnt vmcnt(4)
buffer_load_dwordx4 v1, s[20:23], s45 offen offset:1024 nt lds
v_mfma_f32_16x16x32_bf16 v[16:19], a[192:195], v[128:131], v[16:19]
v_exp_f32 v120, v120
v_mfma_f32_16x16x32_bf16 v[20:23], a[196:199], v[128:131], v[20:23]
ds_read_b64_tr_b16 a[228:229], v3 offset:50720
v_mfma_f32_16x16x32_bf16 v[24:27], a[200:203], v[128:131], v[24:27]
v_exp_f32 v121, v121
v_mfma_f32_16x16x32_bf16 v[28:31], a[204:207], v[128:131], v[28:31]
v_cvt_pk_bf16_f32 v132, v120, v121
s_add_u32 m0, s47, 16672
v_mfma_f32_16x16x32_bf16 a[0:3], a[208:211], v[128:131], a[0:3]
v_exp_f32 v122, v122
v_mfma_f32_16x16x32_bf16 a[4:7], a[212:215], v[128:131], a[4:7]
ds_read_b64_tr_b16 a[230:231], v3 offset:50976
s_waitcnt vmcnt(4)
buffer_load_dwordx4 v1, s[20:23], s45 offen offset:2048 nt lds
v_mfma_f32_16x16x32_bf16 a[8:11], a[216:219], v[128:131], a[8:11]
v_exp_f32 v123, v123
v_mfma_f32_16x16x32_bf16 a[12:15], a[220:223], v[128:131], a[12:15]
v_cvt_pk_bf16_f32 v133, v122, v123
v_mfma_f32_16x16x32_bf16 v[160:163], v[184:187], v[128:131], v[160:163]
v_exp_f32 v124, v124
v_mfma_f32_16x16x32_bf16 v[112:115], v[188:191], a[128:131], v[144:147]
ds_read_b64_tr_b16 a[232:233], v3 offset:50752
v_mfma_f32_16x16x32_bf16 v[112:115], v[192:195], a[132:135], v[112:115]
v_exp_f32 v125, v125
v_mfma_f32_16x16x32_bf16 v[112:115], v[196:199], a[136:139], v[112:115]
v_cvt_pk_bf16_f32 v134, v124, v125
v_mfma_f32_16x16x32_bf16 v[112:115], v[200:203], a[140:143], v[112:115]
v_exp_f32 v126, v126
v_mfma_f32_16x16x32_bf16 v[116:119], v[204:207], a[128:131], v[144:147]
ds_read_b64_tr_b16 a[234:235], v3 offset:51008
v_mfma_f32_16x16x32_bf16 v[116:119], v[208:211], a[132:135], v[116:119]
v_exp_f32 v127, v127
v_mfma_f32_16x16x32_bf16 v[116:119], v[212:215], a[136:139], v[116:119]
v_cvt_pk_bf16_f32 v135, v126, v127
s_add_u32 m0, s47, 16688
v_mfma_f32_16x16x32_bf16 v[116:119], v[216:219], a[140:143], v[116:119]
s_waitcnt vmcnt(4)
buffer_load_dwordx4 v1, s[20:23], s45 offen offset:3072 nt lds
v_mfma_f32_16x16x32_bf16 v[32:35], a[192:195], v[132:135], v[32:35]
v_exp_f32 v112, v112
v_mfma_f32_16x16x32_bf16 v[36:39], a[196:199], v[132:135], v[36:39]
ds_read_b64_tr_b16 a[236:237], v3 offset:50784
v_mfma_f32_16x16x32_bf16 v[40:43], a[200:203], v[132:135], v[40:43]
v_exp_f32 v113, v113
v_mfma_f32_16x16x32_bf16 v[44:47], a[204:207], v[132:135], v[44:47]
v_cvt_pk_bf16_f32 v128, v112, v113
v_mfma_f32_16x16x32_bf16 a[16:19], a[208:211], v[132:135], a[16:19]
v_exp_f32 v114, v114
v_mfma_f32_16x16x32_bf16 a[20:23], a[212:215], v[132:135], a[20:23]
ds_read_b64_tr_b16 a[238:239], v3 offset:51040
v_mfma_f32_16x16x32_bf16 a[24:27], a[216:219], v[132:135], a[24:27]
v_exp_f32 v115, v115
v_mfma_f32_16x16x32_bf16 a[28:31], a[220:223], v[132:135], a[28:31]
v_cvt_pk_bf16_f32 v129, v114, v115
v_mfma_f32_16x16x32_bf16 v[164:167], v[184:187], v[132:135], v[164:167]
v_exp_f32 v116, v116
v_mfma_f32_16x16x32_bf16 v[120:123], v[188:191], a[144:147], v[148:151]
ds_read_b64_tr_b16 a[240:241], v4 offset:50688
v_mfma_f32_16x16x32_bf16 v[120:123], v[192:195], a[148:151], v[120:123]
v_exp_f32 v117, v117
v_mfma_f32_16x16x32_bf16 v[120:123], v[196:199], a[152:155], v[120:123]
v_cvt_pk_bf16_f32 v130, v116, v117
v_mfma_f32_16x16x32_bf16 v[120:123], v[200:203], a[156:159], v[120:123]
v_exp_f32 v118, v118
v_mfma_f32_16x16x32_bf16 v[124:127], v[204:207], a[144:147], v[148:151]
ds_read_b64_tr_b16 a[242:243], v4 offset:50944
v_mfma_f32_16x16x32_bf16 v[124:127], v[208:211], a[148:151], v[124:127]
v_exp_f32 v119, v119
v_mfma_f32_16x16x32_bf16 v[124:127], v[212:215], a[152:155], v[124:127]
v_cvt_pk_bf16_f32 v131, v118, v119
s_add_u32 m0, s48, 16896
v_mfma_f32_16x16x32_bf16 v[124:127], v[216:219], a[156:159], v[124:127]
s_waitcnt vmcnt(4)
buffer_load_dwordx4 v1, s[24:27], s45 offen offset:0 nt lds
v_mfma_f32_16x16x32_bf16 v[48:51], a[192:195], v[128:131], v[48:51]
v_exp_f32 v120, v120
v_mfma_f32_16x16x32_bf16 v[52:55], a[196:199], v[128:131], v[52:55]
ds_read_b64_tr_b16 a[244:245], v4 offset:50720
v_mfma_f32_16x16x32_bf16 v[56:59], a[200:203], v[128:131], v[56:59]
v_exp_f32 v121, v121
v_mfma_f32_16x16x32_bf16 v[60:63], a[204:207], v[128:131], v[60:63]
v_cvt_pk_bf16_f32 v132, v120, v121
v_mfma_f32_16x16x32_bf16 a[32:35], a[208:211], v[128:131], a[32:35]
v_exp_f32 v122, v122
v_mfma_f32_16x16x32_bf16 a[36:39], a[212:215], v[128:131], a[36:39]
ds_read_b64_tr_b16 a[246:247], v4 offset:50976
v_mfma_f32_16x16x32_bf16 a[40:43], a[216:219], v[128:131], a[40:43]
v_exp_f32 v123, v123
v_mfma_f32_16x16x32_bf16 a[44:47], a[220:223], v[128:131], a[44:47]
v_cvt_pk_bf16_f32 v133, v122, v123
v_mfma_f32_16x16x32_bf16 v[168:171], v[184:187], v[128:131], v[168:171]
v_exp_f32 v124, v124
v_mfma_f32_16x16x32_bf16 v[112:115], v[188:191], a[160:163], v[152:155]
ds_read_b64_tr_b16 a[248:249], v4 offset:50752
v_mfma_f32_16x16x32_bf16 v[112:115], v[192:195], a[164:167], v[112:115]
v_exp_f32 v125, v125
v_mfma_f32_16x16x32_bf16 v[112:115], v[196:199], a[168:171], v[112:115]
v_cvt_pk_bf16_f32 v134, v124, v125
v_mfma_f32_16x16x32_bf16 v[112:115], v[200:203], a[172:175], v[112:115]
v_exp_f32 v126, v126
v_mfma_f32_16x16x32_bf16 v[116:119], v[204:207], a[160:163], v[152:155]
ds_read_b64_tr_b16 a[250:251], v4 offset:51008
v_mfma_f32_16x16x32_bf16 v[116:119], v[208:211], a[164:167], v[116:119]
v_exp_f32 v127, v127
v_mfma_f32_16x16x32_bf16 v[116:119], v[212:215], a[168:171], v[116:119]
v_cvt_pk_bf16_f32 v135, v126, v127
s_add_u32 m0, s48, 16928
v_mfma_f32_16x16x32_bf16 v[116:119], v[216:219], a[172:175], v[116:119]
s_waitcnt vmcnt(4)
buffer_load_dwordx4 v1, s[24:27], s45 offen offset:1024 nt lds
v_mfma_f32_16x16x32_bf16 v[64:67], a[192:195], v[132:135], v[64:67]
v_exp_f32 v112, v112
v_mfma_f32_16x16x32_bf16 v[68:71], a[196:199], v[132:135], v[68:71]
ds_read_b64_tr_b16 a[252:253], v4 offset:50784
v_mfma_f32_16x16x32_bf16 v[72:75], a[200:203], v[132:135], v[72:75]
v_exp_f32 v113, v113
v_mfma_f32_16x16x32_bf16 v[76:79], a[204:207], v[132:135], v[76:79]
v_cvt_pk_bf16_f32 v128, v112, v113
s_add_u32 m0, s48, 16960
v_mfma_f32_16x16x32_bf16 a[48:51], a[208:211], v[132:135], a[48:51]
v_exp_f32 v114, v114
v_mfma_f32_16x16x32_bf16 a[52:55], a[212:215], v[132:135], a[52:55]
ds_read_b64_tr_b16 a[254:255], v4 offset:51040
s_waitcnt vmcnt(3)
buffer_load_dwordx4 v1, s[24:27], s45 offen offset:2048 nt lds
v_mfma_f32_16x16x32_bf16 a[56:59], a[216:219], v[132:135], a[56:59]
v_exp_f32 v115, v115
v_mfma_f32_16x16x32_bf16 a[60:63], a[220:223], v[132:135], a[60:63]
v_cvt_pk_bf16_f32 v129, v114, v115
v_mfma_f32_16x16x32_bf16 v[172:175], v[184:187], v[132:135], v[172:175]
v_exp_f32 v116, v116
v_mfma_f32_16x16x32_bf16 v[120:123], v[188:191], a[176:179], v[156:159]
v_mfma_f32_16x16x32_bf16 v[120:123], v[192:195], a[180:183], v[120:123]
v_exp_f32 v117, v117
v_mfma_f32_16x16x32_bf16 v[120:123], v[196:199], a[184:187], v[120:123]
v_cvt_pk_bf16_f32 v130, v116, v117
v_mfma_f32_16x16x32_bf16 v[120:123], v[200:203], a[188:191], v[120:123]
v_exp_f32 v118, v118
v_mfma_f32_16x16x32_bf16 v[124:127], v[204:207], a[176:179], v[156:159]
v_mfma_f32_16x16x32_bf16 v[124:127], v[208:211], a[180:183], v[124:127]
v_exp_f32 v119, v119
v_mfma_f32_16x16x32_bf16 v[124:127], v[212:215], a[184:187], v[124:127]
v_cvt_pk_bf16_f32 v131, v118, v119
s_add_u32 m0, s48, 16992
v_mfma_f32_16x16x32_bf16 v[124:127], v[216:219], a[188:191], v[124:127]
s_waitcnt vmcnt(3)
buffer_load_dwordx4 v1, s[24:27], s45 offen offset:3072 nt lds
v_mfma_f32_16x16x32_bf16 v[80:83], a[192:195], v[128:131], v[80:83]
v_exp_f32 v120, v120
v_mfma_f32_16x16x32_bf16 v[84:87], a[196:199], v[128:131], v[84:87]
v_mfma_f32_16x16x32_bf16 v[88:91], a[200:203], v[128:131], v[88:91]
v_exp_f32 v121, v121
v_mfma_f32_16x16x32_bf16 v[92:95], a[204:207], v[128:131], v[92:95]
v_cvt_pk_bf16_f32 v132, v120, v121
s_add_u32 s45, s45, 16384
v_mfma_f32_16x16x32_bf16 a[64:67], a[208:211], v[128:131], a[64:67]
v_exp_f32 v122, v122
v_mfma_f32_16x16x32_bf16 a[68:71], a[212:215], v[128:131], a[68:71]
v_mfma_f32_16x16x32_bf16 a[72:75], a[216:219], v[128:131], a[72:75]
v_exp_f32 v123, v123
v_mfma_f32_16x16x32_bf16 a[76:79], a[220:223], v[128:131], a[76:79]
v_cvt_pk_bf16_f32 v133, v122, v123
v_mfma_f32_16x16x32_bf16 v[176:179], v[184:187], v[128:131], v[176:179]
v_exp_f32 v124, v124
s_waitcnt vmcnt(8) lgkmcnt(0)
s_barrier
v_mfma_f32_16x16x32_bf16 v[112:115], v[220:223], a[96:99], v[136:139]
ds_read_b128 v[188:191], v2 offset:0
ds_read_b128 v[192:195], v2 offset:16
v_mfma_f32_16x16x32_bf16 v[112:115], v[224:227], a[100:103], v[112:115]
v_exp_f32 v125, v125
v_mfma_f32_16x16x32_bf16 v[112:115], v[228:231], a[104:107], v[112:115]
v_cvt_pk_bf16_f32 v134, v124, v125
v_mfma_f32_16x16x32_bf16 v[112:115], v[232:235], a[108:111], v[112:115]
v_exp_f32 v126, v126
v_mfma_f32_16x16x32_bf16 v[116:119], v[236:239], a[96:99], v[136:139]
ds_read_b128 v[196:199], v2 offset:32
ds_read_b128 v[200:203], v2 offset:48
v_mfma_f32_16x16x32_bf16 v[116:119], v[240:243], a[100:103], v[116:119]
v_exp_f32 v127, v127
v_mfma_f32_16x16x32_bf16 v[116:119], v[244:247], a[104:107], v[116:119]
v_cvt_pk_bf16_f32 v135, v126, v127
s_add_u32 m0, s47, 33280
v_mfma_f32_16x16x32_bf16 v[116:119], v[248:251], a[108:111], v[116:119]
s_waitcnt vmcnt(4)
buffer_load_dwordx4 v1, s[20:23], s45 offen offset:0 nt lds
v_mfma_f32_16x16x32_bf16 v[96:99], a[192:195], v[132:135], v[96:99]
v_exp_f32 v112, v112
v_mfma_f32_16x16x32_bf16 v[100:103], a[196:199], v[132:135], v[100:103]
ds_read_b128 v[204:207], v2 offset:256
ds_read_b128 v[208:211], v2 offset:272
v_mfma_f32_16x16x32_bf16 v[104:107], a[200:203], v[132:135], v[104:107]
v_exp_f32 v113, v113
v_mfma_f32_16x16x32_bf16 v[108:111], a[204:207], v[132:135], v[108:111]
v_cvt_pk_bf16_f32 v128, v112, v113
v_mfma_f32_16x16x32_bf16 a[80:83], a[208:211], v[132:135], a[80:83]
v_exp_f32 v114, v114
v_mfma_f32_16x16x32_bf16 a[84:87], a[212:215], v[132:135], a[84:87]
ds_read_b128 v[212:215], v2 offset:288
ds_read_b128 v[216:219], v2 offset:304
v_mfma_f32_16x16x32_bf16 a[88:91], a[216:219], v[132:135], a[88:91]
v_exp_f32 v115, v115
v_mfma_f32_16x16x32_bf16 a[92:95], a[220:223], v[132:135], a[92:95]
v_cvt_pk_bf16_f32 v129, v114, v115
v_mfma_f32_16x16x32_bf16 v[180:183], v[184:187], v[132:135], v[180:183]
v_exp_f32 v116, v116
v_mfma_f32_16x16x32_bf16 v[120:123], v[220:223], a[112:115], v[140:143]
ds_read_b64_tr_b16 a[192:193], v3 offset:0
v_mfma_f32_16x16x32_bf16 v[120:123], v[224:227], a[116:119], v[120:123]
v_exp_f32 v117, v117
v_mfma_f32_16x16x32_bf16 v[120:123], v[228:231], a[120:123], v[120:123]
v_cvt_pk_bf16_f32 v130, v116, v117
v_mfma_f32_16x16x32_bf16 v[120:123], v[232:235], a[124:127], v[120:123]
v_exp_f32 v118, v118
v_mfma_f32_16x16x32_bf16 v[124:127], v[236:239], a[112:115], v[140:143]
ds_read_b64_tr_b16 a[194:195], v3 offset:256
v_mfma_f32_16x16x32_bf16 v[124:127], v[240:243], a[116:119], v[124:127]
v_exp_f32 v119, v119
v_mfma_f32_16x16x32_bf16 v[124:127], v[244:247], a[120:123], v[124:127]
v_cvt_pk_bf16_f32 v131, v118, v119
s_add_u32 m0, s47, 33296
v_mfma_f32_16x16x32_bf16 v[124:127], v[248:251], a[124:127], v[124:127]
s_waitcnt vmcnt(4)
buffer_load_dwordx4 v1, s[20:23], s45 offen offset:1024 nt lds
v_mfma_f32_16x16x32_bf16 v[16:19], a[224:227], v[128:131], v[16:19]
v_exp_f32 v120, v120
v_mfma_f32_16x16x32_bf16 v[20:23], a[228:231], v[128:131], v[20:23]
ds_read_b64_tr_b16 a[196:197], v3 offset:32
v_mfma_f32_16x16x32_bf16 v[24:27], a[232:235], v[128:131], v[24:27]
v_exp_f32 v121, v121
v_mfma_f32_16x16x32_bf16 v[28:31], a[236:239], v[128:131], v[28:31]
v_cvt_pk_bf16_f32 v132, v120, v121
s_add_u32 m0, s47, 33312
v_mfma_f32_16x16x32_bf16 a[0:3], a[240:243], v[128:131], a[0:3]
v_exp_f32 v122, v122
v_mfma_f32_16x16x32_bf16 a[4:7], a[244:247], v[128:131], a[4:7]
ds_read_b64_tr_b16 a[198:199], v3 offset:288
s_waitcnt vmcnt(4)
buffer_load_dwordx4 v1, s[20:23], s45 offen offset:2048 nt lds
v_mfma_f32_16x16x32_bf16 a[8:11], a[248:251], v[128:131], a[8:11]
v_exp_f32 v123, v123
v_mfma_f32_16x16x32_bf16 a[12:15], a[252:255], v[128:131], a[12:15]
v_cvt_pk_bf16_f32 v133, v122, v123
v_mfma_f32_16x16x32_bf16 v[160:163], v[184:187], v[128:131], v[160:163]
v_exp_f32 v124, v124
v_mfma_f32_16x16x32_bf16 v[112:115], v[220:223], a[128:131], v[144:147]
ds_read_b64_tr_b16 a[200:201], v3 offset:64
v_mfma_f32_16x16x32_bf16 v[112:115], v[224:227], a[132:135], v[112:115]
v_exp_f32 v125, v125
v_mfma_f32_16x16x32_bf16 v[112:115], v[228:231], a[136:139], v[112:115]
v_cvt_pk_bf16_f32 v134, v124, v125
v_mfma_f32_16x16x32_bf16 v[112:115], v[232:235], a[140:143], v[112:115]
v_exp_f32 v126, v126
v_mfma_f32_16x16x32_bf16 v[116:119], v[236:239], a[128:131], v[144:147]
ds_read_b64_tr_b16 a[202:203], v3 offset:320
v_mfma_f32_16x16x32_bf16 v[116:119], v[240:243], a[132:135], v[116:119]
v_exp_f32 v127, v127
v_mfma_f32_16x16x32_bf16 v[116:119], v[244:247], a[136:139], v[116:119]
v_cvt_pk_bf16_f32 v135, v126, v127
s_add_u32 m0, s47, 33328
v_mfma_f32_16x16x32_bf16 v[116:119], v[248:251], a[140:143], v[116:119]
s_waitcnt vmcnt(4)
buffer_load_dwordx4 v1, s[20:23], s45 offen offset:3072 nt lds
v_mfma_f32_16x16x32_bf16 v[32:35], a[224:227], v[132:135], v[32:35]
v_exp_f32 v112, v112
v_mfma_f32_16x16x32_bf16 v[36:39], a[228:231], v[132:135], v[36:39]
ds_read_b64_tr_b16 a[204:205], v3 offset:96
v_mfma_f32_16x16x32_bf16 v[40:43], a[232:235], v[132:135], v[40:43]
v_exp_f32 v113, v113
v_mfma_f32_16x16x32_bf16 v[44:47], a[236:239], v[132:135], v[44:47]
v_cvt_pk_bf16_f32 v128, v112, v113
v_mfma_f32_16x16x32_bf16 a[16:19], a[240:243], v[132:135], a[16:19]
v_exp_f32 v114, v114
v_mfma_f32_16x16x32_bf16 a[20:23], a[244:247], v[132:135], a[20:23]
ds_read_b64_tr_b16 a[206:207], v3 offset:352
v_mfma_f32_16x16x32_bf16 a[24:27], a[248:251], v[132:135], a[24:27]
v_exp_f32 v115, v115
v_mfma_f32_16x16x32_bf16 a[28:31], a[252:255], v[132:135], a[28:31]
v_cvt_pk_bf16_f32 v129, v114, v115
v_mfma_f32_16x16x32_bf16 v[164:167], v[184:187], v[132:135], v[164:167]
v_exp_f32 v116, v116
v_mfma_f32_16x16x32_bf16 v[120:123], v[220:223], a[144:147], v[148:151]
ds_read_b64_tr_b16 a[208:209], v4 offset:0
v_mfma_f32_16x16x32_bf16 v[120:123], v[224:227], a[148:151], v[120:123]
v_exp_f32 v117, v117
v_mfma_f32_16x16x32_bf16 v[120:123], v[228:231], a[152:155], v[120:123]
v_cvt_pk_bf16_f32 v130, v116, v117
v_mfma_f32_16x16x32_bf16 v[120:123], v[232:235], a[156:159], v[120:123]
v_exp_f32 v118, v118
v_mfma_f32_16x16x32_bf16 v[124:127], v[236:239], a[144:147], v[148:151]
ds_read_b64_tr_b16 a[210:211], v4 offset:256
v_mfma_f32_16x16x32_bf16 v[124:127], v[240:243], a[148:151], v[124:127]
v_exp_f32 v119, v119
v_mfma_f32_16x16x32_bf16 v[124:127], v[244:247], a[152:155], v[124:127]
v_cvt_pk_bf16_f32 v131, v118, v119
s_add_u32 m0, s48, 33792
v_mfma_f32_16x16x32_bf16 v[124:127], v[248:251], a[156:159], v[124:127]
s_waitcnt vmcnt(4)
buffer_load_dwordx4 v1, s[24:27], s45 offen offset:0 nt lds
v_mfma_f32_16x16x32_bf16 v[48:51], a[224:227], v[128:131], v[48:51]
v_exp_f32 v120, v120
v_mfma_f32_16x16x32_bf16 v[52:55], a[228:231], v[128:131], v[52:55]
ds_read_b64_tr_b16 a[212:213], v4 offset:32
v_mfma_f32_16x16x32_bf16 v[56:59], a[232:235], v[128:131], v[56:59]
v_exp_f32 v121, v121
v_mfma_f32_16x16x32_bf16 v[60:63], a[236:239], v[128:131], v[60:63]
v_cvt_pk_bf16_f32 v132, v120, v121
v_mfma_f32_16x16x32_bf16 a[32:35], a[240:243], v[128:131], a[32:35]
v_exp_f32 v122, v122
v_mfma_f32_16x16x32_bf16 a[36:39], a[244:247], v[128:131], a[36:39]
ds_read_b64_tr_b16 a[214:215], v4 offset:288
v_mfma_f32_16x16x32_bf16 a[40:43], a[248:251], v[128:131], a[40:43]
v_exp_f32 v123, v123
v_mfma_f32_16x16x32_bf16 a[44:47], a[252:255], v[128:131], a[44:47]
v_cvt_pk_bf16_f32 v133, v122, v123
v_mfma_f32_16x16x32_bf16 v[168:171], v[184:187], v[128:131], v[168:171]
v_exp_f32 v124, v124
v_mfma_f32_16x16x32_bf16 v[112:115], v[220:223], a[160:163], v[152:155]
ds_read_b64_tr_b16 a[216:217], v4 offset:64
v_mfma_f32_16x16x32_bf16 v[112:115], v[224:227], a[164:167], v[112:115]
v_exp_f32 v125, v125
v_mfma_f32_16x16x32_bf16 v[112:115], v[228:231], a[168:171], v[112:115]
v_cvt_pk_bf16_f32 v134, v124, v125
v_mfma_f32_16x16x32_bf16 v[112:115], v[232:235], a[172:175], v[112:115]
v_exp_f32 v126, v126
v_mfma_f32_16x16x32_bf16 v[116:119], v[236:239], a[160:163], v[152:155]
ds_read_b64_tr_b16 a[218:219], v4 offset:320
v_mfma_f32_16x16x32_bf16 v[116:119], v[240:243], a[164:167], v[116:119]
v_exp_f32 v127, v127
v_mfma_f32_16x16x32_bf16 v[116:119], v[244:247], a[168:171], v[116:119]
v_cvt_pk_bf16_f32 v135, v126, v127
s_add_u32 m0, s48, 33824
v_mfma_f32_16x16x32_bf16 v[116:119], v[248:251], a[172:175], v[116:119]
s_waitcnt vmcnt(4)
buffer_load_dwordx4 v1, s[24:27], s45 offen offset:1024 nt lds
v_mfma_f32_16x16x32_bf16 v[64:67], a[224:227], v[132:135], v[64:67]
v_exp_f32 v112, v112
v_mfma_f32_16x16x32_bf16 v[68:71], a[228:231], v[132:135], v[68:71]
ds_read_b64_tr_b16 a[220:221], v4 offset:96
v_mfma_f32_16x16x32_bf16 v[72:75], a[232:235], v[132:135], v[72:75]
v_exp_f32 v113, v113
v_mfma_f32_16x16x32_bf16 v[76:79], a[236:239], v[132:135], v[76:79]
v_cvt_pk_bf16_f32 v128, v112, v113
s_add_u32 m0, s48, 33856
v_mfma_f32_16x16x32_bf16 a[48:51], a[240:243], v[132:135], a[48:51]
v_exp_f32 v114, v114
v_mfma_f32_16x16x32_bf16 a[52:55], a[244:247], v[132:135], a[52:55]
ds_read_b64_tr_b16 a[222:223], v4 offset:352
s_waitcnt vmcnt(3)
buffer_load_dwordx4 v1, s[24:27], s45 offen offset:2048 nt lds
v_mfma_f32_16x16x32_bf16 a[56:59], a[248:251], v[132:135], a[56:59]
v_exp_f32 v115, v115
v_mfma_f32_16x16x32_bf16 a[60:63], a[252:255], v[132:135], a[60:63]
v_cvt_pk_bf16_f32 v129, v114, v115
v_mfma_f32_16x16x32_bf16 v[172:175], v[184:187], v[132:135], v[172:175]
v_exp_f32 v116, v116
v_mfma_f32_16x16x32_bf16 v[120:123], v[220:223], a[176:179], v[156:159]
v_mfma_f32_16x16x32_bf16 v[120:123], v[224:227], a[180:183], v[120:123]
v_exp_f32 v117, v117
v_mfma_f32_16x16x32_bf16 v[120:123], v[228:231], a[184:187], v[120:123]
v_cvt_pk_bf16_f32 v130, v116, v117
v_mfma_f32_16x16x32_bf16 v[120:123], v[232:235], a[188:191], v[120:123]
v_exp_f32 v118, v118
v_mfma_f32_16x16x32_bf16 v[124:127], v[236:239], a[176:179], v[156:159]
v_mfma_f32_16x16x32_bf16 v[124:127], v[240:243], a[180:183], v[124:127]
v_exp_f32 v119, v119
v_mfma_f32_16x16x32_bf16 v[124:127], v[244:247], a[184:187], v[124:127]
v_cvt_pk_bf16_f32 v131, v118, v119
s_add_u32 m0, s48, 33888
v_mfma_f32_16x16x32_bf16 v[124:127], v[248:251], a[188:191], v[124:127]
s_waitcnt vmcnt(3)
buffer_load_dwordx4 v1, s[24:27], s45 offen offset:3072 nt lds
v_mfma_f32_16x16x32_bf16 v[80:83], a[224:227], v[128:131], v[80:83]
v_exp_f32 v120, v120
v_mfma_f32_16x16x32_bf16 v[84:87], a[228:231], v[128:131], v[84:87]
v_mfma_f32_16x16x32_bf16 v[88:91], a[232:235], v[128:131], v[88:91]
v_exp_f32 v121, v121
v_mfma_f32_16x16x32_bf16 v[92:95], a[236:239], v[128:131], v[92:95]
v_cvt_pk_bf16_f32 v132, v120, v121
s_add_u32 s45, s45, 16384
v_mfma_f32_16x16x32_bf16 a[64:67], a[240:243], v[128:131], a[64:67]
v_exp_f32 v122, v122
v_mfma_f32_16x16x32_bf16 a[68:71], a[244:247], v[128:131], a[68:71]
v_mfma_f32_16x16x32_bf16 a[72:75], a[248:251], v[128:131], a[72:75]
v_exp_f32 v123, v123
v_mfma_f32_16x16x32_bf16 a[76:79], a[252:255], v[128:131], a[76:79]
v_cvt_pk_bf16_f32 v133, v122, v123
v_mfma_f32_16x16x32_bf16 v[176:179], v[184:187], v[128:131], v[176:179]
v_exp_f32 v124, v124
s_waitcnt vmcnt(8) lgkmcnt(0)
s_barrier
v_mfma_f32_16x16x32_bf16 v[112:115], v[188:191], a[96:99], v[136:139]
ds_read_b128 v[220:223], v2 offset:16640
ds_read_b128 v[224:227], v2 offset:16656
v_mfma_f32_16x16x32_bf16 v[112:115], v[192:195], a[100:103], v[112:115]
v_exp_f32 v125, v125
v_mfma_f32_16x16x32_bf16 v[112:115], v[196:199], a[104:107], v[112:115]
v_cvt_pk_bf16_f32 v134, v124, v125
v_mfma_f32_16x16x32_bf16 v[112:115], v[200:203], a[108:111], v[112:115]
v_exp_f32 v126, v126
v_mfma_f32_16x16x32_bf16 v[116:119], v[204:207], a[96:99], v[136:139]
ds_read_b128 v[228:231], v2 offset:16672
ds_read_b128 v[232:235], v2 offset:16688
v_mfma_f32_16x16x32_bf16 v[116:119], v[208:211], a[100:103], v[116:119]
v_exp_f32 v127, v127
v_mfma_f32_16x16x32_bf16 v[116:119], v[212:215], a[104:107], v[116:119]
v_cvt_pk_bf16_f32 v135, v126, v127
s_add_u32 m0, s47, 49920
v_mfma_f32_16x16x32_bf16 v[116:119], v[216:219], a[108:111], v[116:119]
s_waitcnt vmcnt(4)
buffer_load_dwordx4 v1, s[20:23], s45 offen offset:0 nt lds
v_mfma_f32_16x16x32_bf16 v[96:99], a[224:227], v[132:135], v[96:99]
v_exp_f32 v112, v112
v_mfma_f32_16x16x32_bf16 v[100:103], a[228:231], v[132:135], v[100:103]
ds_read_b128 v[236:239], v2 offset:16896
ds_read_b128 v[240:243], v2 offset:16912
v_mfma_f32_16x16x32_bf16 v[104:107], a[232:235], v[132:135], v[104:107]
v_exp_f32 v113, v113
v_mfma_f32_16x16x32_bf16 v[108:111], a[236:239], v[132:135], v[108:111]
v_cvt_pk_bf16_f32 v128, v112, v113
v_mfma_f32_16x16x32_bf16 a[80:83], a[240:243], v[132:135], a[80:83]
v_exp_f32 v114, v114
v_mfma_f32_16x16x32_bf16 a[84:87], a[244:247], v[132:135], a[84:87]
ds_read_b128 v[244:247], v2 offset:16928
ds_read_b128 v[248:251], v2 offset:16944
v_mfma_f32_16x16x32_bf16 a[88:91], a[248:251], v[132:135], a[88:91]
v_exp_f32 v115, v115
v_mfma_f32_16x16x32_bf16 a[92:95], a[252:255], v[132:135], a[92:95]
v_cvt_pk_bf16_f32 v129, v114, v115
v_mfma_f32_16x16x32_bf16 v[180:183], v[184:187], v[132:135], v[180:183]
v_exp_f32 v116, v116
v_mfma_f32_16x16x32_bf16 v[120:123], v[188:191], a[112:115], v[140:143]
ds_read_b64_tr_b16 a[224:225], v3 offset:16896
v_mfma_f32_16x16x32_bf16 v[120:123], v[192:195], a[116:119], v[120:123]
v_exp_f32 v117, v117
v_mfma_f32_16x16x32_bf16 v[120:123], v[196:199], a[120:123], v[120:123]
v_cvt_pk_bf16_f32 v130, v116, v117
v_mfma_f32_16x16x32_bf16 v[120:123], v[200:203], a[124:127], v[120:123]
v_exp_f32 v118, v118
v_mfma_f32_16x16x32_bf16 v[124:127], v[204:207], a[112:115], v[140:143]
ds_read_b64_tr_b16 a[226:227], v3 offset:17152
v_mfma_f32_16x16x32_bf16 v[124:127], v[208:211], a[116:119], v[124:127]
v_exp_f32 v119, v119
v_mfma_f32_16x16x32_bf16 v[124:127], v[212:215], a[120:123], v[124:127]
v_cvt_pk_bf16_f32 v131, v118, v119
s_add_u32 m0, s47, 49936
v_mfma_f32_16x16x32_bf16 v[124:127], v[216:219], a[124:127], v[124:127]
s_waitcnt vmcnt(4)
buffer_load_dwordx4 v1, s[20:23], s45 offen offset:1024 nt lds
v_mfma_f32_16x16x32_bf16 v[16:19], a[192:195], v[128:131], v[16:19]
v_exp_f32 v120, v120
v_mfma_f32_16x16x32_bf16 v[20:23], a[196:199], v[128:131], v[20:23]
ds_read_b64_tr_b16 a[228:229], v3 offset:16928
v_mfma_f32_16x16x32_bf16 v[24:27], a[200:203], v[128:131], v[24:27]
v_exp_f32 v121, v121
v_mfma_f32_16x16x32_bf16 v[28:31], a[204:207], v[128:131], v[28:31]
v_cvt_pk_bf16_f32 v132, v120, v121
s_add_u32 m0, s47, 49952
v_mfma_f32_16x16x32_bf16 a[0:3], a[208:211], v[128:131], a[0:3]
v_exp_f32 v122, v122
v_mfma_f32_16x16x32_bf16 a[4:7], a[212:215], v[128:131], a[4:7]
ds_read_b64_tr_b16 a[230:231], v3 offset:17184
s_waitcnt vmcnt(4)
buffer_load_dwordx4 v1, s[20:23], s45 offen offset:2048 nt lds
v_mfma_f32_16x16x32_bf16 a[8:11], a[216:219], v[128:131], a[8:11]
v_exp_f32 v123, v123
v_mfma_f32_16x16x32_bf16 a[12:15], a[220:223], v[128:131], a[12:15]
v_cvt_pk_bf16_f32 v133, v122, v123
v_mfma_f32_16x16x32_bf16 v[160:163], v[184:187], v[128:131], v[160:163]
v_exp_f32 v124, v124
v_mfma_f32_16x16x32_bf16 v[112:115], v[188:191], a[128:131], v[144:147]
ds_read_b64_tr_b16 a[232:233], v3 offset:16960
v_mfma_f32_16x16x32_bf16 v[112:115], v[192:195], a[132:135], v[112:115]
v_exp_f32 v125, v125
v_mfma_f32_16x16x32_bf16 v[112:115], v[196:199], a[136:139], v[112:115]
v_cvt_pk_bf16_f32 v134, v124, v125
v_mfma_f32_16x16x32_bf16 v[112:115], v[200:203], a[140:143], v[112:115]
v_exp_f32 v126, v126
v_mfma_f32_16x16x32_bf16 v[116:119], v[204:207], a[128:131], v[144:147]
ds_read_b64_tr_b16 a[234:235], v3 offset:17216
v_mfma_f32_16x16x32_bf16 v[116:119], v[208:211], a[132:135], v[116:119]
v_exp_f32 v127, v127
v_mfma_f32_16x16x32_bf16 v[116:119], v[212:215], a[136:139], v[116:119]
v_cvt_pk_bf16_f32 v135, v126, v127
s_add_u32 m0, s47, 49968
v_mfma_f32_16x16x32_bf16 v[116:119], v[216:219], a[140:143], v[116:119]
s_waitcnt vmcnt(4)
buffer_load_dwordx4 v1, s[20:23], s45 offen offset:3072 nt lds
v_mfma_f32_16x16x32_bf16 v[32:35], a[192:195], v[132:135], v[32:35]
v_exp_f32 v112, v112
v_mfma_f32_16x16x32_bf16 v[36:39], a[196:199], v[132:135], v[36:39]
ds_read_b64_tr_b16 a[236:237], v3 offset:16992
v_mfma_f32_16x16x32_bf16 v[40:43], a[200:203], v[132:135], v[40:43]
v_exp_f32 v113, v113
v_mfma_f32_16x16x32_bf16 v[44:47], a[204:207], v[132:135], v[44:47]
v_cvt_pk_bf16_f32 v128, v112, v113
v_mfma_f32_16x16x32_bf16 a[16:19], a[208:211], v[132:135], a[16:19]
v_exp_f32 v114, v114
v_mfma_f32_16x16x32_bf16 a[20:23], a[212:215], v[132:135], a[20:23]
ds_read_b64_tr_b16 a[238:239], v3 offset:17248
v_mfma_f32_16x16x32_bf16 a[24:27], a[216:219], v[132:135], a[24:27]
v_exp_f32 v115, v115
v_mfma_f32_16x16x32_bf16 a[28:31], a[220:223], v[132:135], a[28:31]
v_cvt_pk_bf16_f32 v129, v114, v115
v_mfma_f32_16x16x32_bf16 v[164:167], v[184:187], v[132:135], v[164:167]
v_exp_f32 v116, v116
v_mfma_f32_16x16x32_bf16 v[120:123], v[188:191], a[144:147], v[148:151]
ds_read_b64_tr_b16 a[240:241], v4 offset:16896
v_mfma_f32_16x16x32_bf16 v[120:123], v[192:195], a[148:151], v[120:123]
v_exp_f32 v117, v117
v_mfma_f32_16x16x32_bf16 v[120:123], v[196:199], a[152:155], v[120:123]
v_cvt_pk_bf16_f32 v130, v116, v117
v_mfma_f32_16x16x32_bf16 v[120:123], v[200:203], a[156:159], v[120:123]
v_exp_f32 v118, v118
v_mfma_f32_16x16x32_bf16 v[124:127], v[204:207], a[144:147], v[148:151]
ds_read_b64_tr_b16 a[242:243], v4 offset:17152
v_mfma_f32_16x16x32_bf16 v[124:127], v[208:211], a[148:151], v[124:127]
v_exp_f32 v119, v119
v_mfma_f32_16x16x32_bf16 v[124:127], v[212:215], a[152:155], v[124:127]
v_cvt_pk_bf16_f32 v131, v118, v119
s_add_u32 m0, s48, 50688
v_mfma_f32_16x16x32_bf16 v[124:127], v[216:219], a[156:159], v[124:127]
s_waitcnt vmcnt(4)
buffer_load_dwordx4 v1, s[24:27], s45 offen offset:0 nt lds
v_mfma_f32_16x16x32_bf16 v[48:51], a[192:195], v[128:131], v[48:51]
v_exp_f32 v120, v120
v_mfma_f32_16x16x32_bf16 v[52:55], a[196:199], v[128:131], v[52:55]
ds_read_b64_tr_b16 a[244:245], v4 offset:16928
v_mfma_f32_16x16x32_bf16 v[56:59], a[200:203], v[128:131], v[56:59]
v_exp_f32 v121, v121
v_mfma_f32_16x16x32_bf16 v[60:63], a[204:207], v[128:131], v[60:63]
v_cvt_pk_bf16_f32 v132, v120, v121
v_mfma_f32_16x16x32_bf16 a[32:35], a[208:211], v[128:131], a[32:35]
v_exp_f32 v122, v122
v_mfma_f32_16x16x32_bf16 a[36:39], a[212:215], v[128:131], a[36:39]
ds_read_b64_tr_b16 a[246:247], v4 offset:17184
v_mfma_f32_16x16x32_bf16 a[40:43], a[216:219], v[128:131], a[40:43]
v_exp_f32 v123, v123
v_mfma_f32_16x16x32_bf16 a[44:47], a[220:223], v[128:131], a[44:47]
v_cvt_pk_bf16_f32 v133, v122, v123
v_mfma_f32_16x16x32_bf16 v[168:171], v[184:187], v[128:131], v[168:171]
v_exp_f32 v124, v124
v_mfma_f32_16x16x32_bf16 v[112:115], v[188:191], a[160:163], v[152:155]
ds_read_b64_tr_b16 a[248:249], v4 offset:16960
v_mfma_f32_16x16x32_bf16 v[112:115], v[192:195], a[164:167], v[112:115]
v_exp_f32 v125, v125
v_mfma_f32_16x16x32_bf16 v[112:115], v[196:199], a[168:171], v[112:115]
v_cvt_pk_bf16_f32 v134, v124, v125
v_mfma_f32_16x16x32_bf16 v[112:115], v[200:203], a[172:175], v[112:115]
v_exp_f32 v126, v126
v_mfma_f32_16x16x32_bf16 v[116:119], v[204:207], a[160:163], v[152:155]
ds_read_b64_tr_b16 a[250:251], v4 offset:17216
v_mfma_f32_16x16x32_bf16 v[116:119], v[208:211], a[164:167], v[116:119]
v_exp_f32 v127, v127
v_mfma_f32_16x16x32_bf16 v[116:119], v[212:215], a[168:171], v[116:119]
v_cvt_pk_bf16_f32 v135, v126, v127
s_add_u32 m0, s48, 50720
v_mfma_f32_16x16x32_bf16 v[116:119], v[216:219], a[172:175], v[116:119]
s_waitcnt vmcnt(4)
buffer_load_dwordx4 v1, s[24:27], s45 offen offset:1024 nt lds
v_mfma_f32_16x16x32_bf16 v[64:67], a[192:195], v[132:135], v[64:67]
v_exp_f32 v112, v112
v_mfma_f32_16x16x32_bf16 v[68:71], a[196:199], v[132:135], v[68:71]
ds_read_b64_tr_b16 a[252:253], v4 offset:16992
v_mfma_f32_16x16x32_bf16 v[72:75], a[200:203], v[132:135], v[72:75]
v_exp_f32 v113, v113
v_mfma_f32_16x16x32_bf16 v[76:79], a[204:207], v[132:135], v[76:79]
v_cvt_pk_bf16_f32 v128, v112, v113
s_add_u32 m0, s48, 50752
v_mfma_f32_16x16x32_bf16 a[48:51], a[208:211], v[132:135], a[48:51]
v_exp_f32 v114, v114
v_mfma_f32_16x16x32_bf16 a[52:55], a[212:215], v[132:135], a[52:55]
ds_read_b64_tr_b16 a[254:255], v4 offset:17248
s_waitcnt vmcnt(3)
buffer_load_dwordx4 v1, s[24:27], s45 offen offset:2048 nt lds
v_mfma_f32_16x16x32_bf16 a[56:59], a[216:219], v[132:135], a[56:59]
v_exp_f32 v115, v115
v_mfma_f32_16x16x32_bf16 a[60:63], a[220:223], v[132:135], a[60:63]
v_cvt_pk_bf16_f32 v129, v114, v115
v_mfma_f32_16x16x32_bf16 v[172:175], v[184:187], v[132:135], v[172:175]
v_exp_f32 v116, v116
v_mfma_f32_16x16x32_bf16 v[120:123], v[188:191], a[176:179], v[156:159]
v_mfma_f32_16x16x32_bf16 v[120:123], v[192:195], a[180:183], v[120:123]
v_exp_f32 v117, v117
v_mfma_f32_16x16x32_bf16 v[120:123], v[196:199], a[184:187], v[120:123]
v_cvt_pk_bf16_f32 v130, v116, v117
v_mfma_f32_16x16x32_bf16 v[120:123], v[200:203], a[188:191], v[120:123]
v_exp_f32 v118, v118
v_mfma_f32_16x16x32_bf16 v[124:127], v[204:207], a[176:179], v[156:159]
v_mfma_f32_16x16x32_bf16 v[124:127], v[208:211], a[180:183], v[124:127]
v_exp_f32 v119, v119
v_mfma_f32_16x16x32_bf16 v[124:127], v[212:215], a[184:187], v[124:127]
v_cvt_pk_bf16_f32 v131, v118, v119
s_add_u32 m0, s48, 50784
v_mfma_f32_16x16x32_bf16 v[124:127], v[216:219], a[188:191], v[124:127]
s_waitcnt vmcnt(3)
buffer_load_dwordx4 v1, s[24:27], s45 offen offset:3072 nt lds
v_mfma_f32_16x16x32_bf16 v[80:83], a[192:195], v[128:131], v[80:83]
v_exp_f32 v120, v120
v_mfma_f32_16x16x32_bf16 v[84:87], a[196:199], v[128:131], v[84:87]
v_mfma_f32_16x16x32_bf16 v[88:91], a[200:203], v[128:131], v[88:91]
v_exp_f32 v121, v121
v_mfma_f32_16x16x32_bf16 v[92:95], a[204:207], v[128:131], v[92:95]
v_cvt_pk_bf16_f32 v132, v120, v121
s_add_u32 s45, s45, 16384
v_mfma_f32_16x16x32_bf16 a[64:67], a[208:211], v[128:131], a[64:67]
v_exp_f32 v122, v122
v_mfma_f32_16x16x32_bf16 a[68:71], a[212:215], v[128:131], a[68:71]
v_mfma_f32_16x16x32_bf16 a[72:75], a[216:219], v[128:131], a[72:75]
v_exp_f32 v123, v123
v_mfma_f32_16x16x32_bf16 a[76:79], a[220:223], v[128:131], a[76:79]
v_cvt_pk_bf16_f32 v133, v122, v123
v_mfma_f32_16x16x32_bf16 v[176:179], v[184:187], v[128:131], v[176:179]
v_exp_f32 v124, v124
s_add_u32 s49, s49, 1
s_cmp_lt_u32 s49, 7
s_cbranch_scc1 L_loop1
L_loopdone:
s_waitcnt vmcnt(8) lgkmcnt(0)
s_barrier
v_mfma_f32_16x16x32_bf16 v[112:115], v[220:223], a[96:99], v[136:139]
ds_read_b128 v[188:191], v2 offset:33280
ds_read_b128 v[192:195], v2 offset:33296
v_mfma_f32_16x16x32_bf16 v[112:115], v[224:227], a[100:103], v[112:115]
v_exp_f32 v125, v125
v_mfma_f32_16x16x32_bf16 v[112:115], v[228:231], a[104:107], v[112:115]
v_cvt_pk_bf16_f32 v134, v124, v125
v_mfma_f32_16x16x32_bf16 v[112:115], v[232:235], a[108:111], v[112:115]
v_exp_f32 v126, v126
v_mfma_f32_16x16x32_bf16 v[116:119], v[236:239], a[96:99], v[136:139]
ds_read_b128 v[196:199], v2 offset:33312
ds_read_b128 v[200:203], v2 offset:33328
v_mfma_f32_16x16x32_bf16 v[116:119], v[240:243], a[100:103], v[116:119]
v_exp_f32 v127, v127
v_mfma_f32_16x16x32_bf16 v[116:119], v[244:247], a[104:107], v[116:119]
v_cvt_pk_bf16_f32 v135, v126, v127
v_mfma_f32_16x16x32_bf16 v[116:119], v[248:251], a[108:111], v[116:119]
s_nop 0
v_mfma_f32_16x16x32_bf16 v[96:99], a[192:195], v[132:135], v[96:99]
v_exp_f32 v112, v112
v_mfma_f32_16x16x32_bf16 v[100:103], a[196:199], v[132:135], v[100:103]
ds_read_b128 v[204:207], v2 offset:33536
ds_read_b128 v[208:211], v2 offset:33552
v_mfma_f32_16x16x32_bf16 v[104:107], a[200:203], v[132:135], v[104:107]
v_exp_f32 v113, v113
v_mfma_f32_16x16x32_bf16 v[108:111], a[204:207], v[132:135], v[108:111]
v_cvt_pk_bf16_f32 v128, v112, v113
v_mfma_f32_16x16x32_bf16 a[80:83], a[208:211], v[132:135], a[80:83]
v_exp_f32 v114, v114
v_mfma_f32_16x16x32_bf16 a[84:87], a[212:215], v[132:135], a[84:87]
ds_read_b128 v[212:215], v2 offset:33568
ds_read_b128 v[216:219], v2 offset:33584
v_mfma_f32_16x16x32_bf16 a[88:91], a[216:219], v[132:135], a[88:91]
v_exp_f32 v115, v115
v_mfma_f32_16x16x32_bf16 a[92:95], a[220:223], v[132:135], a[92:95]
v_cvt_pk_bf16_f32 v129, v114, v115
v_mfma_f32_16x16x32_bf16 v[180:183], v[184:187], v[132:135], v[180:183]
v_exp_f32 v116, v116
v_mfma_f32_16x16x32_bf16 v[120:123], v[220:223], a[112:115], v[140:143]
ds_read_b64_tr_b16 a[192:193], v3 offset:33792
v_mfma_f32_16x16x32_bf16 v[120:123], v[224:227], a[116:119], v[120:123]
v_exp_f32 v117, v117
v_mfma_f32_16x16x32_bf16 v[120:123], v[228:231], a[120:123], v[120:123]
v_cvt_pk_bf16_f32 v130, v116, v117
v_mfma_f32_16x16x32_bf16 v[120:123], v[232:235], a[124:127], v[120:123]
v_exp_f32 v118, v118
v_mfma_f32_16x16x32_bf16 v[124:127], v[236:239], a[112:115], v[140:143]
ds_read_b64_tr_b16 a[194:195], v3 offset:34048
v_mfma_f32_16x16x32_bf16 v[124:127], v[240:243], a[116:119], v[124:127]
v_exp_f32 v119, v119
v_mfma_f32_16x16x32_bf16 v[124:127], v[244:247], a[120:123], v[124:127]
v_cvt_pk_bf16_f32 v131, v118, v119
v_mfma_f32_16x16x32_bf16 v[124:127], v[248:251], a[124:127], v[124:127]
s_nop 0
v_mfma_f32_16x16x32_bf16 v[16:19], a[224:227], v[128:131], v[16:19]
v_exp_f32 v120, v120
v_mfma_f32_16x16x32_bf16 v[20:23], a[228:231], v[128:131], v[20:23]
ds_read_b64_tr_b16 a[196:197], v3 offset:33824
v_mfma_f32_16x16x32_bf16 v[24:27], a[232:235], v[128:131], v[24:27]
v_exp_f32 v121, v121
v_mfma_f32_16x16x32_bf16 v[28:31], a[236:239], v[128:131], v[28:31]
v_cvt_pk_bf16_f32 v132, v120, v121
v_mfma_f32_16x16x32_bf16 a[0:3], a[240:243], v[128:131], a[0:3]
v_exp_f32 v122, v122
v_mfma_f32_16x16x32_bf16 a[4:7], a[244:247], v[128:131], a[4:7]
ds_read_b64_tr_b16 a[198:199], v3 offset:34080
v_mfma_f32_16x16x32_bf16 a[8:11], a[248:251], v[128:131], a[8:11]
v_exp_f32 v123, v123
v_mfma_f32_16x16x32_bf16 a[12:15], a[252:255], v[128:131], a[12:15]
v_cvt_pk_bf16_f32 v133, v122, v123
v_mfma_f32_16x16x32_bf16 v[160:163], v[184:187], v[128:131], v[160:163]
v_exp_f32 v124, v124
v_mfma_f32_16x16x32_bf16 v[112:115], v[220:223], a[128:131], v[144:147]
ds_read_b64_tr_b16 a[200:201], v3 offset:33856
v_mfma_f32_16x16x32_bf16 v[112:115], v[224:227], a[132:135], v[112:115]
v_exp_f32 v125, v125
v_mfma_f32_16x16x32_bf16 v[112:115], v[228:231], a[136:139], v[112:115]
v_cvt_pk_bf16_f32 v134, v124, v125
v_mfma_f32_16x16x32_bf16 v[112:115], v[232:235], a[140:143], v[112:115]
v_exp_f32 v126, v126
v_mfma_f32_16x16x32_bf16 v[116:119], v[236:239], a[128:131], v[144:147]
ds_read_b64_tr_b16 a[202:203], v3 offset:34112
v_mfma_f32_16x16x32_bf16 v[116:119], v[240:243], a[132:135], v[116:119]
v_exp_f32 v127, v127
v_mfma_f32_16x16x32_bf16 v[116:119], v[244:247], a[136:139], v[116:119]
v_cvt_pk_bf16_f32 v135, v126, v127
v_mfma_f32_16x16x32_bf16 v[116:119], v[248:251], a[140:143], v[116:119]
s_nop 0
v_mfma_f32_16x16x32_bf16 v[32:35], a[224:227], v[132:135], v[32:35]
v_exp_f32 v112, v112
v_mfma_f32_16x16x32_bf16 v[36:39], a[228:231], v[132:135], v[36:39]
ds_read_b64_tr_b16 a[204:205], v3 offset:33888
v_mfma_f32_16x16x32_bf16 v[40:43], a[232:235], v[132:135], v[40:43]
v_exp_f32 v113, v113
v_mfma_f32_16x16x32_bf16 v[44:47], a[236:239], v[132:135], v[44:47]
v_cvt_pk_bf16_f32 v128, v112, v113
v_mfma_f32_16x16x32_bf16 a[16:19], a[240:243], v[132:135], a[16:19]
v_exp_f32 v114, v114
v_mfma_f32_16x16x32_bf16 a[20:23], a[244:247], v[132:135], a[20:23]
ds_read_b64_tr_b16 a[206:207], v3 offset:34144
v_mfma_f32_16x16x32_bf16 a[24:27], a[248:251], v[132:135], a[24:27]
v_exp_f32 v115, v115
v_mfma_f32_16x16x32_bf16 a[28:31], a[252:255], v[132:135], a[28:31]
v_cvt_pk_bf16_f32 v129, v114, v115
v_mfma_f32_16x16x32_bf16 v[164:167], v[184:187], v[132:135], v[164:167]
v_exp_f32 v116, v116
v_mfma_f32_16x16x32_bf16 v[120:123], v[220:223], a[144:147], v[148:151]
ds_read_b64_tr_b16 a[208:209], v4 offset:33792
v_mfma_f32_16x16x32_bf16 v[120:123], v[224:227], a[148:151], v[120:123]
v_exp_f32 v117, v117
v_mfma_f32_16x16x32_bf16 v[120:123], v[228:231], a[152:155], v[120:123]
v_cvt_pk_bf16_f32 v130, v116, v117
v_mfma_f32_16x16x32_bf16 v[120:123], v[232:235], a[156:159], v[120:123]
v_exp_f32 v118, v118
v_mfma_f32_16x16x32_bf16 v[124:127], v[236:239], a[144:147], v[148:151]
ds_read_b64_tr_b16 a[210:211], v4 offset:34048
v_mfma_f32_16x16x32_bf16 v[124:127], v[240:243], a[148:151], v[124:127]
v_exp_f32 v119, v119
v_mfma_f32_16x16x32_bf16 v[124:127], v[244:247], a[152:155], v[124:127]
v_cvt_pk_bf16_f32 v131, v118, v119
s_add_u32 m0, s59, 0
v_mfma_f32_16x16x32_bf16 v[124:127], v[248:251], a[156:159], v[124:127]
buffer_load_dwordx4 v6, s[28:31], s55 offen offset:0  lds
v_mfma_f32_16x16x32_bf16 v[48:51], a[224:227], v[128:131], v[48:51]
v_exp_f32 v120, v120
v_mfma_f32_16x16x32_bf16 v[52:55], a[228:231], v[128:131], v[52:55]
ds_read_b64_tr_b16 a[212:213], v4 offset:33824
v_mfma_f32_16x16x32_bf16 v[56:59], a[232:235], v[128:131], v[56:59]
v_exp_f32 v121, v121
v_mfma_f32_16x16x32_bf16 v[60:63], a[236:239], v[128:131], v[60:63]
v_cvt_pk_bf16_f32 v132, v120, v121
v_mfma_f32_16x16x32_bf16 a[32:35], a[240:243], v[128:131], a[32:35]
v_exp_f32 v122, v122
v_mfma_f32_16x16x32_bf16 a[36:39], a[244:247], v[128:131], a[36:39]
ds_read_b64_tr_b16 a[214:215], v4 offset:34080
v_mfma_f32_16x16x32_bf16 a[40:43], a[248:251], v[128:131], a[40:43]
v_exp_f32 v123, v123
v_mfma_f32_16x16x32_bf16 a[44:47], a[252:255], v[128:131], a[44:47]
v_cvt_pk_bf16_f32 v133, v122, v123
v_mfma_f32_16x16x32_bf16 v[168:171], v[184:187], v[128:131], v[168:171]
v_exp_f32 v124, v124
v_mfma_f32_16x16x32_bf16 v[112:115], v[220:223], a[160:163], v[152:155]
ds_read_b64_tr_b16 a[216:217], v4 offset:33856
v_mfma_f32_16x16x32_bf16 v[112:115], v[224:227], a[164:167], v[112:115]
v_exp_f32 v125, v125
v_mfma_f32_16x16x32_bf16 v[112:115], v[228:231], a[168:171], v[112:115]
v_cvt_pk_bf16_f32 v134, v124, v125
v_mfma_f32_16x16x32_bf16 v[112:115], v[232:235], a[172:175], v[112:115]
v_exp_f32 v126, v126
v_mfma_f32_16x16x32_bf16 v[116:119], v[236:239], a[160:163], v[152:155]
ds_read_b64_tr_b16 a[218:219], v4 offset:34112
v_mfma_f32_16x16x32_bf16 v[116:119], v[240:243], a[164:167], v[116:119]
v_exp_f32 v127, v127
v_mfma_f32_16x16x32_bf16 v[116:119], v[244:247], a[168:171], v[116:119]
v_cvt_pk_bf16_f32 v135, v126, v127
s_add_u32 m0, s59, 32
v_mfma_f32_16x16x32_bf16 v[116:119], v[248:251], a[172:175], v[116:119]
buffer_load_dwordx4 v6, s[28:31], s55 offen offset:1024  lds
v_mfma_f32_16x16x32_bf16 v[64:67], a[224:227], v[132:135], v[64:67]
v_exp_f32 v112, v112
v_mfma_f32_16x16x32_bf16 v[68:71], a[228:231], v[132:135], v[68:71]
ds_read_b64_tr_b16 a[220:221], v4 offset:33888
v_mfma_f32_16x16x32_bf16 v[72:75], a[232:235], v[132:135], v[72:75]
v_exp_f32 v113, v113
v_mfma_f32_16x16x32_bf16 v[76:79], a[236:239], v[132:135], v[76:79]
v_cvt_pk_bf16_f32 v128, v112, v113
s_add_u32 m0, s59, 64
v_mfma_f32_16x16x32_bf16 a[48:51], a[240:243], v[132:135], a[48:51]
v_exp_f32 v114, v114
v_mfma_f32_16x16x32_bf16 a[52:55], a[244:247], v[132:135], a[52:55]
ds_read_b64_tr_b16 a[222:223], v4 offset:34144
buffer_load_dwordx4 v6, s[28:31], s55 offen offset:2048  lds
v_mfma_f32_16x16x32_bf16 a[56:59], a[248:251], v[132:135], a[56:59]
v_exp_f32 v115, v115
v_mfma_f32_16x16x32_bf16 a[60:63], a[252:255], v[132:135], a[60:63]
v_cvt_pk_bf16_f32 v129, v114, v115
v_mfma_f32_16x16x32_bf16 v[172:175], v[184:187], v[132:135], v[172:175]
v_exp_f32 v116, v116
v_mfma_f32_16x16x32_bf16 v[120:123], v[220:223], a[176:179], v[156:159]
v_mfma_f32_16x16x32_bf16 v[120:123], v[224:227], a[180:183], v[120:123]
v_exp_f32 v117, v117
v_mfma_f32_16x16x32_bf16 v[120:123], v[228:231], a[184:187], v[120:123]
v_cvt_pk_bf16_f32 v130, v116, v117
v_mfma_f32_16x16x32_bf16 v[120:123], v[232:235], a[188:191], v[120:123]
v_exp_f32 v118, v118
v_mfma_f32_16x16x32_bf16 v[124:127], v[236:239], a[176:179], v[156:159]
v_mfma_f32_16x16x32_bf16 v[124:127], v[240:243], a[180:183], v[124:127]
v_exp_f32 v119, v119
v_mfma_f32_16x16x32_bf16 v[124:127], v[244:247], a[184:187], v[124:127]
v_cvt_pk_bf16_f32 v131, v118, v119
s_add_u32 m0, s59, 96
v_mfma_f32_16x16x32_bf16 v[124:127], v[248:251], a[188:191], v[124:127]
buffer_load_dwordx4 v6, s[28:31], s55 offen offset:3072  lds
v_mfma_f32_16x16x32_bf16 v[80:83], a[224:227], v[128:131], v[80:83]
v_exp_f32 v120, v120
v_mfma_f32_16x16x32_bf16 v[84:87], a[228:231], v[128:131], v[84:87]
v_mfma_f32_16x16x32_bf16 v[88:91], a[232:235], v[128:131], v[88:91]
v_exp_f32 v121, v121
v_mfma_f32_16x16x32_bf16 v[92:95], a[236:239], v[128:131], v[92:95]
v_cvt_pk_bf16_f32 v132, v120, v121
s_add_u32 s55, s55, 32768
s_and_b32 s55, s55, 0x7ffff
v_mfma_f32_16x16x32_bf16 a[64:67], a[240:243], v[128:131], a[64:67]
v_exp_f32 v122, v122
v_mfma_f32_16x16x32_bf16 a[68:71], a[244:247], v[128:131], a[68:71]
v_mfma_f32_16x16x32_bf16 a[72:75], a[248:251], v[128:131], a[72:75]
v_exp_f32 v123, v123
v_mfma_f32_16x16x32_bf16 a[76:79], a[252:255], v[128:131], a[76:79]
v_cvt_pk_bf16_f32 v133, v122, v123
v_mfma_f32_16x16x32_bf16 v[176:179], v[184:187], v[128:131], v[176:179]
v_exp_f32 v124, v124
s_waitcnt vmcnt(4) lgkmcnt(0)
s_barrier
v_mfma_f32_16x16x32_bf16 v[112:115], v[188:191], a[96:99], v[136:139]
ds_read_b128 v[220:223], v2 offset:49920
ds_read_b128 v[224:227], v2 offset:49936
v_mfma_f32_16x16x32_bf16 v[112:115], v[192:195], a[100:103], v[112:115]
v_exp_f32 v125, v125
v_mfma_f32_16x16x32_bf16 v[112:115], v[196:199], a[104:107], v[112:115]
v_cvt_pk_bf16_f32 v134, v124, v125
v_mfma_f32_16x16x32_bf16 v[112:115], v[200:203], a[108:111], v[112:115]
v_exp_f32 v126, v126
v_mfma_f32_16x16x32_bf16 v[116:119], v[204:207], a[96:99], v[136:139]
ds_read_b128 v[228:231], v2 offset:49952
ds_read_b128 v[232:235], v2 offset:49968
v_mfma_f32_16x16x32_bf16 v[116:119], v[208:211], a[100:103], v[116:119]
v_exp_f32 v127, v127
v_mfma_f32_16x16x32_bf16 v[116:119], v[212:215], a[104:107], v[116:119]
v_cvt_pk_bf16_f32 v135, v126, v127
s_add_u32 m0, s59, 4224
v_mfma_f32_16x16x32_bf16 v[116:119], v[216:219], a[108:111], v[116:119]
buffer_load_dwordx4 v6, s[28:31], s55 offen offset:0  lds
v_mfma_f32_16x16x32_bf16 v[96:99], a[224:227], v[132:135], v[96:99]
v_exp_f32 v112, v112
v_mfma_f32_16x16x32_bf16 v[100:103], a[228:231], v[132:135], v[100:103]
ds_read_b128 v[236:239], v2 offset:50176
ds_read_b128 v[240:243], v2 offset:50192
v_mfma_f32_16x16x32_bf16 v[104:107], a[232:235], v[132:135], v[104:107]
v_exp_f32 v113, v113
v_mfma_f32_16x16x32_bf16 v[108:111], a[236:239], v[132:135], v[108:111]
v_cvt_pk_bf16_f32 v128, v112, v113
v_mfma_f32_16x16x32_bf16 a[80:83], a[240:243], v[132:135], a[80:83]
v_exp_f32 v114, v114
v_mfma_f32_16x16x32_bf16 a[84:87], a[244:247], v[132:135], a[84:87]
ds_read_b128 v[244:247], v2 offset:50208
ds_read_b128 v[248:251], v2 offset:50224
v_mfma_f32_16x16x32_bf16 a[88:91], a[248:251], v[132:135], a[88:91]
v_exp_f32 v115, v115
v_mfma_f32_16x16x32_bf16 a[92:95], a[252:255], v[132:135], a[92:95]
v_cvt_pk_bf16_f32 v129, v114, v115
v_mfma_f32_16x16x32_bf16 v[180:183], v[184:187], v[132:135], v[180:183]
v_exp_f32 v116, v116
v_mfma_f32_16x16x32_bf16 v[120:123], v[188:191], a[112:115], v[140:143]
ds_read_b64_tr_b16 a[224:225], v3 offset:50688
v_mfma_f32_16x16x32_bf16 v[120:123], v[192:195], a[116:119], v[120:123]
v_exp_f32 v117, v117
v_mfma_f32_16x16x32_bf16 v[120:123], v[196:199], a[120:123], v[120:123]
v_cvt_pk_bf16_f32 v130, v116, v117
v_mfma_f32_16x16x32_bf16 v[120:123], v[200:203], a[124:127], v[120:123]
v_exp_f32 v118, v118
v_mfma_f32_16x16x32_bf16 v[124:127], v[204:207], a[112:115], v[140:143]
ds_read_b64_tr_b16 a[226:227], v3 offset:50944
v_mfma_f32_16x16x32_bf16 v[124:127], v[208:211], a[116:119], v[124:127]
v_exp_f32 v119, v119
v_mfma_f32_16x16x32_bf16 v[124:127], v[212:215], a[120:123], v[124:127]
v_cvt_pk_bf16_f32 v131, v118, v119
s_add_u32 m0, s59, 4256
v_mfma_f32_16x16x32_bf16 v[124:127], v[216:219], a[124:127], v[124:127]
buffer_load_dwordx4 v6, s[28:31], s55 offen offset:1024  lds
v_mfma_f32_16x16x32_bf16 v[16:19], a[192:195], v[128:131], v[16:19]
v_exp_f32 v120, v120
v_mfma_f32_16x16x32_bf16 v[20:23], a[196:199], v[128:131], v[20:23]
ds_read_b64_tr_b16 a[228:229], v3 offset:50720
v_mfma_f32_16x16x32_bf16 v[24:27], a[200:203], v[128:131], v[24:27]
v_exp_f32 v121, v121
v_mfma_f32_16x16x32_bf16 v[28:31], a[204:207], v[128:131], v[28:31]
v_cvt_pk_bf16_f32 v132, v120, v121
s_add_u32 m0, s59, 4288
v_mfma_f32_16x16x32_bf16 a[0:3], a[208:211], v[128:131], a[0:3]
v_exp_f32 v122, v122
v_mfma_f32_16x16x32_bf16 a[4:7], a[212:215], v[128:131], a[4:7]
ds_read_b64_tr_b16 a[230:231], v3 offset:50976
buffer_load_dwordx4 v6, s[28:31], s55 offen offset:2048  lds
v_mfma_f32_16x16x32_bf16 a[8:11], a[216:219], v[128:131], a[8:11]
v_exp_f32 v123, v123
v_mfma_f32_16x16x32_bf16 a[12:15], a[220:223], v[128:131], a[12:15]
v_cvt_pk_bf16_f32 v133, v122, v123
v_mfma_f32_16x16x32_bf16 v[160:163], v[184:187], v[128:131], v[160:163]
v_exp_f32 v124, v124
v_mfma_f32_16x16x32_bf16 v[112:115], v[188:191], a[128:131], v[144:147]
ds_read_b64_tr_b16 a[232:233], v3 offset:50752
v_mfma_f32_16x16x32_bf16 v[112:115], v[192:195], a[132:135], v[112:115]
v_exp_f32 v125, v125
v_mfma_f32_16x16x32_bf16 v[112:115], v[196:199], a[136:139], v[112:115]
v_cvt_pk_bf16_f32 v134, v124, v125
v_mfma_f32_16x16x32_bf16 v[112:115], v[200:203], a[140:143], v[112:115]
v_exp_f32 v126, v126
v_mfma_f32_16x16x32_bf16 v[116:119], v[204:207], a[128:131], v[144:147]
ds_read_b64_tr_b16 a[234:235], v3 offset:51008
v_mfma_f32_16x16x32_bf16 v[116:119], v[208:211], a[132:135], v[116:119]
v_exp_f32 v127, v127
v_mfma_f32_16x16x32_bf16 v[116:119], v[212:215], a[136:139], v[116:119]
v_cvt_pk_bf16_f32 v135, v126, v127
s_add_u32 m0, s59, 4320
v_mfma_f32_16x16x32_bf16 v[116:119], v[216:219], a[140:143], v[116:119]
buffer_load_dwordx4 v6, s[28:31], s55 offen offset:3072  lds
v_mfma_f32_16x16x32_bf16 v[32:35], a[192:195], v[132:135], v[32:35]
v_exp_f32 v112, v112
v_mfma_f32_16x16x32_bf16 v[36:39], a[196:199], v[132:135], v[36:39]
ds_read_b64_tr_b16 a[236:237], v3 offset:50784
v_mfma_f32_16x16x32_bf16 v[40:43], a[200:203], v[132:135], v[40:43]
v_exp_f32 v113, v113
v_mfma_f32_16x16x32_bf16 v[44:47], a[204:207], v[132:135], v[44:47]
v_cvt_pk_bf16_f32 v128, v112, v113
s_add_u32 s55, s55, 32768
s_and_b32 s55, s55, 0x7ffff
v_mfma_f32_16x16x32_bf16 a[16:19], a[208:211], v[132:135], a[16:19]
v_exp_f32 v114, v114
v_mfma_f32_16x16x32_bf16 a[20:23], a[212:215], v[132:135], a[20:23]
ds_read_b64_tr_b16 a[238:239], v3 offset:51040
v_mfma_f32_16x16x32_bf16 a[24:27], a[216:219], v[132:135], a[24:27]
v_exp_f32 v115, v115
v_mfma_f32_16x16x32_bf16 a[28:31], a[220:223], v[132:135], a[28:31]
v_cvt_pk_bf16_f32 v129, v114, v115
v_mfma_f32_16x16x32_bf16 v[164:167], v[184:187], v[132:135], v[164:167]
v_exp_f32 v116, v116
v_mfma_f32_16x16x32_bf16 v[120:123], v[188:191], a[144:147], v[148:151]
ds_read_b64_tr_b16 a[240:241], v4 offset:50688
v_mfma_f32_16x16x32_bf16 v[120:123], v[192:195], a[148:151], v[120:123]
v_exp_f32 v117, v117
v_mfma_f32_16x16x32_bf16 v[120:123], v[196:199], a[152:155], v[120:123]
v_cvt_pk_bf16_f32 v130, v116, v117
v_mfma_f32_16x16x32_bf16 v[120:123], v[200:203], a[156:159], v[120:123]
v_exp_f32 v118, v118
v_mfma_f32_16x16x32_bf16 v[124:127], v[204:207], a[144:147], v[148:151]
ds_read_b64_tr_b16 a[242:243], v4 offset:50944
v_mfma_f32_16x16x32_bf16 v[124:127], v[208:211], a[148:151], v[124:127]
v_exp_f32 v119, v119
v_mfma_f32_16x16x32_bf16 v[124:127], v[212:215], a[152:155], v[124:127]
v_cvt_pk_bf16_f32 v131, v118, v119
s_add_u32 m0, s59, 8448
v_mfma_f32_16x16x32_bf16 v[124:127], v[216:219], a[156:159], v[124:127]
buffer_load_dwordx4 v6, s[28:31], s55 offen offset:0  lds
v_mfma_f32_16x16x32_bf16 v[48:51], a[192:195], v[128:131], v[48:51]
v_exp_f32 v120, v120
v_mfma_f32_16x16x32_bf16 v[52:55], a[196:199], v[128:131], v[52:55]
ds_read_b64_tr_b16 a[244:245], v4 offset:50720
v_mfma_f32_16x16x32_bf16 v[56:59], a[200:203], v[128:131], v[56:59]
v_exp_f32 v121, v121
v_mfma_f32_16x16x32_bf16 v[60:63], a[204:207], v[128:131], v[60:63]
v_cvt_pk_bf16_f32 v132, v120, v121
v_mfma_f32_16x16x32_bf16 a[32:35], a[208:211], v[128:131], a[32:35]
v_exp_f32 v122, v122
v_mfma_f32_16x16x32_bf16 a[36:39], a[212:215], v[128:131], a[36:39]
ds_read_b64_tr_b16 a[246:247], v4 offset:50976
v_mfma_f32_16x16x32_bf16 a[40:43], a[216:219], v[128:131], a[40:43]
v_exp_f32 v123, v123
v_mfma_f32_16x16x32_bf16 a[44:47], a[220:223], v[128:131], a[44:47]
v_cvt_pk_bf16_f32 v133, v122, v123
v_mfma_f32_16x16x32_bf16 v[168:171], v[184:187], v[128:131], v[168:171]
v_exp_f32 v124, v124
v_mfma_f32_16x16x32_bf16 v[112:115], v[188:191], a[160:163], v[152:155]
ds_read_b64_tr_b16 a[248:249], v4 offset:50752
v_mfma_f32_16x16x32_bf16 v[112:115], v[192:195], a[164:167], v[112:115]
v_exp_f32 v125, v125
v_mfma_f32_16x16x32_bf16 v[112:115], v[196:199], a[168:171], v[112:115]
v_cvt_pk_bf16_f32 v134, v124, v125
v_mfma_f32_16x16x32_bf16 v[112:115], v[200:203], a[172:175], v[112:115]
v_exp_f32 v126, v126
v_mfma_f32_16x16x32_bf16 v[116:119], v[204:207], a[160:163], v[152:155]
ds_read_b64_tr_b16 a[250:251], v4 offset:51008
v_mfma_f32_16x16x32_bf16 v[116:119], v[208:211], a[164:167], v[116:119]
v_exp_f32 v127, v127
v_mfma_f32_16x16x32_bf16 v[116:119], v[212:215], a[168:171], v[116:119]
v_cvt_pk_bf16_f32 v135, v126, v127
s_add_u32 m0, s59, 8480
v_mfma_f32_16x16x32_bf16 v[116:119], v[216:219], a[172:175], v[116:119]
buffer_load_dwordx4 v6, s[28:31], s55 offen offset:1024  lds
v_mfma_f32_16x16x32_bf16 v[64:67], a[192:195], v[132:135], v[64:67]
v_exp_f32 v112, v112
v_mfma_f32_16x16x32_bf16 v[68:71], a[196:199], v[132:135], v[68:71]
ds_read_b64_tr_b16 a[252:253], v4 offset:50784
v_mfma_f32_16x16x32_bf16 v[72:75], a[200:203], v[132:135], v[72:75]
v_exp_f32 v113, v113
v_mfma_f32_16x16x32_bf16 v[76:79], a[204:207], v[132:135], v[76:79]
v_cvt_pk_bf16_f32 v128, v112, v113
s_add_u32 m0, s59, 8512
v_mfma_f32_16x16x32_bf16 a[48:51], a[208:211], v[132:135], a[48:51]
v_exp_f32 v114, v114
v_mfma_f32_16x16x32_bf16 a[52:55], a[212:215], v[132:135], a[52:55]
ds_read_b64_tr_b16 a[254:255], v4 offset:51040
buffer_load_dwordx4 v6, s[28:31], s55 offen offset:2048  lds
v_mfma_f32_16x16x32_bf16 a[56:59], a[216:219], v[132:135], a[56:59]
v_exp_f32 v115, v115
v_mfma_f32_16x16x32_bf16 a[60:63], a[220:223], v[132:135], a[60:63]
v_cvt_pk_bf16_f32 v129, v114, v115
v_mfma_f32_16x16x32_bf16 v[172:175], v[184:187], v[132:135], v[172:175]
v_exp_f32 v116, v116
v_mfma_f32_16x16x32_bf16 v[120:123], v[188:191], a[176:179], v[156:159]
v_mfma_f32_16x16x32_bf16 v[120:123], v[192:195], a[180:183], v[120:123]
v_exp_f32 v117, v117
v_mfma_f32_16x16x32_bf16 v[120:123], v[196:199], a[184:187], v[120:123]
v_cvt_pk_bf16_f32 v130, v116, v117
v_mfma_f32_16x16x32_bf16 v[120:123], v[200:203], a[188:191], v[120:123]
v_exp_f32 v118, v118
v_mfma_f32_16x16x32_bf16 v[124:127], v[204:207], a[176:179], v[156:159]
v_mfma_f32_16x16x32_bf16 v[124:127], v[208:211], a[180:183], v[124:127]
v_exp_f32 v119, v119
v_mfma_f32_16x16x32_bf16 v[124:127], v[212:215], a[184:187], v[124:127]
v_cvt_pk_bf16_f32 v131, v118, v119
s_add_u32 m0, s59, 8544
v_mfma_f32_16x16x32_bf16 v[124:127], v[216:219], a[188:191], v[124:127]
buffer_load_dwordx4 v6, s[28:31], s55 offen offset:3072  lds
v_mfma_f32_16x16x32_bf16 v[80:83], a[192:195], v[128:131], v[80:83]
v_exp_f32 v120, v120
v_mfma_f32_16x16x32_bf16 v[84:87], a[196:199], v[128:131], v[84:87]
v_mfma_f32_16x16x32_bf16 v[88:91], a[200:203], v[128:131], v[88:91]
v_exp_f32 v121, v121
v_mfma_f32_16x16x32_bf16 v[92:95], a[204:207], v[128:131], v[92:95]
v_cvt_pk_bf16_f32 v132, v120, v121
s_add_u32 s55, s55, 32768
s_and_b32 s55, s55, 0x7ffff
v_mfma_f32_16x16x32_bf16 a[64:67], a[208:211], v[128:131], a[64:67]
v_exp_f32 v122, v122
v_mfma_f32_16x16x32_bf16 a[68:71], a[212:215], v[128:131], a[68:71]
v_mfma_f32_16x16x32_bf16 a[72:75], a[216:219], v[128:131], a[72:75]
v_exp_f32 v123, v123
v_mfma_f32_16x16x32_bf16 a[76:79], a[220:223], v[128:131], a[76:79]
v_cvt_pk_bf16_f32 v133, v122, v123
v_mfma_f32_16x16x32_bf16 v[176:179], v[184:187], v[128:131], v[176:179]
v_exp_f32 v124, v124
s_waitcnt lgkmcnt(0)
s_barrier
v_mfma_f32_16x16x32_bf16 v[112:115], v[220:223], a[96:99], v[136:139]
s_mul_i32 s50, s40, 24576
s_add_u32 s50, s50, 25344
v_add_u32 v252, s50, v1
v_mfma_f32_16x16x32_bf16 v[112:115], v[224:227], a[100:103], v[112:115]
v_exp_f32 v125, v125
v_mfma_f32_16x16x32_bf16 v[112:115], v[228:231], a[104:107], v[112:115]
v_cvt_pk_bf16_f32 v134, v124, v125
v_mfma_f32_16x16x32_bf16 v[112:115], v[232:235], a[108:111], v[112:115]
v_exp_f32 v126, v126
v_mfma_f32_16x16x32_bf16 v[116:119], v[236:239], a[96:99], v[136:139]
s_xor_b32 s51, s40, 2
s_mul_i32 s52, s51, 24576
s_add_u32 s52, s52, 25344
v_mfma_f32_16x16x32_bf16 v[116:119], v[240:243], a[100:103], v[116:119]
v_exp_f32 v127, v127
v_mfma_f32_16x16x32_bf16 v[116:119], v[244:247], a[104:107], v[116:119]
v_cvt_pk_bf16_f32 v135, v126, v127
v_mfma_f32_16x16x32_bf16 v[116:119], v[248:251], a[108:111], v[116:119]
v_add_u32 v253, s52, v1
v_and_b32 v5, 15, v0
v_lshlrev_b32 v5, 3, v5
v_mfma_f32_16x16x32_bf16 v[96:99], a[192:195], v[132:135], v[96:99]
v_exp_f32 v112, v112
v_mfma_f32_16x16x32_bf16 v[100:103], a[196:199], v[132:135], v[100:103]
s_mul_i32 s50, s40, 768
s_add_u32 s50, s50, 159488
v_add_u32 v254, s50, v5
v_mfma_f32_16x16x32_bf16 v[104:107], a[200:203], v[132:135], v[104:107]
v_exp_f32 v113, v113
v_mfma_f32_16x16x32_bf16 v[108:111], a[204:207], v[132:135], v[108:111]
v_cvt_pk_bf16_f32 v128, v112, v113
v_mfma_f32_16x16x32_bf16 a[80:83], a[208:211], v[132:135], a[80:83]
v_exp_f32 v114, v114
v_mfma_f32_16x16x32_bf16 a[84:87], a[212:215], v[132:135], a[84:87]
s_mul_i32 s52, s51, 768
s_add_u32 s52, s52, 159488
v_add_u32 v255, s52, v5
v_mfma_f32_16x16x32_bf16 a[88:91], a[216:219], v[132:135], a[88:91]
v_exp_f32 v115, v115
v_mfma_f32_16x16x32_bf16 a[92:95], a[220:223], v[132:135], a[92:95]
v_cvt_pk_bf16_f32 v129, v114, v115
v_mfma_f32_16x16x32_bf16 v[180:183], v[184:187], v[132:135], v[180:183]
v_exp_f32 v116, v116
v_mfma_f32_16x16x32_bf16 v[120:123], v[220:223], a[112:115], v[140:143]
s_waitcnt vmcnt(8)
ds_read_b64_tr_b16 a[192:193], v10 offset:0
ds_read_b64_tr_b16 a[194:195], v10 offset:512
ds_read_b64_tr_b16 a[196:197], v10 offset:32
v_mfma_f32_16x16x32_bf16 v[120:123], v[224:227], a[116:119], v[120:123]
v_exp_f32 v117, v117
v_mfma_f32_16x16x32_bf16 v[120:123], v[228:231], a[120:123], v[120:123]
v_cvt_pk_bf16_f32 v130, v116, v117
v_mfma_f32_16x16x32_bf16 v[120:123], v[232:235], a[124:127], v[120:123]
v_exp_f32 v118, v118
v_mfma_f32_16x16x32_bf16 v[124:127], v[236:239], a[112:115], v[140:143]
ds_read_b64_tr_b16 a[198:199], v10 offset:544
ds_read_b64_tr_b16 a[200:201], v10 offset:64
ds_read_b64_tr_b16 a[202:203], v10 offset:576
v_mfma_f32_16x16x32_bf16 v[124:127], v[240:243], a[116:119], v[124:127]
v_exp_f32 v119, v119
v_mfma_f32_16x16x32_bf16 v[124:127], v[244:247], a[120:123], v[124:127]
v_cvt_pk_bf16_f32 v131, v118, v119
v_mfma_f32_16x16x32_bf16 v[124:127], v[248:251], a[124:127], v[124:127]
ds_read_b64_tr_b16 a[204:205], v10 offset:96
ds_read_b64_tr_b16 a[206:207], v10 offset:608
v_mfma_f32_16x16x32_bf16 v[16:19], a[224:227], v[128:131], v[16:19]
v_exp_f32 v120, v120
v_mfma_f32_16x16x32_bf16 v[20:23], a[228:231], v[128:131], v[20:23]
v_mfma_f32_16x16x32_bf16 v[24:27], a[232:235], v[128:131], v[24:27]
v_exp_f32 v121, v121
v_mfma_f32_16x16x32_bf16 v[28:31], a[236:239], v[128:131], v[28:31]
v_cvt_pk_bf16_f32 v132, v120, v121
v_mfma_f32_16x16x32_bf16 a[0:3], a[240:243], v[128:131], a[0:3]
v_exp_f32 v122, v122
s_add_u32 m0, s59, 0
v_mfma_f32_16x16x32_bf16 a[4:7], a[244:247], v[128:131], a[4:7]
s_waitcnt lgkmcnt(0)
buffer_load_dwordx4 v6, s[28:31], s55 offen offset:0  lds
v_mfma_f32_16x16x32_bf16 a[8:11], a[248:251], v[128:131], a[8:11]
v_exp_f32 v123, v123
s_add_u32 m0, s59, 32
v_mfma_f32_16x16x32_bf16 a[12:15], a[252:255], v[128:131], a[12:15]
v_cvt_pk_bf16_f32 v133, v122, v123
buffer_load_dwordx4 v6, s[28:31], s55 offen offset:1024  lds
v_mfma_f32_16x16x32_bf16 v[160:163], v[184:187], v[128:131], v[160:163]
v_exp_f32 v124, v124
s_add_u32 m0, s59, 64
v_mfma_f32_16x16x32_bf16 v[112:115], v[220:223], a[128:131], v[144:147]
s_waitcnt vmcnt(6)
ds_read_b64_tr_b16 a[208:209], v10 offset:4224
ds_read_b64_tr_b16 a[210:211], v10 offset:4736
ds_read_b64_tr_b16 a[212:213], v10 offset:4256
buffer_load_dwordx4 v6, s[28:31], s55 offen offset:2048  lds
v_mfma_f32_16x16x32_bf16 v[112:115], v[224:227], a[132:135], v[112:115]
v_exp_f32 v125, v125
s_add_u32 m0, s59, 96
v_mfma_f32_16x16x32_bf16 v[112:115], v[228:231], a[136:139], v[112:115]
v_cvt_pk_bf16_f32 v134, v124, v125
ds_write_b128 v252, a[0:3] offset:0
buffer_load_dwordx4 v6, s[28:31], s55 offen offset:3072  lds
v_mfma_f32_16x16x32_bf16 v[112:115], v[232:235], a[140:143], v[112:115]
v_exp_f32 v126, v126
s_add_u32 s55, s55, 32768
s_and_b32 s55, s55, 0x7ffff
v_mfma_f32_16x16x32_bf16 v[116:119], v[236:239], a[128:131], v[144:147]
ds_read_b64_tr_b16 a[214:215], v10 offset:4768
ds_read_b64_tr_b16 a[216:217], v10 offset:4288
ds_read_b64_tr_b16 a[218:219], v10 offset:4800
v_mfma_f32_16x16x32_bf16 v[116:119], v[240:243], a[132:135], v[116:119]
v_exp_f32 v127, v127
v_mfma_f32_16x16x32_bf16 v[116:119], v[244:247], a[136:139], v[116:119]
v_cvt_pk_bf16_f32 v135, v126, v127
ds_write_b128 v252, a[4:7] offset:1024
v_mfma_f32_16x16x32_bf16 v[116:119], v[248:251], a[140:143], v[116:119]
ds_read_b64_tr_b16 a[220:221], v10 offset:4320
ds_read_b64_tr_b16 a[222:223], v10 offset:4832
v_mfma_f32_16x16x32_bf16 v[32:35], a[224:227], v[132:135], v[32:35]
v_exp_f32 v112, v112
v_mfma_f32_16x16x32_bf16 v[36:39], a[228:231], v[132:135], v[36:39]
v_mfma_f32_16x16x32_bf16 v[40:43], a[232:235], v[132:135], v[40:43]
v_exp_f32 v113, v113
v_mfma_f32_16x16x32_bf16 v[44:47], a[236:239], v[132:135], v[44:47]
v_cvt_pk_bf16_f32 v128, v112, v113
ds_write_b128 v252, a[8:11] offset:2048
v_mfma_f32_16x16x32_bf16 a[16:19], a[240:243], v[132:135], a[16:19]
v_exp_f32 v114, v114
s_add_u32 m0, s59, 4224
v_mfma_f32_16x16x32_bf16 a[20:23], a[244:247], v[132:135], a[20:23]
s_waitcnt lgkmcnt(0)
buffer_load_dwordx4 v6, s[28:31], s55 offen offset:0  lds
v_mfma_f32_16x16x32_bf16 a[24:27], a[248:251], v[132:135], a[24:27]
v_exp_f32 v115, v115
s_add_u32 m0, s59, 4256
v_mfma_f32_16x16x32_bf16 a[28:31], a[252:255], v[132:135], a[28:31]
v_cvt_pk_bf16_f32 v129, v114, v115
ds_write_b128 v252, a[12:15] offset:3072
buffer_load_dwordx4 v6, s[28:31], s55 offen offset:1024  lds
v_mfma_f32_16x16x32_bf16 v[164:167], v[184:187], v[132:135], v[164:167]
v_exp_f32 v116, v116
s_add_u32 m0, s59, 4288
v_mfma_f32_16x16x32_bf16 v[120:123], v[220:223], a[144:147], v[148:151]
s_waitcnt vmcnt(6)
ds_read_b64_tr_b16 a[96:97], v10 offset:8448
ds_read_b64_tr_b16 a[98:99], v10 offset:8960
ds_read_b64_tr_b16 a[100:101], v10 offset:8480
buffer_load_dwordx4 v6, s[28:31], s55 offen offset:2048  lds
v_mfma_f32_16x16x32_bf16 v[120:123], v[224:227], a[148:151], v[120:123]
v_exp_f32 v117, v117
s_add_u32 m0, s59, 4320
v_mfma_f32_16x16x32_bf16 v[120:123], v[228:231], a[152:155], v[120:123]
v_cvt_pk_bf16_f32 v130, v116, v117
ds_write_b128 v252, a[16:19] offset:4096
buffer_load_dwordx4 v6, s[28:31], s55 offen offset:3072  lds
v_mfma_f32_16x16x32_bf16 v[120:123], v[232:235], a[156:159], v[120:123]
v_exp_f32 v118, v118
s_add_u32 s55, s55, 32768
s_and_b32 s55, s55, 0x7ffff
v_mfma_f32_16x16x32_bf16 v[124:127], v[236:239], a[144:147], v[148:151]
ds_read_b64_tr_b16 a[102:103], v10 offset:8992
ds_read_b64_tr_b16 a[104:105], v10 offset:8512
ds_read_b64_tr_b16 a[106:107], v10 offset:9024
v_mfma_f32_16x16x32_bf16 v[124:127], v[240:243], a[148:151], v[124:127]
v_exp_f32 v119, v119
v_mfma_f32_16x16x32_bf16 v[124:127], v[244:247], a[152:155], v[124:127]
v_cvt_pk_bf16_f32 v131, v118, v119
ds_write_b128 v252, a[20:23] offset:5120
v_mfma_f32_16x16x32_bf16 v[124:127], v[248:251], a[156:159], v[124:127]
ds_read_b64_tr_b16 a[108:109], v10 offset:8544
ds_read_b64_tr_b16 a[110:111], v10 offset:9056
v_mfma_f32_16x16x32_bf16 v[48:51], a[224:227], v[128:131], v[48:51]
v_exp_f32 v120, v120
v_mfma_f32_16x16x32_bf16 v[52:55], a[228:231], v[128:131], v[52:55]
v_mfma_f32_16x16x32_bf16 v[56:59], a[232:235], v[128:131], v[56:59]
v_exp_f32 v121, v121
v_mfma_f32_16x16x32_bf16 v[60:63], a[236:239], v[128:131], v[60:63]
v_cvt_pk_bf16_f32 v132, v120, v121
ds_write_b128 v252, a[24:27] offset:6144
v_mfma_f32_16x16x32_bf16 a[32:35], a[240:243], v[128:131], a[32:35]
v_exp_f32 v122, v122
s_add_u32 m0, s59, 8448
v_mfma_f32_16x16x32_bf16 a[36:39], a[244:247], v[128:131], a[36:39]
s_waitcnt lgkmcnt(0)
buffer_load_dwordx4 v6, s[28:31], s55 offen offset:0  lds
v_mfma_f32_16x16x32_bf16 a[40:43], a[248:251], v[128:131], a[40:43]
v_exp_f32 v123, v123
s_add_u32 m0, s59, 8480
v_mfma_f32_16x16x32_bf16 a[44:47], a[252:255], v[128:131], a[44:47]
v_cvt_pk_bf16_f32 v133, v122, v123
ds_write_b128 v252, a[28:31] offset:7168
buffer_load_dwordx4 v6, s[28:31], s55 offen offset:1024  lds
v_mfma_f32_16x16x32_bf16 v[168:171], v[184:187], v[128:131], v[168:171]
v_exp_f32 v124, v124
s_add_u32 m0, s59, 8512
v_mfma_f32_16x16x32_bf16 v[112:115], v[220:223], a[160:163], v[152:155]
s_waitcnt vmcnt(6)
ds_read_b64_tr_b16 a[112:113], v10 offset:0
ds_read_b64_tr_b16 a[114:115], v10 offset:512
ds_read_b64_tr_b16 a[116:117], v10 offset:32
buffer_load_dwordx4 v6, s[28:31], s55 offen offset:2048  lds
v_mfma_f32_16x16x32_bf16 v[112:115], v[224:227], a[164:167], v[112:115]
v_exp_f32 v125, v125
s_add_u32 m0, s59, 8544
v_mfma_f32_16x16x32_bf16 v[112:115], v[228:231], a[168:171], v[112:115]
v_cvt_pk_bf16_f32 v134, v124, v125
ds_write_b128 v252, a[32:35] offset:8192
buffer_load_dwordx4 v6, s[28:31], s55 offen offset:3072  lds
v_mfma_f32_16x16x32_bf16 v[112:115], v[232:235], a[172:175], v[112:115]
v_exp_f32 v126, v126
s_add_u32 s55, s55, 32768
s_and_b32 s55, s55, 0x7ffff
v_mfma_f32_16x16x32_bf16 v[116:119], v[236:239], a[160:163], v[152:155]
ds_read_b64_tr_b16 a[118:119], v10 offset:544
ds_read_b64_tr_b16 a[120:121], v10 offset:64
ds_read_b64_tr_b16 a[122:123], v10 offset:576
v_mfma_f32_16x16x32_bf16 v[116:119], v[240:243], a[164:167], v[116:119]
v_exp_f32 v127, v127
v_mfma_f32_16x16x32_bf16 v[116:119], v[244:247], a[168:171], v[116:119]
v_cvt_pk_bf16_f32 v135, v126, v127
ds_write_b128 v252, a[36:39] offset:9216
v_mfma_f32_16x16x32_bf16 v[116:119], v[248:251], a[172:175], v[116:119]
ds_read_b64_tr_b16 a[124:125], v10 offset:96
ds_read_b64_tr_b16 a[126:127], v10 offset:608
v_mfma_f32_16x16x32_bf16 v[64:67], a[224:227], v[132:135], v[64:67]
v_exp_f32 v112, v112
v_mfma_f32_16x16x32_bf16 v[68:71], a[228:231], v[132:135], v[68:71]
v_mov_b32 v188, -1
v_mov_b32 v189, -1
v_mfma_f32_16x16x32_bf16 v[72:75], a[232:235], v[132:135], v[72:75]
v_exp_f32 v113, v113
v_mov_b32 v190, -1
v_mov_b32 v191, -1
v_mfma_f32_16x16x32_bf16 v[76:79], a[236:239], v[132:135], v[76:79]
v_cvt_pk_bf16_f32 v128, v112, v113
ds_write_b128 v252, a[40:43] offset:10240
v_mfma_f32_16x16x32_bf16 a[48:51], a[240:243], v[132:135], a[48:51]
v_exp_f32 v114, v114
s_add_u32 m0, s59, 0
v_mfma_f32_16x16x32_bf16 a[52:55], a[244:247], v[132:135], a[52:55]
s_waitcnt lgkmcnt(0)
buffer_load_dwordx4 v6, s[28:31], s55 offen offset:0  lds
v_mfma_f32_16x16x32_bf16 a[56:59], a[248:251], v[132:135], a[56:59]
v_exp_f32 v115, v115
s_add_u32 m0, s59, 32
v_mfma_f32_16x16x32_bf16 a[60:63], a[252:255], v[132:135], a[60:63]
v_cvt_pk_bf16_f32 v129, v114, v115
ds_write_b128 v252, a[44:47] offset:11264
buffer_load_dwordx4 v6, s[28:31], s55 offen offset:1024  lds
v_mfma_f32_16x16x32_bf16 v[172:175], v[184:187], v[132:135], v[172:175]
v_exp_f32 v116, v116
s_add_u32 m0, s59, 64
v_mfma_f32_16x16x32_bf16 v[120:123], v[220:223], a[176:179], v[156:159]
s_waitcnt vmcnt(6)
ds_read_b64_tr_b16 a[128:129], v10 offset:4224
ds_read_b64_tr_b16 a[130:131], v10 offset:4736
ds_read_b64_tr_b16 a[132:133], v10 offset:4256
buffer_load_dwordx4 v6, s[28:31], s55 offen offset:2048  lds
v_mfma_f32_16x16x32_bf16 v[120:123], v[224:227], a[180:183], v[120:123]
v_exp_f32 v117, v117
s_add_u32 m0, s59, 96
v_mfma_f32_16x16x32_bf16 v[120:123], v[228:231], a[184:187], v[120:123]
v_cvt_pk_bf16_f32 v130, v116, v117
ds_write_b128 v252, a[48:51] offset:12288
buffer_load_dwordx4 v6, s[28:31], s55 offen offset:3072  lds
v_mfma_f32_16x16x32_bf16 v[120:123], v[232:235], a[188:191], v[120:123]
v_exp_f32 v118, v118
s_add_u32 s55, s55, 32768
s_and_b32 s55, s55, 0x7ffff
v_mfma_f32_16x16x32_bf16 v[124:127], v[236:239], a[176:179], v[156:159]
ds_read_b64_tr_b16 a[134:135], v10 offset:4768
ds_read_b64_tr_b16 a[136:137], v10 offset:4288
ds_read_b64_tr_b16 a[138:139], v10 offset:4800
v_mfma_f32_16x16x32_bf16 v[124:127], v[240:243], a[180:183], v[124:127]
v_exp_f32 v119, v119
v_mfma_f32_16x16x32_bf16 v[124:127], v[244:247], a[184:187], v[124:127]
v_cvt_pk_bf16_f32 v131, v118, v119
ds_write_b128 v252, a[52:55] offset:13312
v_mfma_f32_16x16x32_bf16 v[124:127], v[248:251], a[188:191], v[124:127]
ds_read_b64_tr_b16 a[140:141], v10 offset:4320
ds_read_b64_tr_b16 a[142:143], v10 offset:4832
v_mfma_f32_16x16x32_bf16 v[80:83], a[224:227], v[128:131], v[80:83]
v_exp_f32 v120, v120
v_mfma_f32_16x16x32_bf16 v[84:87], a[228:231], v[128:131], v[84:87]
buffer_store_dwordx4 v[188:191], v1, s[12:15], s17 offen offset:0 sc1
v_mfma_f32_16x16x32_bf16 v[88:91], a[232:235], v[128:131], v[88:91]
v_exp_f32 v121, v121
v_mfma_f32_16x16x32_bf16 v[92:95], a[236:239], v[128:131], v[92:95]
v_cvt_pk_bf16_f32 v132, v120, v121
ds_write_b128 v252, a[56:59] offset:14336
buffer_store_dwordx4 v[188:191], v1, s[12:15], s17 offen offset:1024 sc1
v_mfma_f32_16x16x32_bf16 a[64:67], a[240:243], v[128:131], a[64:67]
v_exp_f32 v122, v122
v_mfma_f32_16x16x32_bf16 a[68:71], a[244:247], v[128:131], a[68:71]
buffer_store_dwordx4 v[188:191], v1, s[12:15], s17 offen offset:2048 sc1
v_mfma_f32_16x16x32_bf16 a[72:75], a[248:251], v[128:131], a[72:75]
v_exp_f32 v123, v123
v_mfma_f32_16x16x32_bf16 a[76:79], a[252:255], v[128:131], a[76:79]
v_cvt_pk_bf16_f32 v133, v122, v123
ds_write_b128 v252, a[60:63] offset:15360
v_mfma_f32_16x16x32_bf16 v[176:179], v[184:187], v[128:131], v[176:179]
v_exp_f32 v124, v124
v_exp_f32 v125, v125
ds_write_b128 v252, a[64:67] offset:16384
v_cvt_pk_bf16_f32 v134, v124, v125
v_exp_f32 v126, v126
ds_write_b128 v252, a[68:71] offset:17408
v_exp_f32 v127, v127
ds_write_b128 v252, a[72:75] offset:18432
v_cvt_pk_bf16_f32 v135, v126, v127
ds_write_b128 v252, a[76:79] offset:19456
s_nop 0
v_mfma_f32_16x16x32_bf16 v[96:99], a[224:227], v[132:135], v[96:99]
v_mfma_f32_16x16x32_bf16 v[100:103], a[228:231], v[132:135], v[100:103]
v_mfma_f32_16x16x32_bf16 v[104:107], a[232:235], v[132:135], v[104:107]
v_mfma_f32_16x16x32_bf16 v[108:111], a[236:239], v[132:135], v[108:111]
v_mfma_f32_16x16x32_bf16 a[80:83], a[240:243], v[132:135], a[80:83]
v_mfma_f32_16x16x32_bf16 a[84:87], a[244:247], v[132:135], a[84:87]
v_mfma_f32_16x16x32_bf16 a[88:91], a[248:251], v[132:135], a[88:91]
v_mfma_f32_16x16x32_bf16 a[92:95], a[252:255], v[132:135], a[92:95]
v_mfma_f32_16x16x32_bf16 v[180:183], v[184:187], v[132:135], v[180:183]
s_mov_b32 s50, 0x4e800000
s_mov_b64 s[52:53], 0
v_mov_b32 v161, v136
v_cmp_ngt_f32 vcc, s50, v160
ds_write_b64 v254, v[160:161] offset:0
s_or_b64 s[52:53], s[52:53], vcc
v_mov_b32 v165, v140
v_cmp_ngt_f32 vcc, s50, v164
ds_write_b64 v254, v[164:165] offset:128
s_or_b64 s[52:53], s[52:53], vcc
v_mov_b32 v169, v144
v_cmp_ngt_f32 vcc, s50, v168
ds_write_b64 v254, v[168:169] offset:256
s_or_b64 s[52:53], s[52:53], vcc
v_mov_b32 v173, v148
v_cmp_ngt_f32 vcc, s50, v172
ds_write_b64 v254, v[172:173] offset:384
s_or_b64 s[52:53], s[52:53], vcc
v_mov_b32 v177, v152
v_cmp_ngt_f32 vcc, s50, v176
ds_write_b64 v254, v[176:177] offset:512
s_or_b64 s[52:53], s[52:53], vcc
v_mov_b32 v181, v156
v_cmp_ngt_f32 vcc, s50, v180
ds_write_b64 v254, v[180:181] offset:640
s_or_b64 s[52:53], s[52:53], vcc
ds_write_b128 v252, a[80:83] offset:20480
ds_write_b128 v252, a[84:87] offset:21504
ds_write_b128 v252, a[88:91] offset:22528
ds_write_b128 v252, a[92:95] offset:23552
s_cmp_lg_u64 s[52:53], 0
s_cselect_b32 s50, 1, 0
v_mov_b32 v5, s50
s_lshl_b32 s50, s40, 2
s_add_u32 s50, s50, 162560
v_mov_b32 v9, s50
ds_write_b32 v9, v5
ds_write_b32 v9, v13 offset:16
v_mov_b32 v9, 162560
s_waitcnt lgkmcnt(0)
s_barrier
ds_read_b128 v[248:251], v9
ds_read_b64 v[162:163], v255 offset:0
ds_read_b64 v[166:167], v255 offset:128
ds_read_b64 v[170:171], v255 offset:256
ds_read_b64 v[174:175], v255 offset:384
ds_read_b64 v[178:179], v255 offset:512
ds_read_b64 v[182:183], v255 offset:640
ds_read_b128 v[112:115], v253 offset:0
ds_read_b128 v[116:119], v253 offset:1024
ds_read_b128 v[120:123], v253 offset:2048
ds_read_b128 v[124:127], v253 offset:3072
ds_read_b128 v[128:131], v253 offset:4096
ds_read_b128 v[132:135], v253 offset:5120
ds_read_b128 v[136:139], v253 offset:6144
ds_read_b128 v[140:143], v253 offset:7168
s_waitcnt lgkmcnt(8)
v_or3_b32 v248, v248, v249, v250
v_or_b32 v248, v248, v251
s_nop 0
v_readfirstlane_b32 s50, v248
v_min_f32 v240, v161, v163
v_min_f32 v241, v165, v167
v_min_f32 v242, v169, v171
v_min_f32 v243, v173, v175
v_min_f32 v244, v177, v179
v_min_f32 v245, v181, v183
s_andn2_b32 s50, s50, s3
s_cbranch_scc1 L_redo
v_sub_f32 v161, v240, v161
v_sub_f32 v165, v241, v165
v_sub_f32 v169, v242, v169
v_sub_f32 v173, v243, v173
v_sub_f32 v177, v244, v177
v_sub_f32 v181, v245, v181
ds_read_b128 v[144:147], v253 offset:8192
ds_read_b128 v[148:151], v253 offset:9216
ds_read_b128 v[152:155], v253 offset:10240
ds_read_b128 v[156:159], v253 offset:11264
v_sub_f32 v163, v240, v163
v_sub_f32 v167, v241, v167
v_sub_f32 v171, v242, v171
v_sub_f32 v175, v243, v175
v_sub_f32 v179, v244, v179
v_sub_f32 v183, v245, v183
v_exp_f32 v161, v161
v_exp_f32 v165, v165
v_exp_f32 v169, v169
v_exp_f32 v173, v173
v_exp_f32 v177, v177
v_exp_f32 v181, v181
ds_read_b128 v[188:191], v253 offset:12288
ds_read_b128 v[192:195], v253 offset:13312
ds_read_b128 v[196:199], v253 offset:14336
ds_read_b128 v[200:203], v253 offset:15360
v_exp_f32 v163, v163
v_exp_f32 v167, v167
v_exp_f32 v171, v171
v_exp_f32 v175, v175
v_exp_f32 v179, v179
v_exp_f32 v183, v183
v_mul_f32 v240, v161, v160
v_mul_f32 v241, v165, v164
v_mul_f32 v242, v169, v168
v_mul_f32 v243, v173, v172
v_mul_f32 v244, v177, v176
v_mul_f32 v245, v181, v180
ds_read_b128 v[204:207], v253 offset:16384
ds_read_b128 v[208:211], v253 offset:17408
ds_read_b128 v[212:215], v253 offset:18432
ds_read_b128 v[216:219], v253 offset:19456
v_fma_f32 v240, v163, v162, v240
v_fma_f32 v241, v167, v166, v241
v_fma_f32 v242, v171, v170, v242
v_fma_f32 v243, v175, v174, v243
v_fma_f32 v244, v179, v178, v244
v_fma_f32 v245, v183, v182, v245
v_rcp_f32 v240, v240
v_rcp_f32 v241, v241
v_rcp_f32 v242, v242
v_rcp_f32 v243, v243
v_rcp_f32 v244, v244
v_rcp_f32 v245, v245
ds_read_b128 v[220:223], v253 offset:20480
ds_read_b128 v[224:227], v253 offset:21504
ds_read_b128 v[228:231], v253 offset:22528
ds_read_b128 v[232:235], v253 offset:23552
v_mul_f32 v160, v161, v240
v_mul_f32 v164, v165, v241
v_mul_f32 v168, v169, v242
v_mul_f32 v172, v173, v243
v_mul_f32 v176, v177, v244
v_mul_f32 v180, v181, v245
v_mul_f32 v162, v163, v240
v_mul_f32 v166, v167, v241
v_mul_f32 v170, v171, v242
v_mul_f32 v174, v175, v243
v_mul_f32 v178, v179, v244
v_mul_f32 v182, v183, v245
s_mul_i32 s50, s41, 786432
s_lshl_b32 s51, s42, 11
s_add_u32 s50, s50, s51
s_waitcnt lgkmcnt(15)
v_pk_mul_f32 v[16:17], v[16:17], v[160:161] op_sel_hi:[1,0]
v_pk_mul_f32 v[18:19], v[18:19], v[160:161] op_sel_hi:[1,0]
v_pk_mul_f32 v[20:21], v[20:21], v[160:161] op_sel_hi:[1,0]
v_pk_mul_f32 v[22:23], v[22:23], v[160:161] op_sel_hi:[1,0]
v_pk_mul_f32 v[24:25], v[24:25], v[160:161] op_sel_hi:[1,0]
v_pk_mul_f32 v[26:27], v[26:27], v[160:161] op_sel_hi:[1,0]
v_pk_mul_f32 v[28:29], v[28:29], v[160:161] op_sel_hi:[1,0]
v_pk_mul_f32 v[30:31], v[30:31], v[160:161] op_sel_hi:[1,0]
v_pk_fma_f32 v[16:17], v[112:113], v[162:163], v[16:17] op_sel_hi:[1,0,1]
v_pk_fma_f32 v[18:19], v[114:115], v[162:163], v[18:19] op_sel_hi:[1,0,1]
v_pk_fma_f32 v[20:21], v[116:117], v[162:163], v[20:21] op_sel_hi:[1,0,1]
v_pk_fma_f32 v[22:23], v[118:119], v[162:163], v[22:23] op_sel_hi:[1,0,1]
v_pk_fma_f32 v[24:25], v[120:121], v[162:163], v[24:25] op_sel_hi:[1,0,1]
v_pk_fma_f32 v[26:27], v[122:123], v[162:163], v[26:27] op_sel_hi:[1,0,1]
v_pk_fma_f32 v[28:29], v[124:125], v[162:163], v[28:29] op_sel_hi:[1,0,1]
v_pk_fma_f32 v[30:31], v[126:127], v[162:163], v[30:31] op_sel_hi:[1,0,1]
v_cvt_pk_bf16_f32 v112, v16, v17
v_cvt_pk_bf16_f32 v113, v18, v19
v_cvt_pk_bf16_f32 v114, v20, v21
v_cvt_pk_bf16_f32 v115, v22, v23
v_cvt_pk_bf16_f32 v116, v24, v25
v_cvt_pk_bf16_f32 v117, v26, v27
v_cvt_pk_bf16_f32 v118, v28, v29
v_cvt_pk_bf16_f32 v119, v30, v31
buffer_store_dwordx4 v[112:115], v1, s[36:39], s50 offen offset:0 sc1
buffer_store_dwordx4 v[116:119], v1, s[36:39], s50 offen offset:1024 sc1
s_add_u32 s50, s50, 131072
s_waitcnt lgkmcnt(15)
v_pk_mul_f32 v[32:33], v[32:33], v[164:165] op_sel_hi:[1,0]
v_pk_mul_f32 v[34:35], v[34:35], v[164:165] op_sel_hi:[1,0]
v_pk_mul_f32 v[36:37], v[36:37], v[164:165] op_sel_hi:[1,0]
v_pk_mul_f32 v[38:39], v[38:39], v[164:165] op_sel_hi:[1,0]
v_pk_mul_f32 v[40:41], v[40:41], v[164:165] op_sel_hi:[1,0]
v_pk_mul_f32 v[42:43], v[42:43], v[164:165] op_sel_hi:[1,0]
v_pk_mul_f32 v[44:45], v[44:45], v[164:165] op_sel_hi:[1,0]
v_pk_mul_f32 v[46:47], v[46:47], v[164:165] op_sel_hi:[1,0]
v_pk_fma_f32 v[32:33], v[128:129], v[166:167], v[32:33] op_sel_hi:[1,0,1]
v_pk_fma_f32 v[34:35], v[130:131], v[166:167], v[34:35] op_sel_hi:[1,0,1]
v_pk_fma_f32 v[36:37], v[132:133], v[166:167], v[36:37] op_sel_hi:[1,0,1]
v_pk_fma_f32 v[38:39], v[134:135], v[166:167], v[38:39] op_sel_hi:[1,0,1]
v_pk_fma_f32 v[40:41], v[136:137], v[166:167], v[40:41] op_sel_hi:[1,0,1]
v_pk_fma_f32 v[42:43], v[138:139], v[166:167], v[42:43] op_sel_hi:[1,0,1]
v_pk_fma_f32 v[44:45], v[140:141], v[166:167], v[44:45] op_sel_hi:[1,0,1]
v_pk_fma_f32 v[46:47], v[142:143], v[166:167], v[46:47] op_sel_hi:[1,0,1]
v_cvt_pk_bf16_f32 v128, v32, v33
v_cvt_pk_bf16_f32 v129, v34, v35
v_cvt_pk_bf16_f32 v130, v36, v37
v_cvt_pk_bf16_f32 v131, v38, v39
v_cvt_pk_bf16_f32 v132, v40, v41
v_cvt_pk_bf16_f32 v133, v42, v43
v_cvt_pk_bf16_f32 v134, v44, v45
v_cvt_pk_bf16_f32 v135, v46, v47
buffer_store_dwordx4 v[128:131], v1, s[36:39], s50 offen offset:0 sc1
buffer_store_dwordx4 v[132:135], v1, s[36:39], s50 offen offset:1024 sc1
s_add_u32 s50, s50, 131072
s_waitcnt lgkmcnt(12)
v_pk_mul_f32 v[48:49], v[48:49], v[168:169] op_sel_hi:[1,0]
v_pk_mul_f32 v[50:51], v[50:51], v[168:169] op_sel_hi:[1,0]
v_pk_mul_f32 v[52:53], v[52:53], v[168:169] op_sel_hi:[1,0]
v_pk_mul_f32 v[54:55], v[54:55], v[168:169] op_sel_hi:[1,0]
v_pk_mul_f32 v[56:57], v[56:57], v[168:169] op_sel_hi:[1,0]
v_pk_mul_f32 v[58:59], v[58:59], v[168:169] op_sel_hi:[1,0]
v_pk_mul_f32 v[60:61], v[60:61], v[168:169] op_sel_hi:[1,0]
v_pk_mul_f32 v[62:63], v[62:63], v[168:169] op_sel_hi:[1,0]
v_pk_fma_f32 v[48:49], v[144:145], v[170:171], v[48:49] op_sel_hi:[1,0,1]
v_pk_fma_f32 v[50:51], v[146:147], v[170:171], v[50:51] op_sel_hi:[1,0,1]
v_pk_fma_f32 v[52:53], v[148:149], v[170:171], v[52:53] op_sel_hi:[1,0,1]
v_pk_fma_f32 v[54:55], v[150:151], v[170:171], v[54:55] op_sel_hi:[1,0,1]
v_pk_fma_f32 v[56:57], v[152:153], v[170:171], v[56:57] op_sel_hi:[1,0,1]
v_pk_fma_f32 v[58:59], v[154:155], v[170:171], v[58:59] op_sel_hi:[1,0,1]
v_pk_fma_f32 v[60:61], v[156:157], v[170:171], v[60:61] op_sel_hi:[1,0,1]
v_pk_fma_f32 v[62:63], v[158:159], v[170:171], v[62:63] op_sel_hi:[1,0,1]
v_cvt_pk_bf16_f32 v144, v48, v49
v_cvt_pk_bf16_f32 v145, v50, v51
v_cvt_pk_bf16_f32 v146, v52, v53
v_cvt_pk_bf16_f32 v147, v54, v55
v_cvt_pk_bf16_f32 v148, v56, v57
v_cvt_pk_bf16_f32 v149, v58, v59
v_cvt_pk_bf16_f32 v150, v60, v61
v_cvt_pk_bf16_f32 v151, v62, v63
buffer_store_dwordx4 v[144:147], v1, s[36:39], s50 offen offset:0 sc1
buffer_store_dwordx4 v[148:151], v1, s[36:39], s50 offen offset:1024 sc1
s_add_u32 s50, s50, 131072
s_waitcnt lgkmcnt(8)
v_pk_mul_f32 v[64:65], v[64:65], v[172:173] op_sel_hi:[1,0]
v_pk_mul_f32 v[66:67], v[66:67], v[172:173] op_sel_hi:[1,0]
v_pk_mul_f32 v[68:69], v[68:69], v[172:173] op_sel_hi:[1,0]
v_pk_mul_f32 v[70:71], v[70:71], v[172:173] op_sel_hi:[1,0]
v_pk_mul_f32 v[72:73], v[72:73], v[172:173] op_sel_hi:[1,0]
v_pk_mul_f32 v[74:75], v[74:75], v[172:173] op_sel_hi:[1,0]
v_pk_mul_f32 v[76:77], v[76:77], v[172:173] op_sel_hi:[1,0]
v_pk_mul_f32 v[78:79], v[78:79], v[172:173] op_sel_hi:[1,0]
v_pk_fma_f32 v[64:65], v[188:189], v[174:175], v[64:65] op_sel_hi:[1,0,1]
v_pk_fma_f32 v[66:67], v[190:191], v[174:175], v[66:67] op_sel_hi:[1,0,1]
v_pk_fma_f32 v[68:69], v[192:193], v[174:175], v[68:69] op_sel_hi:[1,0,1]
v_pk_fma_f32 v[70:71], v[194:195], v[174:175], v[70:71] op_sel_hi:[1,0,1]
v_pk_fma_f32 v[72:73], v[196:197], v[174:175], v[72:73] op_sel_hi:[1,0,1]
v_pk_fma_f32 v[74:75], v[198:199], v[174:175], v[74:75] op_sel_hi:[1,0,1]
v_pk_fma_f32 v[76:77], v[200:201], v[174:175], v[76:77] op_sel_hi:[1,0,1]
v_pk_fma_f32 v[78:79], v[202:203], v[174:175], v[78:79] op_sel_hi:[1,0,1]
v_cvt_pk_bf16_f32 v188, v64, v65
v_cvt_pk_bf16_f32 v189, v66, v67
v_cvt_pk_bf16_f32 v190, v68, v69
v_cvt_pk_bf16_f32 v191, v70, v71
v_cvt_pk_bf16_f32 v192, v72, v73
v_cvt_pk_bf16_f32 v193, v74, v75
v_cvt_pk_bf16_f32 v194, v76, v77
v_cvt_pk_bf16_f32 v195, v78, v79
buffer_store_dwordx4 v[188:191], v1, s[36:39], s50 offen offset:0 sc1
buffer_store_dwordx4 v[192:195], v1, s[36:39], s50 offen offset:1024 sc1
s_add_u32 s50, s50, 131072
s_waitcnt lgkmcnt(4)
v_pk_mul_f32 v[80:81], v[80:81], v[176:177] op_sel_hi:[1,0]
v_pk_mul_f32 v[82:83], v[82:83], v[176:177] op_sel_hi:[1,0]
v_pk_mul_f32 v[84:85], v[84:85], v[176:177] op_sel_hi:[1,0]
v_pk_mul_f32 v[86:87], v[86:87], v[176:177] op_sel_hi:[1,0]
v_pk_mul_f32 v[88:89], v[88:89], v[176:177] op_sel_hi:[1,0]
v_pk_mul_f32 v[90:91], v[90:91], v[176:177] op_sel_hi:[1,0]
v_pk_mul_f32 v[92:93], v[92:93], v[176:177] op_sel_hi:[1,0]
v_pk_mul_f32 v[94:95], v[94:95], v[176:177] op_sel_hi:[1,0]
v_pk_fma_f32 v[80:81], v[204:205], v[178:179], v[80:81] op_sel_hi:[1,0,1]
v_pk_fma_f32 v[82:83], v[206:207], v[178:179], v[82:83] op_sel_hi:[1,0,1]
v_pk_fma_f32 v[84:85], v[208:209], v[178:179], v[84:85] op_sel_hi:[1,0,1]
v_pk_fma_f32 v[86:87], v[210:211], v[178:179], v[86:87] op_sel_hi:[1,0,1]
v_pk_fma_f32 v[88:89], v[212:213], v[178:179], v[88:89] op_sel_hi:[1,0,1]
v_pk_fma_f32 v[90:91], v[214:215], v[178:179], v[90:91] op_sel_hi:[1,0,1]
v_pk_fma_f32 v[92:93], v[216:217], v[178:179], v[92:93] op_sel_hi:[1,0,1]
v_pk_fma_f32 v[94:95], v[218:219], v[178:179], v[94:95] op_sel_hi:[1,0,1]
v_cvt_pk_bf16_f32 v204, v80, v81
v_cvt_pk_bf16_f32 v205, v82, v83
v_cvt_pk_bf16_f32 v206, v84, v85
v_cvt_pk_bf16_f32 v207, v86, v87
v_cvt_pk_bf16_f32 v208, v88, v89
v_cvt_pk_bf16_f32 v209, v90, v91
v_cvt_pk_bf16_f32 v210, v92, v93
v_cvt_pk_bf16_f32 v211, v94, v95
buffer_store_dwordx4 v[204:207], v1, s[36:39], s50 offen offset:0 sc1
buffer_store_dwordx4 v[208:211], v1, s[36:39], s50 offen offset:1024 sc1
s_add_u32 s50, s50, 131072
s_waitcnt lgkmcnt(0)
s_barrier
v_pk_mul_f32 v[96:97], v[96:97], v[180:181] op_sel_hi:[1,0]
v_pk_mul_f32 v[98:99], v[98:99], v[180:181] op_sel_hi:[1,0]
v_pk_mul_f32 v[100:101], v[100:101], v[180:181] op_sel_hi:[1,0]
v_pk_mul_f32 v[102:103], v[102:103], v[180:181] op_sel_hi:[1,0]
v_pk_mul_f32 v[104:105], v[104:105], v[180:181] op_sel_hi:[1,0]
v_pk_mul_f32 v[106:107], v[106:107], v[180:181] op_sel_hi:[1,0]
v_pk_mul_f32 v[108:109], v[108:109], v[180:181] op_sel_hi:[1,0]
v_pk_mul_f32 v[110:111], v[110:111], v[180:181] op_sel_hi:[1,0]
v_pk_fma_f32 v[96:97], v[220:221], v[182:183], v[96:97] op_sel_hi:[1,0,1]
v_pk_fma_f32 v[98:99], v[222:223], v[182:183], v[98:99] op_sel_hi:[1,0,1]
v_pk_fma_f32 v[100:101], v[224:225], v[182:183], v[100:101] op_sel_hi:[1,0,1]
v_pk_fma_f32 v[102:103], v[226:227], v[182:183], v[102:103] op_sel_hi:[1,0,1]
v_pk_fma_f32 v[104:105], v[228:229], v[182:183], v[104:105] op_sel_hi:[1,0,1]
v_pk_fma_f32 v[106:107], v[230:231], v[182:183], v[106:107] op_sel_hi:[1,0,1]
v_pk_fma_f32 v[108:109], v[232:233], v[182:183], v[108:109] op_sel_hi:[1,0,1]
v_pk_fma_f32 v[110:111], v[234:235], v[182:183], v[110:111] op_sel_hi:[1,0,1]
v_cvt_pk_bf16_f32 v220, v96, v97
v_cvt_pk_bf16_f32 v221, v98, v99
v_cvt_pk_bf16_f32 v222, v100, v101
v_cvt_pk_bf16_f32 v223, v102, v103
v_cvt_pk_bf16_f32 v224, v104, v105
v_cvt_pk_bf16_f32 v225, v106, v107
v_cvt_pk_bf16_f32 v226, v108, v109
v_cvt_pk_bf16_f32 v227, v110, v111
buffer_store_dwordx4 v[220:223], v1, s[36:39], s50 offen offset:0 sc1
buffer_store_dwordx4 v[224:227], v1, s[36:39], s50 offen offset:1024 sc1
s_waitcnt vmcnt(19)
ds_read_b64_tr_b16 a[144:145], v10 offset:8448
ds_read_b64_tr_b16 a[146:147], v10 offset:8960
ds_read_b64_tr_b16 a[148:149], v10 offset:8480
ds_read_b64_tr_b16 a[150:151], v10 offset:8992
ds_read_b64_tr_b16 a[152:153], v10 offset:8512
ds_read_b64_tr_b16 a[154:155], v10 offset:9024
ds_read_b64_tr_b16 a[156:157], v10 offset:8544
ds_read_b64_tr_b16 a[158:159], v10 offset:9056
s_waitcnt lgkmcnt(8)
s_add_u32 m0, s59, 4224
s_nop 0
buffer_load_dwordx4 v6, s[28:31], s55 offen offset:0  lds
s_add_u32 m0, s59, 4256
s_nop 0
buffer_load_dwordx4 v6, s[28:31], s55 offen offset:1024  lds
s_add_u32 m0, s59, 4288
s_nop 0
buffer_load_dwordx4 v6, s[28:31], s55 offen offset:2048  lds
s_add_u32 m0, s59, 4320
s_nop 0
buffer_load_dwordx4 v6, s[28:31], s55 offen offset:3072  lds
s_add_u32 s55, s55, 32768
s_and_b32 s55, s55, 0x7ffff
s_waitcnt vmcnt(4)
s_barrier
s_cmp_lg_u32 s40, 3
s_cbranch_scc1 L_noflag
s_lshl_b64 exec, 1, s44
v_add_u32 v254, 1, v14
buffer_store_dword v254, v15, s[12:15], s58 offen sc1
s_mov_b64 exec, -1
L_noflag:
s_add_u32 s50, 0, s57
v_add_u32 v2, s50, v1
s_add_u32 s50, 131072, s57
v_add_u32 v3, s50, v1
s_add_u32 s50, 262144, s57
v_add_u32 v4, s50, v1
s_sub_u32 s50, 393216, s57
v_add_u32 v7, s50, v1
s_sub_u32 s50, 524288, s57
v_add_u32 v8, s50, v1
s_sub_u32 s50, 655360, s57
v_add_u32 v9, s50, v1
s_waitcnt vmcnt(19)
ds_read_b64_tr_b16 a[160:161], v10 offset:0
ds_read_b64_tr_b16 a[162:163], v10 offset:512
ds_read_b64_tr_b16 a[164:165], v10 offset:32
ds_read_b64_tr_b16 a[166:167], v10 offset:544
ds_read_b64_tr_b16 a[168:169], v10 offset:64
ds_read_b64_tr_b16 a[170:171], v10 offset:576
ds_read_b64_tr_b16 a[172:173], v10 offset:96
ds_read_b64_tr_b16 a[174:175], v10 offset:608
s_add_u32 m0, s46, 0
s_nop 0
buffer_load_dwordx4 v6, s[28:31], s55 offen offset:0  lds
s_add_u32 m0, s46, 32
s_nop 0
buffer_load_dwordx4 v6, s[28:31], s55 offen offset:1024  lds
s_add_u32 m0, s46, 64
s_nop 0
buffer_load_dwordx4 v6, s[28:31], s55 offen offset:2048  lds
s_add_u32 m0, s46, 96
s_nop 0
buffer_load_dwordx4 v6, s[28:31], s55 offen offset:3072  lds
s_add_u32 s55, s55, 32768
s_and_b32 s55, s55, 0x7ffff
s_add_u32 m0, s46, 4224
s_nop 0
buffer_load_dwordx4 v6, s[28:31], s55 offen offset:0  lds
s_add_u32 m0, s46, 4256
s_nop 0
buffer_load_dwordx4 v6, s[28:31], s55 offen offset:1024  lds
s_add_u32 m0, s46, 4288
s_nop 0
buffer_load_dwordx4 v6, s[28:31], s55 offen offset:2048  lds
s_add_u32 m0, s46, 4320
s_nop 0
buffer_load_dwordx4 v6, s[28:31], s55 offen offset:3072  lds
s_add_u32 s55, s55, 32768
s_and_b32 s55, s55, 0x7ffff
s_add_u32 m0, s46, 8448
s_nop 0
buffer_load_dwordx4 v6, s[28:31], s55 offen offset:0  lds
s_add_u32 m0, s46, 8480
s_nop 0
buffer_load_dwordx4 v6, s[28:31], s55 offen offset:1024  lds
s_add_u32 m0, s46, 8512
s_nop 0
buffer_load_dwordx4 v6, s[28:31], s55 offen offset:2048  lds
s_add_u32 m0, s46, 8544
s_nop 0
buffer_load_dwordx4 v6, s[28:31], s55 offen offset:3072  lds
s_add_u32 s55, s55, 32768
s_and_b32 s55, s55, 0x7ffff
s_add_u32 m0, s46, 12672
s_nop 0
buffer_load_dwordx4 v6, s[28:31], s55 offen offset:0  lds
s_add_u32 m0, s46, 12704
s_nop 0
buffer_load_dwordx4 v6, s[28:31], s55 offen offset:1024  lds
s_add_u32 m0, s46, 12736
s_nop 0
buffer_load_dwordx4 v6, s[28:31], s55 offen offset:2048  lds
s_add_u32 m0, s46, 12768
s_nop 0
buffer_load_dwordx4 v6, s[28:31], s55 offen offset:3072  lds
s_add_u32 s55, s55, 32768
s_and_b32 s55, s55, 0x7ffff
s_add_u32 m0, s46, 16896
s_nop 0
buffer_load_dwordx4 v6, s[28:31], s55 offen offset:0  lds
s_add_u32 m0, s46, 16928
s_nop 0
buffer_load_dwordx4 v6, s[28:31], s55 offen offset:1024  lds
s_add_u32 m0, s46, 16960
s_nop 0
buffer_load_dwordx4 v6, s[28:31], s55 offen offset:2048  lds
s_add_u32 m0, s46, 16992
s_nop 0
buffer_load_dwordx4 v6, s[28:31], s55 offen offset:3072  lds
s_add_u32 s55, s55, 32768
s_and_b32 s55, s55, 0x7ffff
s_add_u32 m0, s46, 21120
s_nop 0
buffer_load_dwordx4 v6, s[28:31], s55 offen offset:0  lds
s_add_u32 m0, s46, 21152
s_nop 0
buffer_load_dwordx4 v6, s[28:31], s55 offen offset:1024  lds
s_add_u32 m0, s46, 21184
s_nop 0
buffer_load_dwordx4 v6, s[28:31], s55 offen offset:2048  lds
s_add_u32 m0, s46, 21216
s_nop 0
buffer_load_dwordx4 v6, s[28:31], s55 offen offset:3072  lds
s_add_u32 s55, s55, 32768
s_and_b32 s55, s55, 0x7ffff
s_waitcnt lgkmcnt(8)
s_add_u32 m0, s59, 8448
s_nop 0
buffer_load_dwordx4 v6, s[28:31], s55 offen offset:0  lds
s_add_u32 m0, s59, 8480
s_nop 0
buffer_load_dwordx4 v6, s[28:31], s55 offen offset:1024  lds
s_add_u32 m0, s59, 8512
s_nop 0
buffer_load_dwordx4 v6, s[28:31], s55 offen offset:2048  lds
s_add_u32 m0, s59, 8544
s_nop 0
buffer_load_dwordx4 v6, s[28:31], s55 offen offset:3072  lds
s_add_u32 s55, s55, 32768
s_and_b32 s55, s55, 0x7ffff
s_waitcnt lgkmcnt(0)
s_add_u32 m0, s59, 0
s_nop 0
buffer_load_dwordx4 v6, s[28:31], s55 offen offset:0  lds
s_add_u32 m0, s59, 32
s_nop 0
buffer_load_dwordx4 v6, s[28:31], s55 offen offset:1024  lds
s_add_u32 m0, s59, 64
s_nop 0
buffer_load_dwordx4 v6, s[28:31], s55 offen offset:2048  lds
s_add_u32 m0, s59, 96
s_nop 0
buffer_load_dwordx4 v6, s[28:31], s55 offen offset:3072  lds
s_waitcnt vmcnt(32)
ds_read_b64_tr_b16 a[176:177], v10 offset:4224
ds_read_b64_tr_b16 a[178:179], v10 offset:4736
ds_read_b64_tr_b16 a[180:181], v10 offset:4256
ds_read_b64_tr_b16 a[182:183], v10 offset:4768
ds_read_b64_tr_b16 a[184:185], v10 offset:4288
ds_read_b64_tr_b16 a[186:187], v10 offset:4800
ds_read_b64_tr_b16 a[188:189], v10 offset:4320
ds_read_b64_tr_b16 a[190:191], v10 offset:4832
s_waitcnt vmcnt(28)
ds_read_b64_tr_b16 a[224:225], v11 offset:0
ds_read_b64_tr_b16 a[226:227], v11 offset:512
ds_read_b64_tr_b16 a[228:229], v11 offset:32
ds_read_b64_tr_b16 a[230:231], v11 offset:544
ds_read_b64_tr_b16 a[232:233], v11 offset:64
ds_read_b64_tr_b16 a[234:235], v11 offset:576
ds_read_b64_tr_b16 a[236:237], v11 offset:96
ds_read_b64_tr_b16 a[238:239], v11 offset:608
s_waitcnt vmcnt(24)
ds_read_b64_tr_b16 a[240:241], v11 offset:4224
ds_read_b64_tr_b16 a[242:243], v11 offset:4736
ds_read_b64_tr_b16 a[244:245], v11 offset:4256
ds_read_b64_tr_b16 a[246:247], v11 offset:4768
ds_read_b64_tr_b16 a[248:249], v11 offset:4288
ds_read_b64_tr_b16 a[250:251], v11 offset:4800
ds_read_b64_tr_b16 a[252:253], v11 offset:4320
ds_read_b64_tr_b16 a[254:255], v11 offset:4832
s_waitcnt vmcnt(20)
ds_read_b64_tr_b16 a[0:1], v11 offset:8448
ds_read_b64_tr_b16 a[2:3], v11 offset:8960
ds_read_b64_tr_b16 a[4:5], v11 offset:8480
ds_read_b64_tr_b16 a[6:7], v11 offset:8992
ds_read_b64_tr_b16 a[8:9], v11 offset:8512
ds_read_b64_tr_b16 a[10:11], v11 offset:9024
ds_read_b64_tr_b16 a[12:13], v11 offset:8544
ds_read_b64_tr_b16 a[14:15], v11 offset:9056
s_waitcnt vmcnt(16)
ds_read_b64_tr_b16 a[16:17], v11 offset:12672
ds_read_b64_tr_b16 a[18:19], v11 offset:13184
ds_read_b64_tr_b16 a[20:21], v11 offset:12704
ds_read_b64_tr_b16 a[22:23], v11 offset:13216
ds_read_b64_tr_b16 a[24:25], v11 offset:12736
ds_read_b64_tr_b16 a[26:27], v11 offset:13248
ds_read_b64_tr_b16 a[28:29], v11 offset:12768
ds_read_b64_tr_b16 a[30:31], v11 offset:13280
s_waitcnt vmcnt(12)
ds_read_b64_tr_b16 a[32:33], v11 offset:16896
ds_read_b64_tr_b16 a[34:35], v11 offset:17408
ds_read_b64_tr_b16 a[36:37], v11 offset:16928
ds_read_b64_tr_b16 a[38:39], v11 offset:17440
ds_read_b64_tr_b16 a[40:41], v11 offset:16960
ds_read_b64_tr_b16 a[42:43], v11 offset:17472
ds_read_b64_tr_b16 a[44:45], v11 offset:16992
ds_read_b64_tr_b16 a[46:47], v11 offset:17504
s_cmp_lg_u32 s40, 3
s_cbranch_scc1 L_noprobe
buffer_load_dword v255, v15, s[12:15], s58 offen sc1
L_noprobe:
s_waitcnt vmcnt(8)
ds_read_b64_tr_b16 a[48:49], v11 offset:21120
ds_read_b64_tr_b16 a[50:51], v11 offset:21632
ds_read_b64_tr_b16 a[52:53], v11 offset:21152
ds_read_b64_tr_b16 a[54:55], v11 offset:21664
ds_read_b64_tr_b16 a[56:57], v11 offset:21184
ds_read_b64_tr_b16 a[58:59], v11 offset:21696
ds_read_b64_tr_b16 a[60:61], v11 offset:21216
ds_read_b64_tr_b16 a[62:63], v11 offset:21728
v_mov_b32 v5, 162576
s_mov_b32 s50, 0
s_cmp_lg_u32 s40, 3
s_cbranch_scc1 L_lpoll
s_waitcnt vmcnt(0)
v_cmp_eq_u32 vcc, v255, v14
s_cbranch_vccz L_seen
L_poll:
s_sleep 1
buffer_load_dword v255, v15, s[12:15], s58 offen sc1
s_add_u32 s50, s50, 1
s_waitcnt vmcnt(0)
v_cmp_eq_u32 vcc, v255, v14
s_cbranch_vccz L_seen
s_cmp_lt_u32 s50, 0x200000
s_cbranch_scc1 L_poll
L_seen:
v_mov_b32 v255, 1
ds_write_b32 v5, v255 offset:12
s_branch L_polled
L_lpoll:
ds_read_b32 v255, v5 offset:12
s_add_u32 s50, s50, 1
s_waitcnt lgkmcnt(0)
v_readfirstlane_b32 s51, v255
s_cmp_lg_u32 s51, 0
s_cbranch_scc1 L_polled
s_cmp_lt_u32 s50, 0x2000000
s_cbranch_scc1 L_lpoll
L_polled:
buffer_load_dwordx4 v[112:115], v7, s[32:35], s56 offen sc1
buffer_load_dwordx4 v[116:119], v8, s[32:35], s56 offen sc1
buffer_load_dwordx4 v[120:123], v9, s[32:35], s56 offen sc1
s_add_u32 s56, s56, 1024
s_and_b32 s56, s56, 0x3fff
buffer_load_dwordx4 v[124:127], v7, s[32:35], s56 offen sc1
buffer_load_dwordx4 v[128:131], v8, s[32:35], s56 offen sc1
buffer_load_dwordx4 v[132:135], v9, s[32:35], s56 offen sc1
s_add_u32 s56, s56, 1024
s_and_b32 s56, s56, 0x3fff
buffer_load_dwordx4 v[136:139], v7, s[32:35], s56 offen sc1
buffer_load_dwordx4 v[140:143], v8, s[32:35], s56 offen sc1
buffer_load_dwordx4 v[144:147], v9, s[32:35], s56 offen sc1
s_add_u32 s56, s56, 1024
s_and_b32 s56, s56, 0x3fff
s_waitcnt vmcnt(6) lgkmcnt(0)
v_mfma_f32_16x16x32_bf16 v[28:31], a[192:195], v[112:115], 0
buffer_load_dwordx4 v[148:151], v7, s[32:35], s56 offen sc1
v_mfma_f32_16x16x32_bf16 v[32:35], a[192:195], v[116:119], 0
buffer_load_dwordx4 v[152:155], v8, s[32:35], s56 offen sc1
ds_read_b64_tr_b16 a[64:65], v10 offset:8448
v_mfma_f32_16x16x32_bf16 v[36:39], a[192:195], v[120:123], 0
buffer_load_dwordx4 v[156:159], v9, s[32:35], s56 offen sc1
s_add_u32 s56, s56, 1024
s_and_b32 s56, s56, 0x3fff
ds_read_b64_tr_b16 a[66:67], v10 offset:8960
v_mfma_f32_16x16x32_bf16 v[52:55], a[196:199], v[112:115], 0
ds_read_b64_tr_b16 a[68:69], v10 offset:8480
v_mfma_f32_16x16x32_bf16 v[56:59], a[196:199], v[116:119], 0
ds_read_b64_tr_b16 a[70:71], v10 offset:8992
v_mfma_f32_16x16x32_bf16 v[60:63], a[196:199], v[120:123], 0
buffer_load_dwordx4 v[160:163], v7, s[32:35], s56 offen sc1
ds_read_b64_tr_b16 a[72:73], v10 offset:8512
v_mfma_f32_16x16x32_bf16 v[76:79], a[200:203], v[112:115], 0
buffer_load_dwordx4 v[164:167], v8, s[32:35], s56 offen sc1
ds_read_b64_tr_b16 a[74:75], v10 offset:9024
v_mfma_f32_16x16x32_bf16 v[80:83], a[200:203], v[116:119], 0
buffer_load_dwordx4 v[168:171], v9, s[32:35], s56 offen sc1
s_add_u32 s56, s56, 1024
s_and_b32 s56, s56, 0x3fff
ds_read_b64_tr_b16 a[76:77], v10 offset:8544
v_mfma_f32_16x16x32_bf16 v[84:87], a[200:203], v[120:123], 0
ds_read_b64_tr_b16 a[78:79], v10 offset:9056
v_mfma_f32_16x16x32_bf16 v[100:103], a[204:207], v[112:115], 0
v_mfma_f32_16x16x32_bf16 v[104:107], a[204:207], v[116:119], 0
v_mfma_f32_16x16x32_bf16 v[108:111], a[204:207], v[120:123], 0
s_waitcnt vmcnt(9) lgkmcnt(0)
v_mfma_f32_16x16x32_bf16 v[28:31], a[208:211], v[124:127], v[28:31]
buffer_load_dwordx4 v[172:175], v7, s[32:35], s56 offen sc1
v_mfma_f32_16x16x32_bf16 v[32:35], a[208:211], v[128:131], v[32:35]
buffer_load_dwordx4 v[176:179], v8, s[32:35], s56 offen sc1
ds_read_b64_tr_b16 a[80:81], v10 offset:0
v_mfma_f32_16x16x32_bf16 v[36:39], a[208:211], v[132:135], v[36:39]
buffer_load_dwordx4 v[180:183], v9, s[32:35], s56 offen sc1
s_add_u32 s56, s56, 1024
s_and_b32 s56, s56, 0x3fff
ds_read_b64_tr_b16 a[82:83], v10 offset:512
v_mfma_f32_16x16x32_bf16 v[52:55], a[212:215], v[124:127], v[52:55]
ds_read_b64_tr_b16 a[84:85], v10 offset:32
v_mfma_f32_16x16x32_bf16 v[56:59], a[212:215], v[128:131], v[56:59]
ds_read_b64_tr_b16 a[86:87], v10 offset:544
v_mfma_f32_16x16x32_bf16 v[60:63], a[212:215], v[132:135], v[60:63]
buffer_load_dwordx4 v[184:187], v7, s[32:35], s56 offen sc1
ds_read_b64_tr_b16 a[88:89], v10 offset:64
v_mfma_f32_16x16x32_bf16 v[76:79], a[216:219], v[124:127], v[76:79]
buffer_load_dwordx4 v[188:191], v8, s[32:35], s56 offen sc1
ds_read_b64_tr_b16 a[90:91], v10 offset:576
v_mfma_f32_16x16x32_bf16 v[80:83], a[216:219], v[128:131], v[80:83]
buffer_load_dwordx4 v[192:195], v9, s[32:35], s56 offen sc1
s_add_u32 s56, s56, 1024
s_and_b32 s56, s56, 0x3fff
ds_read_b64_tr_b16 a[92:93], v10 offset:96
v_mfma_f32_16x16x32_bf16 v[84:87], a[216:219], v[132:135], v[84:87]
ds_read_b64_tr_b16 a[94:95], v10 offset:608
v_mfma_f32_16x16x32_bf16 v[100:103], a[220:223], v[124:127], v[100:103]
v_mfma_f32_16x16x32_bf16 v[104:107], a[220:223], v[128:131], v[104:107]
v_mfma_f32_16x16x32_bf16 v[108:111], a[220:223], v[132:135], v[108:111]
s_waitcnt vmcnt(9) lgkmcnt(0)
v_mfma_f32_16x16x32_bf16 v[28:31], a[96:99], v[136:139], v[28:31]
buffer_load_dwordx4 v[196:199], v7, s[32:35], s56 offen sc1
v_mfma_f32_16x16x32_bf16 v[28:31], a[112:115], v[148:151], v[28:31]
v_mfma_f32_16x16x32_bf16 v[32:35], a[96:99], v[140:143], v[32:35]
buffer_load_dwordx4 v[200:203], v8, s[32:35], s56 offen sc1
v_mfma_f32_16x16x32_bf16 v[32:35], a[112:115], v[152:155], v[32:35]
v_mfma_f32_16x16x32_bf16 v[36:39], a[96:99], v[144:147], v[36:39]
buffer_load_dwordx4 v[204:207], v9, s[32:35], s56 offen sc1
s_add_u32 s56, s56, 1024
s_and_b32 s56, s56, 0x3fff
v_mfma_f32_16x16x32_bf16 v[36:39], a[112:115], v[156:159], v[36:39]
v_mfma_f32_16x16x32_bf16 v[52:55], a[100:103], v[136:139], v[52:55]
v_mfma_f32_16x16x32_bf16 v[52:55], a[116:119], v[148:151], v[52:55]
buffer_load_dwordx4 v[208:211], v7, s[32:35], s56 offen sc1
v_mfma_f32_16x16x32_bf16 v[56:59], a[100:103], v[140:143], v[56:59]
v_mfma_f32_16x16x32_bf16 v[56:59], a[116:119], v[152:155], v[56:59]
buffer_load_dwordx4 v[212:215], v8, s[32:35], s56 offen sc1
v_mfma_f32_16x16x32_bf16 v[60:63], a[100:103], v[144:147], v[60:63]
v_mfma_f32_16x16x32_bf16 v[60:63], a[116:119], v[156:159], v[60:63]
buffer_load_dwordx4 v[216:219], v9, s[32:35], s56 offen sc1
s_add_u32 s56, s56, 1024
s_and_b32 s56, s56, 0x3fff
v_mfma_f32_16x16x32_bf16 v[76:79], a[104:107], v[136:139], v[76:79]
v_mfma_f32_16x16x32_bf16 v[76:79], a[120:123], v[148:151], v[76:79]
v_mfma_f32_16x16x32_bf16 v[80:83], a[104:107], v[140:143], v[80:83]
buffer_load_dwordx4 v[112:115], v7, s[32:35], s56 offen sc1
v_mfma_f32_16x16x32_bf16 v[80:83], a[120:123], v[152:155], v[80:83]
v_mfma_f32_16x16x32_bf16 v[84:87], a[104:107], v[144:147], v[84:87]
buffer_load_dwordx4 v[116:119], v8, s[32:35], s56 offen sc1
v_mfma_f32_16x16x32_bf16 v[84:87], a[120:123], v[156:159], v[84:87]
v_mfma_f32_16x16x32_bf16 v[100:103], a[108:111], v[136:139], v[100:103]
buffer_load_dwordx4 v[120:123], v9, s[32:35], s56 offen sc1
s_add_u32 s56, s56, 1024
s_and_b32 s56, s56, 0x3fff
v_mfma_f32_16x16x32_bf16 v[100:103], a[124:127], v[148:151], v[100:103]
v_mfma_f32_16x16x32_bf16 v[104:107], a[108:111], v[140:143], v[104:107]
v_mfma_f32_16x16x32_bf16 v[104:107], a[124:127], v[152:155], v[104:107]
v_mfma_f32_16x16x32_bf16 v[108:111], a[108:111], v[144:147], v[108:111]
v_mfma_f32_16x16x32_bf16 v[108:111], a[124:127], v[156:159], v[108:111]
s_waitcnt vmcnt(12) lgkmcnt(0)
v_mfma_f32_16x16x32_bf16 v[28:31], a[128:131], v[160:163], v[28:31]
buffer_load_dwordx4 v[124:127], v7, s[32:35], s56 offen sc1
v_mfma_f32_16x16x32_bf16 v[28:31], a[144:147], v[172:175], v[28:31]
v_mfma_f32_16x16x32_bf16 v[32:35], a[128:131], v[164:167], v[32:35]
buffer_load_dwordx4 v[128:131], v8, s[32:35], s56 offen sc1
v_mfma_f32_16x16x32_bf16 v[32:35], a[144:147], v[176:179], v[32:35]
v_mfma_f32_16x16x32_bf16 v[36:39], a[128:131], v[168:171], v[36:39]
buffer_load_dwordx4 v[132:135], v9, s[32:35], s56 offen sc1
s_add_u32 s56, s56, 1024
s_and_b32 s56, s56, 0x3fff
v_mfma_f32_16x16x32_bf16 v[36:39], a[144:147], v[180:183], v[36:39]
v_mfma_f32_16x16x32_bf16 v[52:55], a[132:135], v[160:163], v[52:55]
v_mfma_f32_16x16x32_bf16 v[52:55], a[148:151], v[172:175], v[52:55]
buffer_load_dwordx4 v[136:139], v7, s[32:35], s56 offen sc1
v_mfma_f32_16x16x32_bf16 v[56:59], a[132:135], v[164:167], v[56:59]
v_mfma_f32_16x16x32_bf16 v[56:59], a[148:151], v[176:179], v[56:59]
buffer_load_dwordx4 v[140:143], v8, s[32:35], s56 offen sc1
v_mfma_f32_16x16x32_bf16 v[60:63], a[132:135], v[168:171], v[60:63]
v_mfma_f32_16x16x32_bf16 v[60:63], a[148:151], v[180:183], v[60:63]
buffer_load_dwordx4 v[144:147], v9, s[32:35], s56 offen sc1
s_add_u32 s56, s56, 1024
s_and_b32 s56, s56, 0x3fff
v_mfma_f32_16x16x32_bf16 v[76:79], a[136:139], v[160:163], v[76:79]
v_mfma_f32_16x16x32_bf16 v[76:79], a[152:155], v[172:175], v[76:79]
v_mfma_f32_16x16x32_bf16 v[80:83], a[136:139], v[164:167], v[80:83]
buffer_load_dwordx4 v[148:151], v7, s[32:35], s56 offen sc1
v_mfma_f32_16x16x32_bf16 v[80:83], a[152:155], v[176:179], v[80:83]
v_mfma_f32_16x16x32_bf16 v[84:87], a[136:139], v[168:171], v[84:87]
buffer_load_dwordx4 v[152:155], v8, s[32:35], s56 offen sc1
v_mfma_f32_16x16x32_bf16 v[84:87], a[152:155], v[180:183], v[84:87]
v_mfma_f32_16x16x32_bf16 v[100:103], a[140:143], v[160:163], v[100:103]
buffer_load_dwordx4 v[156:159], v9, s[32:35], s56 offen sc1
s_add_u32 s56, s56, 1024
s_and_b32 s56, s56, 0x3fff
v_mfma_f32_16x16x32_bf16 v[100:103], a[156:159], v[172:175], v[100:103]
v_mfma_f32_16x16x32_bf16 v[104:107], a[140:143], v[164:167], v[104:107]
v_mfma_f32_16x16x32_bf16 v[104:107], a[156:159], v[176:179], v[104:107]
v_mfma_f32_16x16x32_bf16 v[108:111], a[140:143], v[168:171], v[108:111]
v_mfma_f32_16x16x32_bf16 v[108:111], a[156:159], v[180:183], v[108:111]
s_waitcnt vmcnt(15) lgkmcnt(0)
v_mfma_f32_16x16x32_bf16 v[28:31], a[160:163], v[184:187], v[28:31]
buffer_load_dwordx4 v[160:163], v7, s[32:35], s56 offen sc1
v_mfma_f32_16x16x32_bf16 v[28:31], a[176:179], v[196:199], v[28:31]
v_mfma_f32_16x16x32_bf16 v[32:35], a[160:163], v[188:191], v[32:35]
buffer_load_dwordx4 v[164:167], v8, s[32:35], s56 offen sc1
v_mfma_f32_16x16x32_bf16 v[32:35], a[176:179], v[200:203], v[32:35]
v_mfma_f32_16x16x32_bf16 v[36:39], a[160:163], v[192:195], v[36:39]
buffer_load_dwordx4 v[168:171], v9, s[32:35], s56 offen sc1
s_add_u32 s56, s56, 1024
s_and_b32 s56, s56, 0x3fff
v_mfma_f32_16x16x32_bf16 v[36:39], a[176:179], v[204:207], v[36:39]
v_mfma_f32_16x16x32_bf16 v[52:55], a[164:167], v[184:187], v[52:55]
v_mfma_f32_16x16x32_bf16 v[52:55], a[180:183], v[196:199], v[52:55]
v_mfma_f32_16x16x32_bf16 v[56:59], a[164:167], v[188:191], v[56:59]
v_mfma_f32_16x16x32_bf16 v[56:59], a[180:183], v[200:203], v[56:59]
v_mfma_f32_16x16x32_bf16 v[60:63], a[164:167], v[192:195], v[60:63]
v_mfma_f32_16x16x32_bf16 v[60:63], a[180:183], v[204:207], v[60:63]
buffer_load_dwordx4 v[172:175], v7, s[32:35], s56 offen sc1
v_mfma_f32_16x16x32_bf16 v[76:79], a[168:171], v[184:187], v[76:79]
v_mfma_f32_16x16x32_bf16 v[76:79], a[184:187], v[196:199], v[76:79]
buffer_load_dwordx4 v[176:179], v8, s[32:35], s56 offen sc1
v_mfma_f32_16x16x32_bf16 v[80:83], a[168:171], v[188:191], v[80:83]
v_mfma_f32_16x16x32_bf16 v[80:83], a[184:187], v[200:203], v[80:83]
buffer_load_dwordx4 v[180:183], v9, s[32:35], s56 offen sc1
s_add_u32 s56, s56, 1024
s_and_b32 s56, s56, 0x3fff
v_mfma_f32_16x16x32_bf16 v[84:87], a[168:171], v[192:195], v[84:87]
v_mfma_f32_16x16x32_bf16 v[84:87], a[184:187], v[204:207], v[84:87]
v_mfma_f32_16x16x32_bf16 v[100:103], a[172:175], v[184:187], v[100:103]
v_mfma_f32_16x16x32_bf16 v[100:103], a[188:191], v[196:199], v[100:103]
v_mfma_f32_16x16x32_bf16 v[104:107], a[172:175], v[188:191], v[104:107]
v_mfma_f32_16x16x32_bf16 v[104:107], a[188:191], v[200:203], v[104:107]
v_mfma_f32_16x16x32_bf16 v[108:111], a[172:175], v[192:195], v[108:111]
v_mfma_f32_16x16x32_bf16 v[108:111], a[188:191], v[204:207], v[108:111]
s_waitcnt vmcnt(15) lgkmcnt(0)
v_mfma_f32_16x16x32_bf16 v[28:31], a[224:227], v[208:211], v[28:31]
buffer_load_dwordx4 v[184:187], v7, s[32:35], s56 offen sc1
v_mfma_f32_16x16x32_bf16 v[28:31], a[240:243], v[112:115], v[28:31]
v_mfma_f32_16x16x32_bf16 v[32:35], a[224:227], v[212:215], v[32:35]
buffer_load_dwordx4 v[188:191], v8, s[32:35], s56 offen sc1
v_mfma_f32_16x16x32_bf16 v[32:35], a[240:243], v[116:119], v[32:35]
v_mfma_f32_16x16x32_bf16 v[36:39], a[224:227], v[216:219], v[36:39]
buffer_load_dwordx4 v[192:195], v9, s[32:35], s56 offen sc1
s_add_u32 s56, s56, 1024
s_and_b32 s56, s56, 0x3fff
v_mfma_f32_16x16x32_bf16 v[36:39], a[240:243], v[120:123], v[36:39]
v_mfma_f32_16x16x32_bf16 v[52:55], a[228:231], v[208:211], v[52:55]
v_mfma_f32_16x16x32_bf16 v[52:55], a[244:247], v[112:115], v[52:55]
v_mfma_f32_16x16x32_bf16 v[56:59], a[228:231], v[212:215], v[56:59]
v_mfma_f32_16x16x32_bf16 v[56:59], a[244:247], v[116:119], v[56:59]
v_mfma_f32_16x16x32_bf16 v[60:63], a[228:231], v[216:219], v[60:63]
v_mfma_f32_16x16x32_bf16 v[60:63], a[244:247], v[120:123], v[60:63]
buffer_load_dwordx4 v[196:199], v2, s[32:35], s56 offen sc1
v_mfma_f32_16x16x32_bf16 v[76:79], a[232:235], v[208:211], v[76:79]
v_mfma_f32_16x16x32_bf16 v[76:79], a[248:251], v[112:115], v[76:79]
buffer_load_dwordx4 v[200:203], v3, s[32:35], s56 offen sc1
v_mfma_f32_16x16x32_bf16 v[80:83], a[232:235], v[212:215], v[80:83]
v_mfma_f32_16x16x32_bf16 v[80:83], a[248:251], v[116:119], v[80:83]
buffer_load_dwordx4 v[204:207], v4, s[32:35], s56 offen sc1
s_add_u32 s56, s56, 1024
s_and_b32 s56, s56, 0x3fff
v_mfma_f32_16x16x32_bf16 v[84:87], a[232:235], v[216:219], v[84:87]
v_mfma_f32_16x16x32_bf16 v[84:87], a[248:251], v[120:123], v[84:87]
v_mfma_f32_16x16x32_bf16 v[100:103], a[236:239], v[208:211], v[100:103]
v_mfma_f32_16x16x32_bf16 v[100:103], a[252:255], v[112:115], v[100:103]
v_mfma_f32_16x16x32_bf16 v[104:107], a[236:239], v[212:215], v[104:107]
v_mfma_f32_16x16x32_bf16 v[104:107], a[252:255], v[116:119], v[104:107]
v_mfma_f32_16x16x32_bf16 v[108:111], a[236:239], v[216:219], v[108:111]
v_mfma_f32_16x16x32_bf16 v[108:111], a[252:255], v[120:123], v[108:111]
s_waitcnt vmcnt(15) lgkmcnt(0)
v_mfma_f32_16x16x32_bf16 v[28:31], a[0:3], v[124:127], v[28:31]
buffer_load_dwordx4 v[208:211], v2, s[32:35], s56 offen sc1
v_mfma_f32_16x16x32_bf16 v[28:31], a[16:19], v[136:139], v[28:31]
v_mfma_f32_16x16x32_bf16 v[32:35], a[0:3], v[128:131], v[32:35]
buffer_load_dwordx4 v[212:215], v3, s[32:35], s56 offen sc1
v_mfma_f32_16x16x32_bf16 v[32:35], a[16:19], v[140:143], v[32:35]
v_mfma_f32_16x16x32_bf16 v[36:39], a[0:3], v[132:135], v[36:39]
buffer_load_dwordx4 v[216:219], v4, s[32:35], s56 offen sc1
s_add_u32 s56, s56, 1024
s_and_b32 s56, s56, 0x3fff
s_xor_b32 s50, s40, 1
s_mul_i32 s50, s50, 18432
s_add_u32 s50, s50, 0
v_add_u32 v6, s50, v1
v_mfma_f32_16x16x32_bf16 v[36:39], a[16:19], v[144:147], v[36:39]
v_mfma_f32_16x16x32_bf16 v[52:55], a[4:7], v[124:127], v[52:55]
v_mfma_f32_16x16x32_bf16 v[52:55], a[20:23], v[136:139], v[52:55]
v_mfma_f32_16x16x32_bf16 v[56:59], a[4:7], v[128:131], v[56:59]
s_xor_b32 s50, s40, 2
s_mul_i32 s50, s50, 18432
s_add_u32 s50, s50, 6144
v_add_u32 v10, s50, v1
v_mfma_f32_16x16x32_bf16 v[56:59], a[20:23], v[140:143], v[56:59]
v_mfma_f32_16x16x32_bf16 v[60:63], a[4:7], v[132:135], v[60:63]
v_mfma_f32_16x16x32_bf16 v[60:63], a[20:23], v[144:147], v[60:63]
buffer_load_dwordx4 v[112:115], v2, s[32:35], s56 offen sc1
v_mfma_f32_16x16x32_bf16 v[76:79], a[8:11], v[124:127], v[76:79]
s_xor_b32 s50, s40, 3
s_mul_i32 s50, s50, 18432
s_add_u32 s50, s50, 12288
v_add_u32 v11, s50, v1
v_mfma_f32_16x16x32_bf16 v[76:79], a[24:27], v[136:139], v[76:79]
buffer_load_dwordx4 v[116:119], v3, s[32:35], s56 offen sc1
v_mfma_f32_16x16x32_bf16 v[80:83], a[8:11], v[128:131], v[80:83]
v_mfma_f32_16x16x32_bf16 v[80:83], a[24:27], v[140:143], v[80:83]
buffer_load_dwordx4 v[120:123], v4, s[32:35], s56 offen sc1
s_add_u32 s56, s56, 1024
s_and_b32 s56, s56, 0x3fff
v_mfma_f32_16x16x32_bf16 v[84:87], a[8:11], v[132:135], v[84:87]
s_mul_i32 s50, s40, 18432
v_add_u32 v13, s50, v1
v_mfma_f32_16x16x32_bf16 v[84:87], a[24:27], v[144:147], v[84:87]
v_mfma_f32_16x16x32_bf16 v[100:103], a[12:15], v[124:127], v[100:103]
v_mfma_f32_16x16x32_bf16 v[100:103], a[28:31], v[136:139], v[100:103]
v_mfma_f32_16x16x32_bf16 v[104:107], a[12:15], v[128:131], v[104:107]
v_mfma_f32_16x16x32_bf16 v[104:107], a[28:31], v[140:143], v[104:107]
v_mfma_f32_16x16x32_bf16 v[108:111], a[12:15], v[132:135], v[108:111]
v_mfma_f32_16x16x32_bf16 v[108:111], a[28:31], v[144:147], v[108:111]
s_barrier
s_waitcnt vmcnt(15)
v_mfma_f32_16x16x32_bf16 v[28:31], a[32:35], v[148:151], v[28:31]
buffer_load_dwordx4 v[124:127], v2, s[32:35], s56 offen sc1
v_mfma_f32_16x16x32_bf16 v[28:31], a[48:51], v[160:163], v[28:31]
v_mfma_f32_16x16x32_bf16 v[32:35], a[32:35], v[152:155], v[32:35]
buffer_load_dwordx4 v[128:131], v3, s[32:35], s56 offen sc1
v_mfma_f32_16x16x32_bf16 v[32:35], a[48:51], v[164:167], v[32:35]
v_mfma_f32_16x16x32_bf16 v[36:39], a[32:35], v[156:159], v[36:39]
buffer_load_dwordx4 v[132:135], v4, s[32:35], s56 offen sc1
s_add_u32 s56, s56, 1024
s_and_b32 s56, s56, 0x3fff
v_mfma_f32_16x16x32_bf16 v[36:39], a[48:51], v[168:171], v[36:39]
v_mfma_f32_16x16x32_bf16 v[52:55], a[36:39], v[148:151], v[52:55]
v_mfma_f32_16x16x32_bf16 v[52:55], a[52:55], v[160:163], v[52:55]
v_mfma_f32_16x16x32_bf16 v[56:59], a[36:39], v[152:155], v[56:59]
v_mfma_f32_16x16x32_bf16 v[56:59], a[52:55], v[164:167], v[56:59]
v_mfma_f32_16x16x32_bf16 v[60:63], a[36:39], v[156:159], v[60:63]
v_mfma_f32_16x16x32_bf16 v[60:63], a[52:55], v[168:171], v[60:63]
buffer_load_dwordx4 v[136:139], v2, s[32:35], s56 offen sc1
v_mfma_f32_16x16x32_bf16 v[76:79], a[40:43], v[148:151], v[76:79]
v_mfma_f32_16x16x32_bf16 v[76:79], a[56:59], v[160:163], v[76:79]
buffer_load_dwordx4 v[140:143], v3, s[32:35], s56 offen sc1
v_mfma_f32_16x16x32_bf16 v[80:83], a[40:43], v[152:155], v[80:83]
v_mfma_f32_16x16x32_bf16 v[80:83], a[56:59], v[164:167], v[80:83]
buffer_load_dwordx4 v[144:147], v4, s[32:35], s56 offen sc1
s_add_u32 s56, s56, 1024
s_and_b32 s56, s56, 0x3fff
v_mfma_f32_16x16x32_bf16 v[84:87], a[40:43], v[156:159], v[84:87]
v_mfma_f32_16x16x32_bf16 v[84:87], a[56:59], v[168:171], v[84:87]
v_mfma_f32_16x16x32_bf16 v[100:103], a[44:47], v[148:151], v[100:103]
v_mfma_f32_16x16x32_bf16 v[100:103], a[60:63], v[160:163], v[100:103]
v_mfma_f32_16x16x32_bf16 v[104:107], a[44:47], v[152:155], v[104:107]
v_mfma_f32_16x16x32_bf16 v[104:107], a[60:63], v[164:167], v[104:107]
v_mfma_f32_16x16x32_bf16 v[108:111], a[44:47], v[156:159], v[108:111]
v_mfma_f32_16x16x32_bf16 v[108:111], a[60:63], v[168:171], v[108:111]
s_waitcnt vmcnt(15)
v_mfma_f32_16x16x32_bf16 v[52:55], a[68:71], v[172:175], v[52:55]
buffer_load_dwordx4 v[148:151], v2, s[32:35], s56 offen sc1
v_mfma_f32_16x16x32_bf16 v[52:55], a[84:87], v[184:187], v[52:55]
v_mfma_f32_16x16x32_bf16 v[56:59], a[68:71], v[176:179], v[56:59]
buffer_load_dwordx4 v[152:155], v3, s[32:35], s56 offen sc1
v_mfma_f32_16x16x32_bf16 v[56:59], a[84:87], v[188:191], v[56:59]
v_mfma_f32_16x16x32_bf16 v[60:63], a[68:71], v[180:183], v[60:63]
buffer_load_dwordx4 v[156:159], v4, s[32:35], s56 offen sc1
s_add_u32 s56, s56, 1024
s_and_b32 s56, s56, 0x3fff
v_mfma_f32_16x16x32_bf16 v[60:63], a[84:87], v[192:195], v[60:63]
v_mfma_f32_16x16x32_bf16 v[76:79], a[72:75], v[172:175], v[76:79]
v_mfma_f32_16x16x32_bf16 v[76:79], a[88:91], v[184:187], v[76:79]
v_mfma_f32_16x16x32_bf16 v[80:83], a[72:75], v[176:179], v[80:83]
v_mfma_f32_16x16x32_bf16 v[80:83], a[88:91], v[188:191], v[80:83]
ds_write_b128 v6, v[52:55] offset:3072
v_mfma_f32_16x16x32_bf16 v[84:87], a[72:75], v[180:183], v[84:87]
v_mfma_f32_16x16x32_bf16 v[84:87], a[88:91], v[192:195], v[84:87]
buffer_load_dwordx4 v[160:163], v2, s[32:35], s56 offen sc1
ds_write_b128 v6, v[56:59] offset:4096
v_mfma_f32_16x16x32_bf16 v[100:103], a[76:79], v[172:175], v[100:103]
v_mfma_f32_16x16x32_bf16 v[100:103], a[92:95], v[184:187], v[100:103]
buffer_load_dwordx4 v[164:167], v3, s[32:35], s56 offen sc1
ds_write_b128 v6, v[60:63] offset:5120
v_mfma_f32_16x16x32_bf16 v[104:107], a[76:79], v[176:179], v[104:107]
v_mfma_f32_16x16x32_bf16 v[104:107], a[92:95], v[188:191], v[104:107]
buffer_load_dwordx4 v[168:171], v4, s[32:35], s56 offen sc1
s_add_u32 s56, s56, 1024
s_and_b32 s56, s56, 0x3fff
ds_write_b128 v10, v[76:79] offset:3072
v_mfma_f32_16x16x32_bf16 v[108:111], a[76:79], v[180:183], v[108:111]
v_mfma_f32_16x16x32_bf16 v[108:111], a[92:95], v[192:195], v[108:111]
ds_write_b128 v10, v[80:83] offset:4096
v_mfma_f32_16x16x32_bf16 v[28:31], a[64:67], v[172:175], v[28:31]
v_mfma_f32_16x16x32_bf16 v[28:31], a[80:83], v[184:187], v[28:31]
ds_write_b128 v10, v[84:87] offset:5120
v_mfma_f32_16x16x32_bf16 v[32:35], a[64:67], v[176:179], v[32:35]
v_mfma_f32_16x16x32_bf16 v[32:35], a[80:83], v[188:191], v[32:35]
ds_write_b128 v11, v[100:103] offset:3072
v_mfma_f32_16x16x32_bf16 v[36:39], a[64:67], v[180:183], v[36:39]
v_mfma_f32_16x16x32_bf16 v[36:39], a[80:83], v[192:195], v[36:39]
ds_write_b128 v11, v[104:107] offset:4096
s_waitcnt vmcnt(15)
v_mfma_f32_16x16x32_bf16 v[16:19], a[192:195], v[196:199], 0
buffer_load_dwordx4 v[172:175], v2, s[32:35], s56 offen sc1
v_mfma_f32_16x16x32_bf16 v[16:19], a[208:211], v[208:211], v[16:19]
ds_write_b128 v11, v[108:111] offset:5120
v_mfma_f32_16x16x32_bf16 v[20:23], a[192:195], v[200:203], 0
buffer_load_dwordx4 v[176:179], v3, s[32:35], s56 offen sc1
v_mfma_f32_16x16x32_bf16 v[20:23], a[208:211], v[212:215], v[20:23]
v_mfma_f32_16x16x32_bf16 v[24:27], a[192:195], v[204:207], 0
buffer_load_dwordx4 v[180:183], v4, s[32:35], s56 offen sc1
s_add_u32 s56, s56, 1024
s_and_b32 s56, s56, 0x3fff
v_mfma_f32_16x16x32_bf16 v[24:27], a[208:211], v[216:219], v[24:27]
v_mfma_f32_16x16x32_bf16 v[40:43], a[196:199], v[196:199], 0
s_waitcnt lgkmcnt(0)
s_barrier
v_mfma_f32_16x16x32_bf16 v[40:43], a[212:215], v[208:211], v[40:43]
ds_read_b128 v[220:223], v13 offset:3072
ds_read_b128 v[224:227], v13 offset:9216
v_mfma_f32_16x16x32_bf16 v[44:47], a[196:199], v[200:203], 0
ds_read_b128 v[228:231], v13 offset:15360
ds_read_b128 v[232:235], v13 offset:4096
v_mfma_f32_16x16x32_bf16 v[44:47], a[212:215], v[212:215], v[44:47]
ds_read_b128 v[236:239], v13 offset:10240
ds_read_b128 v[240:243], v13 offset:16384
v_mfma_f32_16x16x32_bf16 v[48:51], a[196:199], v[204:207], 0
ds_read_b128 v[244:247], v13 offset:5120
ds_read_b128 v[248:251], v13 offset:11264
v_mfma_f32_16x16x32_bf16 v[48:51], a[212:215], v[216:219], v[48:51]
buffer_load_dwordx4 v[184:187], v2, s[32:35], s56 offen sc1
ds_read_b128 v[252:255], v13 offset:17408
v_mfma_f32_16x16x32_bf16 v[64:67], a[200:203], v[196:199], 0
v_mfma_f32_16x16x32_bf16 v[64:67], a[216:219], v[208:211], v[64:67]
buffer_load_dwordx4 v[188:191], v3, s[32:35], s56 offen sc1
v_mfma_f32_16x16x32_bf16 v[68:71], a[200:203], v[200:203], 0
v_mfma_f32_16x16x32_bf16 v[68:71], a[216:219], v[212:215], v[68:71]
buffer_load_dwordx4 v[192:195], v4, s[32:35], s56 offen sc1
s_add_u32 s56, s56, 1024
s_and_b32 s56, s56, 0x3fff
v_mfma_f32_16x16x32_bf16 v[72:75], a[200:203], v[204:207], 0
v_mfma_f32_16x16x32_bf16 v[72:75], a[216:219], v[216:219], v[72:75]
s_waitcnt lgkmcnt(0)
v_mfma_f32_16x16x32_bf16 v[88:91], a[204:207], v[196:199], 0
v_add_f32 v28, v28, v220
v_add_f32 v224, v224, v228
v_mfma_f32_16x16x32_bf16 v[88:91], a[220:223], v[208:211], v[88:91]
v_add_f32 v29, v29, v221
v_mfma_f32_16x16x32_bf16 v[92:95], a[204:207], v[200:203], 0
v_add_f32 v225, v225, v229
v_add_f32 v30, v30, v222
v_mfma_f32_16x16x32_bf16 v[92:95], a[220:223], v[212:215], v[92:95]
v_add_f32 v226, v226, v230
v_mfma_f32_16x16x32_bf16 v[96:99], a[204:207], v[204:207], 0
v_add_f32 v31, v31, v223
v_add_f32 v227, v227, v231
v_mfma_f32_16x16x32_bf16 v[96:99], a[220:223], v[216:219], v[96:99]
v_add_f32 v28, v28, v224
s_waitcnt vmcnt(15)
v_mfma_f32_16x16x32_bf16 v[16:19], a[96:99], v[112:115], v[16:19]
buffer_load_dwordx4 v[196:199], v2, s[32:35], s56 offen sc1
v_add_f32 v29, v29, v225
v_add_f32 v30, v30, v226
v_mfma_f32_16x16x32_bf16 v[16:19], a[112:115], v[124:127], v[16:19]
v_add_f32 v31, v31, v227
v_mfma_f32_16x16x32_bf16 v[20:23], a[96:99], v[116:119], v[20:23]
buffer_load_dwordx4 v[200:203], v3, s[32:35], s56 offen sc1
buffer_store_dwordx4 v[28:31], v1, s[12:15], s17 offen offset:0 sc1
v_add_f32 v32, v32, v232
v_mfma_f32_16x16x32_bf16 v[20:23], a[112:115], v[128:131], v[20:23]
v_add_f32 v236, v236, v240
v_mfma_f32_16x16x32_bf16 v[24:27], a[96:99], v[120:123], v[24:27]
buffer_load_dwordx4 v[204:207], v4, s[32:35], s56 offen sc1
s_add_u32 s56, s56, 1024
s_and_b32 s56, s56, 0x3fff
v_add_f32 v33, v33, v233
v_add_f32 v237, v237, v241
v_mfma_f32_16x16x32_bf16 v[24:27], a[112:115], v[132:135], v[24:27]
v_add_f32 v34, v34, v234
v_mfma_f32_16x16x32_bf16 v[40:43], a[100:103], v[112:115], v[40:43]
v_add_f32 v238, v238, v242
v_add_f32 v35, v35, v235
v_mfma_f32_16x16x32_bf16 v[40:43], a[116:119], v[124:127], v[40:43]
v_add_f32 v239, v239, v243
v_mfma_f32_16x16x32_bf16 v[44:47], a[100:103], v[116:119], v[44:47]
v_add_f32 v32, v32, v236
v_add_f32 v33, v33, v237
v_mfma_f32_16x16x32_bf16 v[44:47], a[116:119], v[128:131], v[44:47]
v_add_f32 v34, v34, v238
v_mfma_f32_16x16x32_bf16 v[48:51], a[100:103], v[120:123], v[48:51]
v_add_f32 v35, v35, v239
buffer_store_dwordx4 v[32:35], v1, s[12:15], s17 offen offset:1024 sc1
v_mfma_f32_16x16x32_bf16 v[48:51], a[116:119], v[132:135], v[48:51]
buffer_load_dwordx4 v[208:211], v2, s[32:35], s56 offen sc1
v_add_f32 v36, v36, v244
v_mfma_f32_16x16x32_bf16 v[64:67], a[104:107], v[112:115], v[64:67]
v_add_f32 v248, v248, v252
v_add_f32 v37, v37, v245
v_mfma_f32_16x16x32_bf16 v[64:67], a[120:123], v[124:127], v[64:67]
buffer_load_dwordx4 v[212:215], v3, s[32:35], s56 offen sc1
v_add_f32 v249, v249, v253
v_mfma_f32_16x16x32_bf16 v[68:71], a[104:107], v[116:119], v[68:71]
v_add_f32 v38, v38, v246
v_add_f32 v250, v250, v254
v_mfma_f32_16x16x32_bf16 v[68:71], a[120:123], v[128:131], v[68:71]
buffer_load_dwordx4 v[216:219], v4, s[32:35], s56 offen sc1
s_add_u32 s56, s56, 1024
s_and_b32 s56, s56, 0x3fff
v_add_f32 v39, v39, v247
v_mfma_f32_16x16x32_bf16 v[72:75], a[104:107], v[120:123], v[72:75]
v_add_f32 v251, v251, v255
v_add_f32 v36, v36, v248
v_mfma_f32_16x16x32_bf16 v[72:75], a[120:123], v[132:135], v[72:75]
v_add_f32 v37, v37, v249
v_mfma_f32_16x16x32_bf16 v[88:91], a[108:111], v[112:115], v[88:91]
v_add_f32 v38, v38, v250
v_add_f32 v39, v39, v251
v_mfma_f32_16x16x32_bf16 v[88:91], a[124:127], v[124:127], v[88:91]
buffer_store_dwordx4 v[36:39], v1, s[12:15], s17 offen offset:2048 sc1
v_mfma_f32_16x16x32_bf16 v[92:95], a[108:111], v[116:119], v[92:95]
v_mfma_f32_16x16x32_bf16 v[92:95], a[124:127], v[128:131], v[92:95]
v_mfma_f32_16x16x32_bf16 v[96:99], a[108:111], v[120:123], v[96:99]
v_mfma_f32_16x16x32_bf16 v[96:99], a[124:127], v[132:135], v[96:99]
s_waitcnt vmcnt(18)
v_mfma_f32_16x16x32_bf16 v[16:19], a[128:131], v[136:139], v[16:19]
buffer_load_dwordx4 v[112:115], v2, s[32:35], s56 offen sc1
v_mfma_f32_16x16x32_bf16 v[16:19], a[144:147], v[148:151], v[16:19]
v_mfma_f32_16x16x32_bf16 v[20:23], a[128:131], v[140:143], v[20:23]
buffer_load_dwordx4 v[116:119], v3, s[32:35], s56 offen sc1
v_mfma_f32_16x16x32_bf16 v[20:23], a[144:147], v[152:155], v[20:23]
v_mfma_f32_16x16x32_bf16 v[24:27], a[128:131], v[144:147], v[24:27]
buffer_load_dwordx4 v[120:123], v4, s[32:35], s56 offen sc1
s_add_u32 s56, s56, 1024
s_and_b32 s56, s56, 0x3fff
v_mfma_f32_16x16x32_bf16 v[24:27], a[144:147], v[156:159], v[24:27]
v_mfma_f32_16x16x32_bf16 v[40:43], a[132:135], v[136:139], v[40:43]
v_mfma_f32_16x16x32_bf16 v[40:43], a[148:151], v[148:151], v[40:43]
v_mfma_f32_16x16x32_bf16 v[44:47], a[132:135], v[140:143], v[44:47]
v_mfma_f32_16x16x32_bf16 v[44:47], a[148:151], v[152:155], v[44:47]
v_mfma_f32_16x16x32_bf16 v[48:51], a[132:135], v[144:147], v[48:51]
v_mfma_f32_16x16x32_bf16 v[48:51], a[148:151], v[156:159], v[48:51]
buffer_load_dwordx4 v[124:127], v2, s[32:35], s56 offen sc1
v_mfma_f32_16x16x32_bf16 v[64:67], a[136:139], v[136:139], v[64:67]
v_mfma_f32_16x16x32_bf16 v[64:67], a[152:155], v[148:151], v[64:67]
buffer_load_dwordx4 v[128:131], v3, s[32:35], s56 offen sc1
v_mfma_f32_16x16x32_bf16 v[68:71], a[136:139], v[140:143], v[68:71]
v_mfma_f32_16x16x32_bf16 v[68:71], a[152:155], v[152:155], v[68:71]
buffer_load_dwordx4 v[132:135], v4, s[32:35], s56 offen sc1
s_add_u32 s56, s56, 1024
s_and_b32 s56, s56, 0x3fff
v_mfma_f32_16x16x32_bf16 v[72:75], a[136:139], v[144:147], v[72:75]
v_mfma_f32_16x16x32_bf16 v[72:75], a[152:155], v[156:159], v[72:75]
v_mfma_f32_16x16x32_bf16 v[88:91], a[140:143], v[136:139], v[88:91]
v_mfma_f32_16x16x32_bf16 v[88:91], a[156:159], v[148:151], v[88:91]
v_mfma_f32_16x16x32_bf16 v[92:95], a[140:143], v[140:143], v[92:95]
v_mfma_f32_16x16x32_bf16 v[92:95], a[156:159], v[152:155], v[92:95]
v_mfma_f32_16x16x32_bf16 v[96:99], a[140:143], v[144:147], v[96:99]
v_mfma_f32_16x16x32_bf16 v[96:99], a[156:159], v[156:159], v[96:99]
s_waitcnt vmcnt(18)
v_mfma_f32_16x16x32_bf16 v[16:19], a[160:163], v[160:163], v[16:19]
buffer_load_dwordx4 v[136:139], v2, s[32:35], s56 offen sc1
v_mfma_f32_16x16x32_bf16 v[16:19], a[176:179], v[172:175], v[16:19]
v_mfma_f32_16x16x32_bf16 v[20:23], a[160:163], v[164:167], v[20:23]
buffer_load_dwordx4 v[140:143], v3, s[32:35], s56 offen sc1
v_mfma_f32_16x16x32_bf16 v[20:23], a[176:179], v[176:179], v[20:23]
v_mfma_f32_16x16x32_bf16 v[24:27], a[160:163], v[168:171], v[24:27]
buffer_load_dwordx4 v[144:147], v4, s[32:35], s56 offen sc1
s_add_u32 s56, s56, 1024
s_and_b32 s56, s56, 0x3fff
v_mfma_f32_16x16x32_bf16 v[24:27], a[176:179], v[180:183], v[24:27]
v_mfma_f32_16x16x32_bf16 v[40:43], a[164:167], v[160:163], v[40:43]
v_mfma_f32_16x16x32_bf16 v[40:43], a[180:183], v[172:175], v[40:43]
v_mfma_f32_16x16x32_bf16 v[44:47], a[164:167], v[164:167], v[44:47]
v_mfma_f32_16x16x32_bf16 v[44:47], a[180:183], v[176:179], v[44:47]
v_mfma_f32_16x16x32_bf16 v[48:51], a[164:167], v[168:171], v[48:51]
v_mfma_f32_16x16x32_bf16 v[48:51], a[180:183], v[180:183], v[48:51]
buffer_load_dwordx4 v[148:151], v2, s[32:35], s56 offen sc1
v_mfma_f32_16x16x32_bf16 v[64:67], a[168:171], v[160:163], v[64:67]
v_mfma_f32_16x16x32_bf16 v[64:67], a[184:187], v[172:175], v[64:67]
buffer_load_dwordx4 v[152:155], v3, s[32:35], s56 offen sc1
v_mfma_f32_16x16x32_bf16 v[68:71], a[168:171], v[164:167], v[68:71]
v_mfma_f32_16x16x32_bf16 v[68:71], a[184:187], v[176:179], v[68:71]
buffer_load_dwordx4 v[156:159], v4, s[32:35], s56 offen sc1
s_add_u32 s56, s56, 1024
s_and_b32 s56, s56, 0x3fff
v_mfma_f32_16x16x32_bf16 v[72:75], a[168:171], v[168:171], v[72:75]
v_mfma_f32_16x16x32_bf16 v[72:75], a[184:187], v[180:183], v[72:75]
v_mfma_f32_16x16x32_bf16 v[88:91], a[172:175], v[160:163], v[88:91]
v_mfma_f32_16x16x32_bf16 v[88:91], a[188:191], v[172:175], v[88:91]
v_mfma_f32_16x16x32_bf16 v[92:95], a[172:175], v[164:167], v[92:95]
v_mfma_f32_16x16x32_bf16 v[92:95], a[188:191], v[176:179], v[92:95]
v_mfma_f32_16x16x32_bf16 v[96:99], a[172:175], v[168:171], v[96:99]
v_mfma_f32_16x16x32_bf16 v[96:99], a[188:191], v[180:183], v[96:99]
s_waitcnt vmcnt(17)
v_mfma_f32_16x16x32_bf16 v[16:19], a[224:227], v[184:187], v[16:19]
buffer_load_dwordx4 v[160:163], v2, s[32:35], s56 offen sc1
v_mfma_f32_16x16x32_bf16 v[16:19], a[240:243], v[196:199], v[16:19]
v_mfma_f32_16x16x32_bf16 v[20:23], a[224:227], v[188:191], v[20:23]
buffer_load_dwordx4 v[164:167], v3, s[32:35], s56 offen sc1
v_mfma_f32_16x16x32_bf16 v[20:23], a[240:243], v[200:203], v[20:23]
v_mfma_f32_16x16x32_bf16 v[24:27], a[224:227], v[192:195], v[24:27]
buffer_load_dwordx4 v[168:171], v4, s[32:35], s56 offen sc1
s_add_u32 s56, s56, 1024
s_and_b32 s56, s56, 0x3fff
v_mfma_f32_16x16x32_bf16 v[24:27], a[240:243], v[204:207], v[24:27]
v_mfma_f32_16x16x32_bf16 v[40:43], a[228:231], v[184:187], v[40:43]
v_mfma_f32_16x16x32_bf16 v[40:43], a[244:247], v[196:199], v[40:43]
v_mfma_f32_16x16x32_bf16 v[44:47], a[228:231], v[188:191], v[44:47]
v_mfma_f32_16x16x32_bf16 v[44:47], a[244:247], v[200:203], v[44:47]
v_mfma_f32_16x16x32_bf16 v[48:51], a[228:231], v[192:195], v[48:51]
v_mfma_f32_16x16x32_bf16 v[48:51], a[244:247], v[204:207], v[48:51]
v_mfma_f32_16x16x32_bf16 v[64:67], a[232:235], v[184:187], v[64:67]
v_mfma_f32_16x16x32_bf16 v[64:67], a[248:251], v[196:199], v[64:67]
v_mfma_f32_16x16x32_bf16 v[68:71], a[232:235], v[188:191], v[68:71]
v_mfma_f32_16x16x32_bf16 v[68:71], a[248:251], v[200:203], v[68:71]
v_mfma_f32_16x16x32_bf16 v[72:75], a[232:235], v[192:195], v[72:75]
v_mfma_f32_16x16x32_bf16 v[72:75], a[248:251], v[204:207], v[72:75]
v_mfma_f32_16x16x32_bf16 v[88:91], a[236:239], v[184:187], v[88:91]
v_mfma_f32_16x16x32_bf16 v[88:91], a[252:255], v[196:199], v[88:91]
v_mfma_f32_16x16x32_bf16 v[92:95], a[236:239], v[188:191], v[92:95]
v_mfma_f32_16x16x32_bf16 v[92:95], a[252:255], v[200:203], v[92:95]
v_mfma_f32_16x16x32_bf16 v[96:99], a[236:239], v[192:195], v[96:99]
v_mfma_f32_16x16x32_bf16 v[96:99], a[252:255], v[204:207], v[96:99]
s_waitcnt vmcnt(12)
v_mfma_f32_16x16x32_bf16 v[16:19], a[0:3], v[208:211], v[16:19]
v_mfma_f32_16x16x32_bf16 v[16:19], a[16:19], v[112:115], v[16:19]
v_mfma_f32_16x16x32_bf16 v[20:23], a[0:3], v[212:215], v[20:23]
v_mfma_f32_16x16x32_bf16 v[20:23], a[16:19], v[116:119], v[20:23]
v_mfma_f32_16x16x32_bf16 v[24:27], a[0:3], v[216:219], v[24:27]
v_mfma_f32_16x16x32_bf16 v[24:27], a[16:19], v[120:123], v[24:27]
v_mfma_f32_16x16x32_bf16 v[40:43], a[4:7], v[208:211], v[40:43]
v_mfma_f32_16x16x32_bf16 v[40:43], a[20:23], v[112:115], v[40:43]
v_mfma_f32_16x16x32_bf16 v[44:47], a[4:7], v[212:215], v[44:47]
v_mfma_f32_16x16x32_bf16 v[44:47], a[20:23], v[116:119], v[44:47]
v_mfma_f32_16x16x32_bf16 v[48:51], a[4:7], v[216:219], v[48:51]
v_mfma_f32_16x16x32_bf16 v[48:51], a[20:23], v[120:123], v[48:51]
v_mfma_f32_16x16x32_bf16 v[64:67], a[8:11], v[208:211], v[64:67]
v_mfma_f32_16x16x32_bf16 v[64:67], a[24:27], v[112:115], v[64:67]
v_mfma_f32_16x16x32_bf16 v[68:71], a[8:11], v[212:215], v[68:71]
v_mfma_f32_16x16x32_bf16 v[68:71], a[24:27], v[116:119], v[68:71]
v_mfma_f32_16x16x32_bf16 v[72:75], a[8:11], v[216:219], v[72:75]
v_mfma_f32_16x16x32_bf16 v[72:75], a[24:27], v[120:123], v[72:75]
v_mfma_f32_16x16x32_bf16 v[88:91], a[12:15], v[208:211], v[88:91]
v_mfma_f32_16x16x32_bf16 v[88:91], a[28:31], v[112:115], v[88:91]
v_mfma_f32_16x16x32_bf16 v[92:95], a[12:15], v[212:215], v[92:95]
v_mfma_f32_16x16x32_bf16 v[92:95], a[28:31], v[116:119], v[92:95]
v_mfma_f32_16x16x32_bf16 v[96:99], a[12:15], v[216:219], v[96:99]
v_mfma_f32_16x16x32_bf16 v[96:99], a[28:31], v[120:123], v[96:99]
s_waitcnt vmcnt(6)
v_mfma_f32_16x16x32_bf16 v[16:19], a[32:35], v[124:127], v[16:19]
v_mfma_f32_16x16x32_bf16 v[16:19], a[48:51], v[136:139], v[16:19]
v_mfma_f32_16x16x32_bf16 v[20:23], a[32:35], v[128:131], v[20:23]
v_mfma_f32_16x16x32_bf16 v[20:23], a[48:51], v[140:143], v[20:23]
v_mfma_f32_16x16x32_bf16 v[24:27], a[32:35], v[132:135], v[24:27]
v_mfma_f32_16x16x32_bf16 v[24:27], a[48:51], v[144:147], v[24:27]
v_mfma_f32_16x16x32_bf16 v[40:43], a[36:39], v[124:127], v[40:43]
v_mfma_f32_16x16x32_bf16 v[40:43], a[52:55], v[136:139], v[40:43]
v_mfma_f32_16x16x32_bf16 v[44:47], a[36:39], v[128:131], v[44:47]
v_mfma_f32_16x16x32_bf16 v[44:47], a[52:55], v[140:143], v[44:47]
v_mfma_f32_16x16x32_bf16 v[48:51], a[36:39], v[132:135], v[48:51]
v_mfma_f32_16x16x32_bf16 v[48:51], a[52:55], v[144:147], v[48:51]
v_mfma_f32_16x16x32_bf16 v[64:67], a[40:43], v[124:127], v[64:67]
v_mfma_f32_16x16x32_bf16 v[64:67], a[56:59], v[136:139], v[64:67]
v_mfma_f32_16x16x32_bf16 v[68:71], a[40:43], v[128:131], v[68:71]
buffer_load_dwordx4 v[52:55], v1, s[12:15], s16 offen offset:0 sc1
v_mfma_f32_16x16x32_bf16 v[68:71], a[56:59], v[140:143], v[68:71]
v_mfma_f32_16x16x32_bf16 v[72:75], a[40:43], v[132:135], v[72:75]
buffer_load_dwordx4 v[56:59], v1, s[12:15], s16 offen offset:1024 sc1
v_mfma_f32_16x16x32_bf16 v[72:75], a[56:59], v[144:147], v[72:75]
v_mfma_f32_16x16x32_bf16 v[88:91], a[44:47], v[124:127], v[88:91]
buffer_load_dwordx4 v[60:63], v1, s[12:15], s16 offen offset:2048 sc1
v_mfma_f32_16x16x32_bf16 v[88:91], a[60:63], v[136:139], v[88:91]
v_mfma_f32_16x16x32_bf16 v[92:95], a[44:47], v[128:131], v[92:95]
v_mfma_f32_16x16x32_bf16 v[92:95], a[60:63], v[140:143], v[92:95]
v_mfma_f32_16x16x32_bf16 v[96:99], a[44:47], v[132:135], v[96:99]
v_mfma_f32_16x16x32_bf16 v[96:99], a[60:63], v[144:147], v[96:99]
s_waitcnt vmcnt(3)
v_mfma_f32_16x16x32_bf16 v[40:43], a[68:71], v[148:151], v[40:43]
v_mfma_f32_16x16x32_bf16 v[40:43], a[84:87], v[160:163], v[40:43]
v_mfma_f32_16x16x32_bf16 v[44:47], a[68:71], v[152:155], v[44:47]
v_mfma_f32_16x16x32_bf16 v[44:47], a[84:87], v[164:167], v[44:47]
v_mfma_f32_16x16x32_bf16 v[48:51], a[68:71], v[156:159], v[48:51]
v_mfma_f32_16x16x32_bf16 v[48:51], a[84:87], v[168:171], v[48:51]
v_mfma_f32_16x16x32_bf16 v[64:67], a[72:75], v[148:151], v[64:67]
v_mfma_f32_16x16x32_bf16 v[64:67], a[88:91], v[160:163], v[64:67]
v_mfma_f32_16x16x32_bf16 v[68:71], a[72:75], v[152:155], v[68:71]
v_mfma_f32_16x16x32_bf16 v[68:71], a[88:91], v[164:167], v[68:71]
ds_write_b128 v6, v[40:43] offset:0
v_mfma_f32_16x16x32_bf16 v[72:75], a[72:75], v[156:159], v[72:75]
v_mfma_f32_16x16x32_bf16 v[72:75], a[88:91], v[168:171], v[72:75]
ds_write_b128 v6, v[44:47] offset:1024
v_mfma_f32_16x16x32_bf16 v[88:91], a[76:79], v[148:151], v[88:91]
v_mfma_f32_16x16x32_bf16 v[88:91], a[92:95], v[160:163], v[88:91]
ds_write_b128 v6, v[48:51] offset:2048
v_mfma_f32_16x16x32_bf16 v[92:95], a[76:79], v[152:155], v[92:95]
v_mfma_f32_16x16x32_bf16 v[92:95], a[92:95], v[164:167], v[92:95]
ds_write_b128 v10, v[64:67] offset:0
v_mfma_f32_16x16x32_bf16 v[96:99], a[76:79], v[156:159], v[96:99]
v_mfma_f32_16x16x32_bf16 v[96:99], a[92:95], v[168:171], v[96:99]
ds_write_b128 v10, v[68:71] offset:1024
v_mfma_f32_16x16x32_bf16 v[16:19], a[64:67], v[148:151], v[16:19]
v_mfma_f32_16x16x32_bf16 v[16:19], a[80:83], v[160:163], v[16:19]
ds_write_b128 v10, v[72:75] offset:2048
v_mfma_f32_16x16x32_bf16 v[20:23], a[64:67], v[152:155], v[20:23]
v_mfma_f32_16x16x32_bf16 v[20:23], a[80:83], v[164:167], v[20:23]
ds_write_b128 v11, v[88:91] offset:0
v_mfma_f32_16x16x32_bf16 v[24:27], a[64:67], v[156:159], v[24:27]
v_mfma_f32_16x16x32_bf16 v[24:27], a[80:83], v[168:171], v[24:27]
ds_write_b128 v11, v[92:95] offset:1024
s_nop 1
ds_write_b128 v11, v[96:99] offset:2048
s_waitcnt lgkmcnt(0)
s_barrier
ds_read_b128 v[220:223], v13 offset:0
ds_read_b128 v[224:227], v13 offset:6144
ds_read_b128 v[228:231], v13 offset:12288
ds_read_b128 v[232:235], v13 offset:1024
ds_read_b128 v[236:239], v13 offset:7168
ds_read_b128 v[240:243], v13 offset:13312
ds_read_b128 v[244:247], v13 offset:2048
ds_read_b128 v[248:251], v13 offset:8192
ds_read_b128 v[252:255], v13 offset:14336
s_mov_b32 s50, 0
s_branch L_boxchk
L_box:
buffer_load_dwordx4 v[52:55], v1, s[12:15], s16 offen offset:0 sc1
buffer_load_dwordx4 v[56:59], v1, s[12:15], s16 offen offset:1024 sc1
buffer_load_dwordx4 v[60:63], v1, s[12:15], s16 offen offset:2048 sc1
s_add_u32 s50, s50, 1
L_boxchk:
s_waitcnt vmcnt(0)
v_max3_u32 v112, v52, v53, v54
v_max3_u32 v113, v55, v56, v57
v_max3_u32 v114, v58, v59, v60
v_max3_u32 v115, v61, v62, v63
v_max3_u32 v112, v112, v113, v114
v_max_u32 v112, v112, v115
v_cmp_eq_u32 vcc, -1, v112
s_cbranch_vccz L_boxed
s_cmp_lt_u32 s50, 0x200000
s_cbranch_scc1 L_box
L_boxed:
s_waitcnt lgkmcnt(6)
v_add_f32 v16, v16, v220
v_add_f32 v224, v224, v228
v_add_f32 v17, v17, v221
v_add_f32 v225, v225, v229
v_add_f32 v18, v18, v222
v_add_f32 v226, v226, v230
v_add_f32 v19, v19, v223
v_add_f32 v227, v227, v231
v_add_f32 v16, v16, v224
v_add_f32 v17, v17, v225
v_add_f32 v18, v18, v226
v_add_f32 v19, v19, v227
v_add_f32 v16, v16, v52
v_add_f32 v17, v17, v53
v_add_f32 v18, v18, v54
v_add_f32 v19, v19, v55
v_cvt_pk_bf16_f32 v116, v16, v17
v_cvt_pk_bf16_f32 v117, v18, v19
s_mov_b32 s50, 0
buffer_store_dwordx2 v[116:117], v12, s[4:7], s50 offen
s_waitcnt lgkmcnt(3)
v_add_f32 v20, v20, v232
v_add_f32 v236, v236, v240
v_add_f32 v21, v21, v233
v_add_f32 v237, v237, v241
v_add_f32 v22, v22, v234
v_add_f32 v238, v238, v242
v_add_f32 v23, v23, v235
v_add_f32 v239, v239, v243
v_add_f32 v20, v20, v236
v_add_f32 v21, v21, v237
v_add_f32 v22, v22, v238
v_add_f32 v23, v23, v239
v_add_f32 v20, v20, v56
v_add_f32 v21, v21, v57
v_add_f32 v22, v22, v58
v_add_f32 v23, v23, v59
v_cvt_pk_bf16_f32 v118, v20, v21
v_cvt_pk_bf16_f32 v119, v22, v23
s_mov_b32 s50, 16384
buffer_store_dwordx2 v[118:119], v12, s[4:7], s50 offen
s_waitcnt lgkmcnt(0)
v_add_f32 v24, v24, v244
v_add_f32 v248, v248, v252
v_add_f32 v25, v25, v245
v_add_f32 v249, v249, v253
v_add_f32 v26, v26, v246
v_add_f32 v250, v250, v254
v_add_f32 v27, v27, v247
v_add_f32 v251, v251, v255
v_add_f32 v24, v24, v248
v_add_f32 v25, v25, v249
v_add_f32 v26, v26, v250
v_add_f32 v27, v27, v251
v_add_f32 v24, v24, v60
v_add_f32 v25, v25, v61
v_add_f32 v26, v26, v62
v_add_f32 v27, v27, v63
v_cvt_pk_bf16_f32 v120, v24, v25
v_cvt_pk_bf16_f32 v121, v26, v27
s_mov_b32 s50, 32768
buffer_store_dwordx2 v[120:121], v12, s[4:7], s50 offen
L_end:
s_endpgm
L_redo:
s_lshl_b32 s50, s40, 8
s_add_u32 s50, s50, 162624
v_lshl_add_u32 v9, v0, 2, s50
ds_write_b32 v9, v14
s_waitcnt vmcnt(0) lgkmcnt(0)
s_barrier
s_mov_b32 s3, 1
s_branch L_restart
L_snapback:
s_lshl_b32 s50, s40, 8
s_add_u32 s50, s50, 162624
v_lshl_add_u32 v242, v0, 2, s50
ds_read_b32 v243, v242
s_branch L_snapped
L_fullmax:
s_lshl_b32 s53, s40, 12
s_mov_b32 s52, 0
s_waitcnt lgkmcnt(0)
s_barrier
L_fm_loop:
s_add_u32 m0, s47, 49920
s_nop 0
buffer_load_dwordx4 v1, s[20:23], s53 offen offset:0 nt lds
s_add_u32 m0, s47, 49936
s_nop 0
buffer_load_dwordx4 v1, s[20:23], s53 offen offset:1024 nt lds
s_add_u32 m0, s47, 49952
s_nop 0
buffer_load_dwordx4 v1, s[20:23], s53 offen offset:2048 nt lds
s_add_u32 m0, s47, 49968
s_nop 0
buffer_load_dwordx4 v1, s[20:23], s53 offen offset:3072 nt lds
s_add_u32 s53, s53, 16384
s_waitcnt vmcnt(0)
s_barrier
ds_read_b128 v[220:223], v2 offset:49920
ds_read_b128 v[224:227], v2 offset:49936
ds_read_b128 v[228:231], v2 offset:49952
ds_read_b128 v[232:235], v2 offset:49968
ds_read_b128 v[236:239], v2 offset:50176
ds_read_b128 v[240:243], v2 offset:50192
ds_read_b128 v[244:247], v2 offset:50208
ds_read_b128 v[248:251], v2 offset:50224
s_waitcnt lgkmcnt(0)
s_barrier
v_mfma_f32_16x16x32_bf16 v[136:139], v[220:223], a[96:99], 0
v_mfma_f32_16x16x32_bf16 v[136:139], v[224:227], a[100:103], v[136:139]
v_mfma_f32_16x16x32_bf16 v[136:139], v[228:231], a[104:107], v[136:139]
v_mfma_f32_16x16x32_bf16 v[136:139], v[232:235], a[108:111], v[136:139]
v_mfma_f32_16x16x32_bf16 v[140:143], v[236:239], a[96:99], 0
v_mfma_f32_16x16x32_bf16 v[140:143], v[240:243], a[100:103], v[140:143]
v_mfma_f32_16x16x32_bf16 v[140:143], v[244:247], a[104:107], v[140:143]
v_mfma_f32_16x16x32_bf16 v[140:143], v[248:251], a[108:111], v[140:143]
s_nop 7
v_max3_f32 v112, v112, v136, v137
v_max3_f32 v112, v112, v138, v139
v_max3_f32 v112, v112, v140, v141
v_max3_f32 v112, v112, v142, v143
s_nop 1
v_mfma_f32_16x16x32_bf16 v[136:139], v[220:223], a[112:115], 0
v_mfma_f32_16x16x32_bf16 v[136:139], v[224:227], a[116:119], v[136:139]
v_mfma_f32_16x16x32_bf16 v[136:139], v[228:231], a[120:123], v[136:139]
v_mfma_f32_16x16x32_bf16 v[136:139], v[232:235], a[124:127], v[136:139]
v_mfma_f32_16x16x32_bf16 v[140:143], v[236:239], a[112:115], 0
v_mfma_f32_16x16x32_bf16 v[140:143], v[240:243], a[116:119], v[140:143]
v_mfma_f32_16x16x32_bf16 v[140:143], v[244:247], a[120:123], v[140:143]
v_mfma_f32_16x16x32_bf16 v[140:143], v[248:251], a[124:127], v[140:143]
s_nop 7
v_max3_f32 v113, v113, v136, v137
v_max3_f32 v113, v113, v138, v139
v_max3_f32 v113, v113, v140, v141
v_max3_f32 v113, v113, v142, v143
s_nop 1
v_mfma_f32_16x16x32_bf16 v[136:139], v[220:223], a[128:131], 0
v_mfma_f32_16x16x32_bf16 v[136:139], v[224:227], a[132:135], v[136:139]
v_mfma_f32_16x16x32_bf16 v[136:139], v[228:231], a[136:139], v[136:139]
v_mfma_f32_16x16x32_bf16 v[136:139], v[232:235], a[140:143], v[136:139]
v_mfma_f32_16x16x32_bf16 v[140:143], v[236:239], a[128:131], 0
v_mfma_f32_16x16x32_bf16 v[140:143], v[240:243], a[132:135], v[140:143]
v_mfma_f32_16x16x32_bf16 v[140:143], v[244:247], a[136:139], v[140:143]
v_mfma_f32_16x16x32_bf16 v[140:143], v[248:251], a[140:143], v[140:143]
s_nop 7
v_max3_f32 v114, v114, v136, v137
v_max3_f32 v114, v114, v138, v139
v_max3_f32 v114, v114, v140, v141
v_max3_f32 v114, v114, v142, v143
s_nop 1
v_mfma_f32_16x16x32_bf16 v[136:139], v[220:223], a[144:147], 0
v_mfma_f32_16x16x32_bf16 v[136:139], v[224:227], a[148:151], v[136:139]
v_mfma_f32_16x16x32_bf16 v[136:139], v[228:231], a[152:155], v[136:139]
v_mfma_f32_16x16x32_bf16 v[136:139], v[232:235], a[156:159], v[136:139]
v_mfma_f32_16x16x32_bf16 v[140:143], v[236:239], a[144:147], 0
v_mfma_f32_16x16x32_bf16 v[140:143], v[240:243], a[148:151], v[140:143]
v_mfma_f32_16x16x32_bf16 v[140:143], v[244:247], a[152:155], v[140:143]
v_mfma_f32_16x16x32_bf16 v[140:143], v[248:251], a[156:159], v[140:143]
s_nop 7
v_max3_f32 v115, v115, v136, v137
v_max3_f32 v115, v115, v138, v139
v_max3_f32 v115, v115, v140, v141
v_max3_f32 v115, v115, v142, v143
s_nop 1
v_mfma_f32_16x16x32_bf16 v[136:139], v[220:223], a[160:163], 0
v_mfma_f32_16x16x32_bf16 v[136:139], v[224:227], a[164:167], v[136:139]
v_mfma_f32_16x16x32_bf16 v[136:139], v[228:231], a[168:171], v[136:139]
v_mfma_f32_16x16x32_bf16 v[136:139], v[232:235], a[172:175], v[136:139]
v_mfma_f32_16x16x32_bf16 v[140:143], v[236:239], a[160:163], 0
v_mfma_f32_16x16x32_bf16 v[140:143], v[240:243], a[164:167], v[140:143]
v_mfma_f32_16x16x32_bf16 v[140:143], v[244:247], a[168:171], v[140:143]
v_mfma_f32_16x16x32_bf16 v[140:143], v[248:251], a[172:175], v[140:143]
s_nop 7
v_max3_f32 v116, v116, v136, v137
v_max3_f32 v116, v116, v138, v139
v_max3_f32 v116, v116, v140, v141
v_max3_f32 v116, v116, v142, v143
s_nop 1
v_mfma_f32_16x16x32_bf16 v[136:139], v[220:223], a[176:179], 0
v_mfma_f32_16x16x32_bf16 v[136:139], v[224:227], a[180:183], v[136:139]
v_mfma_f32_16x16x32_bf16 v[136:139], v[228:231], a[184:187], v[136:139]
v_mfma_f32_16x16x32_bf16 v[136:139], v[232:235], a[188:191], v[136:139]
v_mfma_f32_16x16x32_bf16 v[140:143], v[236:239], a[176:179], 0
v_mfma_f32_16x16x32_bf16 v[140:143], v[240:243], a[180:183], v[140:143]
v_mfma_f32_16x16x32_bf16 v[140:143], v[244:247], a[184:187], v[140:143]
v_mfma_f32_16x16x32_bf16 v[140:143], v[248:251], a[188:191], v[140:143]
s_nop 7
v_max3_f32 v117, v117, v136, v137
v_max3_f32 v117, v117, v138, v139
v_max3_f32 v117, v117, v140, v141
v_max3_f32 v117, v117, v142, v143
s_nop 1
s_add_u32 s52, s52, 1
s_cmp_lt_u32 s52, 32
s_cbranch_scc1 L_fm_loop
s_branch L_maxdone
L_codeend:
.section .rodata,"a"
.p2align 6
.amdhsa_kernel standalone__mha_block_cached__near_ridge_kernel
  .amdhsa_next_free_vgpr 512
  .amdhsa_next_free_sgpr 102
  .amdhsa_accum_offset 256
  .amdhsa_group_segment_fixed_size 0
  .amdhsa_kernarg_size 64
  .amdhsa_user_sgpr_count 2
  .amdhsa_user_sgpr_kernarg_segment_ptr 1
  .amdhsa_system_sgpr_workgroup_id_x 1
.end_amdhsa_kernel
```
